```python
import torch

def _softmax(x, axis=-1):
    return torch.softmax(x, dim=axis)

def _gelu(x):
    return torch.nn.functional.gelu(x, approximate='tanh')

def _silu(x):
    return torch.nn.functional.silu(x)

def _sigmoid(x):
    return torch.sigmoid(x)

def _layernorm(x, axis=-1, eps=1e-05):
    m = x.mean(dim=axis, keepdim=True)
    v = x.var(dim=axis, keepdim=True, unbiased=False)
    return (x - m) / torch.sqrt(v + eps)

def _scatter_add(tgt, idx, src, axis=0):
    return tgt.clone().index_add_(axis, idx, src)

def _segment_sum(src, seg, n):
    out = torch.zeros((n,) + src.shape[1:], dtype=src.dtype)
    return out.index_add_(0, seg, src)

def _pad(x, pw):
    flat = tuple((v for pair in reversed(pw) for v in pair))
    return torch.nn.functional.pad(x, flat)
kernel_name = 'standalone__mm_dit__diffusion'

def setup_inputs():

    _w = lambda a: (lambda t: t.to(torch.bfloat16) if t.is_floating_point() else t)(torch.as_tensor(a))
    B, Ni, Nt, D = (2, 1024, 32, 1152)
    return {'x_img': _w((lambda *s: torch.randn(*s, dtype=torch.bfloat16) * 0.05)(B, Ni, D)), 'x_txt': _w((lambda *s: torch.randn(*s, dtype=torch.bfloat16) * 0.05)(B, Nt, D)), 'c': _w((lambda *s: torch.randn(*s, dtype=torch.bfloat16) * 0.05)(B, D)), 'wqkv_img': _w((lambda *s: torch.randn(*s, dtype=torch.bfloat16) * 0.05)(D, 3 * D)), 'wqkv_txt': _w((lambda *s: torch.randn(*s, dtype=torch.bfloat16) * 0.05)(D, 3 * D)), 'wo_img': _w((lambda *s: torch.randn(*s, dtype=torch.bfloat16) * 0.05)(D, D)), 'wo_txt': _w((lambda *s: torch.randn(*s, dtype=torch.bfloat16) * 0.05)(D, D)), 'wmod_img': _w((lambda *s: torch.randn(*s, dtype=torch.bfloat16) * 0.05)(D, 6 * D)), 'wmod_txt': _w((lambda *s: torch.randn(*s, dtype=torch.bfloat16) * 0.05)(D, 6 * D))}

def reference(x_img, x_txt, c, wqkv_img, wqkv_txt, wo_img, wo_txt, wmod_img, wmod_txt):
    B, Ni, D = x_img.shape
    Nt = x_txt.shape[1]
    mod_i = (_silu(c) @ wmod_img).reshape(B, 6, 1, D)
    mod_t = (_silu(c) @ wmod_txt).reshape(B, 6, 1, D)
    shi, sci, gai = (mod_i[:, 0].clone(), mod_i[:, 1].clone(), mod_i[:, 2].clone())
    sht, sct, gat = (mod_t[:, 0].clone(), mod_t[:, 1].clone(), mod_t[:, 2].clone())
    hi = _layernorm(x_img, axis=-1) * (1 + sci) + shi
    ht = _layernorm(x_txt, axis=-1) * (1 + sct) + sht
    qkvi = hi @ wqkv_img
    qkvt = ht @ wqkv_txt
    qi, ki, vi = (qkvi[..., :D].clone(), qkvi[..., D:2 * D].clone(), qkvi[..., 2 * D:].clone())
    qt, kt, vt = (qkvt[..., :D].clone(), qkvt[..., D:2 * D].clone(), qkvt[..., 2 * D:].clone())
    q = torch.concatenate([qt, qi], axis=1)
    k = torch.concatenate([kt, ki], axis=1)
    v = torch.concatenate([vt, vi], axis=1)
    scores = torch.einsum('bqd,bkd->bqk', q, k) * D ** (-0.5)
    p = _softmax(scores, axis=-1)
    a = torch.einsum('bqk,bkd->bqd', p, v)
    at, ai = (a[:, :Nt].clone(), a[:, Nt:].clone())
    out_i = x_img + gai * (ai @ wo_img)
    out_t = x_txt + gat * (at @ wo_txt)
    return (out_i, out_t)
```

```asm
; @launch grid=(256,1,1) block=(512,1,1) lds=163840
.amdgcn_target "amdgcn-amd-amdhsa--gfx950"
.text
  .globl standalone__mm_dit__diffusion_kernel
  .p2align 8
  .type standalone__mm_dit__diffusion_kernel,@function
standalone__mm_dit__diffusion_kernel:
  s_load_dwordx8 s[36:43], s[0:1], 0
  s_load_dwordx8 s[44:51], s[0:1], 32
  s_load_dwordx8 s[52:59], s[0:1], 64
  s_cmp_ge_u32 s2, 256
  s_cbranch_scc1 L_end
  s_getpc_b64 s[6:7]
L_pc:
  s_lshr_b32 s92, s2, 3
  s_lshl_b32 s92, s92, 11
  v_subrev_u32 v2, 384, v0
  v_lshl_add_u32 v3, v2, 4, s92
  s_mov_b32 s4, s6
  s_mov_b32 s5, s7
  s_mov_b32 s6, L_end - L_pc
  s_mov_b32 s7, 0x20000
  v_cmp_gt_u32 vcc, 128, v2
  s_cbranch_vccz L_nocpf
  buffer_load_dwordx4 v[248:251], v3, s[4:7], 0 offen
L_nocpf:
  v_lshrrev_b32 v1, 6, v0
  v_mov_b32 v15, 0
  v_readfirstlane_b32 s3, v1
  v_and_b32 v1, 63, v0
  v_lshlrev_b32 v2, 2, v1
  v_add_u32 v2, 163520, v2
  ds_write_b32 v2, v15
  s_cmp_lt_u32 s3, 4
  s_cbranch_scc1 L_nofast
  s_cmp_ge_u32 s2, 112
  s_cbranch_scc1 L_nofast
  s_and_b32 s92, s2, 7
  s_mul_i32 s92, s92, 14
  s_lshr_b32 s93, s2, 3
  s_add_u32 s92, s92, s93
  s_cmp_ge_u32 s92, 108
  s_cbranch_scc1 L_nofast
  s_mul_hi_u32 s70, s92, 119304648
  s_mul_i32 s71, s70, 36
  s_sub_u32 s71, s92, s71
  s_mul_hi_u32 s62, s71, 1431655766
  s_mul_i32 s61, s62, 3
  s_sub_u32 s61, s71, s61
  s_mul_i32 s70, s70, 3
  s_add_u32 s61, s61, s70
  s_mov_b32 s60, 0
  s_lshl_b32 s65, s61, 8
  s_sub_u32 s84, s3, 4
  s_mul_i32 s85, s84, 4160
  s_mov_b32 s82, s85
  s_mul_i32 s5, s84, 1040
  s_sub_u32 s5, 16640, s5
  s_mov_b32 m0, s82
  v_bfe_u32 v2, v1, 2, 2
  v_lshl_add_u32 v2, s84, 4, v2
  v_lshrrev_b32 v20, 4, v1
  v_and_b32 v21, 3, v1
  v_lshlrev_b32 v21, 4, v21
  v_lshl_add_u32 v3, v20, 6, v21
  v_bfe_u32 v20, v1, 2, 3
  v_lshl_add_u32 v4, s84, 5, v20
  s_mul_i32 s75, s84, 24
  v_add_u32 v5, s75, v20
  v_bfe_u32 v20, v1, 4, 1
  v_mul_u32_u24 v20, 48, v20
  v_xor_b32 v21, v21, v20
  v_lshrrev_b32 v20, 5, v1
  v_lshl_add_u32 v6, v20, 6, v21
  s_and_b32 s75, s84, 1
  s_mul_i32 s75, s75, 48
  v_xor_b32 v7, s75, v6
  v_mov_b32 v8, 0
  s_add_u32 s84, s61, s62
  v_add_u32 v20, s84, v1
  v_mov_b32 v22, 3
  v_mul_u32_u24 v21, 13108, v20
  v_lshrrev_b32 v21, 16, v21
  v_mul_u32_u24 v21, 5, v21
  v_sub_u32 v20, v20, v21
  v_cmp_ge_u32 vcc, 3, v20
  v_cmp_eq_u32 s[66:67], 0, v20
  v_sub_u32 v20, v1, v20
  v_cndmask_b32 v21, 0, -1, vcc
  v_cmp_gt_u32 vcc, 15, v20
  v_cndmask_b32 v21, v21, v22, s[66:67]
  s_nop 0
  v_cndmask_b32 v21, 0, v21, vcc
  v_add_u32 v10, v1, v21
  s_and_b32 s84, s2, 7
  s_mul_i32 s84, s84, 9
  s_lshr_b32 s84, s84, 2
  v_add_u32 v10, s84, v10
  v_subrev_u32 v20, 18, v10
  v_min_u32 v10, v10, v20
  s_waitcnt lgkmcnt(0)
  s_load_dword s8, s[58:59], 151424
  s_add_u32 s12, s58, 0
  s_addc_u32 s13, s59, 0
  s_mov_b32 s14, 268435456
  s_mov_b32 s15, 0x20000
  s_add_u32 s67, s65, 0
  s_sub_u32 s66, 2654208, s67
  s_add_u32 s16, s46, s67
  s_addc_u32 s17, s47, 0
  s_mov_b32 s18, s66
  s_mov_b32 s19, 0x20000
  s_mul_i32 s70, s62, 663552
  s_add_u32 s67, s70, 4608
  s_sub_u32 s66, 7962624, s67
  s_add_u32 s20, s42, s67
  s_addc_u32 s21, s43, 0
  s_mov_b32 s22, s66
  s_mov_b32 s23, 0x20000
  s_mov_b32 s7, 2304
  s_mov_b32 s76, 2304
  s_mov_b32 s77, 6912
  s_mov_b32 s78, 147456
  v_mul_u32_u24 v9, s78, v10
  v_lshlrev_b32 v10, 7, v10
  v_mad_u32_u24 v24, v2, s76, v3
  v_add_u32 v25, 8176, v24
  v_add_u32 v26, 16352, v24
  v_add_u32 v27, 24528, v24
  v_readlane_b32 s100, v9, 0
  v_readlane_b32 s101, v10, 0
  s_mov_b32 s98, 1
  v_mad_u32_u24 v28, v5, s77, v7
  v_xor_b32 v20, 48, v28
  v_add_u32 v29, 54256, v20
  v_add_u32 v30, 108512, v28
  s_nop 1
  buffer_load_dwordx4 v24, s[16:19], s100 offen offset:0 sc1 lds
  buffer_load_dwordx4 v25, s[16:19], s100 offen offset:1040 sc1 lds
  buffer_load_dwordx4 v26, s[16:19], s100 offen offset:2080 sc1 lds
  buffer_load_dwordx4 v27, s[16:19], s100 offen offset:3120 sc1 lds
  s_add_u32 m0, s82, s5
  v_readlane_b32 s100, v9, s98
  buffer_load_dwordx4 v28, s[20:23], s101 offen offset:0 sc1 lds
  s_add_u32 s82, s82, 29120
  s_cmp_ge_u32 s82, 145600
  buffer_load_dwordx4 v29, s[20:23], s101 offen offset:1040 sc1 lds
  s_cselect_b32 s82, s85, s82
  buffer_load_dwordx4 v30, s[20:23], s101 offen offset:2080 sc1 lds
  s_mov_b32 m0, s82
  v_readlane_b32 s101, v10, s98
  s_add_u32 s98, s98, 1
  s_branch L_l_u
L_nofast:
  s_sub_u32 s9, s2, 200
  s_sub_u32 s10, s2, 112
  s_cmp_ge_u32 s2, 220
  s_cselect_b32 s81, 1, 0
  s_mul_i32 s92, s81, 108
  s_sub_u32 s92, s10, s92
  s_mov_b32 s66, 1
  s_lshr_b32 s93, s3, 2
  s_mul_i32 s93, s93, 14
  s_add_u32 s92, s92, s93
  s_lshr_b32 s71, s3, 2
  s_mov_b32 s79, 145600
  s_mul_i32 s75, s71, 2048
  s_add_u32 s79, s79, s75
  s_mov_b32 s80, 163520
  s_mul_i32 s75, s71, 4
  s_add_u32 s80, s80, s75
  s_mov_b32 s71, s81
  s_mov_b32 s81, s92
  s_mul_hi_u32 s92, s81, 1431655766
  s_mul_i32 s93, s92, 3
  s_sub_u32 s93, s81, s93
  s_lshl_b32 s67, s92, 7
  s_mul_i32 s70, s93, 384
  s_movk_i32 s78, 9216
  s_mov_b32 s76, 151552
  s_mul_i32 s75, s93, 36864
  s_add_u32 s76, s76, s75
  s_mul_i32 s75, s71, 18432
  s_add_u32 s76, s76, s75
  s_mul_i32 s75, s92, 256
  s_add_u32 s76, s76, s75
  s_mov_b32 s77, 4
  s_mov_b32 s6, -1
  s_and_b32 s75, s3, 3
  s_mul_i32 s75, s75, 96
  s_add_u32 s70, s70, s75
  v_and_b32 v120, 7, v1
  v_lshrrev_b32 v121, 3, v1
  v_lshlrev_b32 v120, 4, v120
  s_mov_b32 s75, 165888
  v_mad_u32_u24 v120, v121, s75, v120
  v_add_u32 v120, s67, v120
  v_mul_u32_u24 v122, 24, v121
  s_waitcnt lgkmcnt(0)
  s_load_dword s8, s[58:59], 151424
  s_add_u32 s12, s58, 0
  s_addc_u32 s13, s59, 0
  s_mov_b32 s14, 268435456
  s_mov_b32 s15, 0x20000
  s_cmp_ge_u32 s3, 4
  s_cbranch_scc1 L_nold
  s_cmp_lt_u32 s2, 112
  s_cbranch_scc1 L_nold
  s_cmp_eq_u32 s71, 1
  s_cselect_b32 s16, s52, s50
  s_cselect_b32 s17, s53, s51
  s_mov_b32 s18, 15925248
  s_mov_b32 s19, 0x20000
  s_add_u32 s20, s40, 0
  s_addc_u32 s21, s41, 0
  s_mov_b32 s22, 4608
  s_mov_b32 s23, 0x20000
  s_lshl_b32 s75, s70, 1
  buffer_load_dwordx2 v[204:205], v122, s[20:23], s75 offen offset:0
  buffer_load_dwordx2 v[206:207], v122, s[20:23], s75 offen offset:8
  buffer_load_dwordx2 v[208:209], v122, s[20:23], s75 offen offset:16
  buffer_load_dwordx2 v[210:211], v122, s[20:23], s75 offen offset:2304
  buffer_load_dwordx2 v[212:213], v122, s[20:23], s75 offen offset:2312
  buffer_load_dwordx2 v[214:215], v122, s[20:23], s75 offen offset:2320
  s_mul_i32 s81, s70, 13824
  buffer_load_dwordx4 v[32:35], v120, s[16:19], s81 offen nt
  s_add_u32 s81, s81, 13824
  buffer_load_dwordx4 v[36:39], v120, s[16:19], s81 offen nt
  s_add_u32 s81, s81, 13824
  buffer_load_dwordx4 v[40:43], v120, s[16:19], s81 offen nt
  s_add_u32 s81, s81, 13824
  buffer_load_dwordx4 v[44:47], v120, s[16:19], s81 offen nt
  s_add_u32 s81, s81, 13824
  buffer_load_dwordx4 v[48:51], v120, s[16:19], s81 offen nt
  s_add_u32 s81, s81, 13824
  buffer_load_dwordx4 v[52:55], v120, s[16:19], s81 offen nt
  s_add_u32 s81, s81, 13824
  buffer_load_dwordx4 v[56:59], v120, s[16:19], s81 offen nt
  s_add_u32 s81, s81, 13824
  buffer_load_dwordx4 v[60:63], v120, s[16:19], s81 offen nt
  s_add_u32 s81, s81, 13824
  buffer_load_dwordx4 v[64:67], v120, s[16:19], s81 offen nt
  s_add_u32 s81, s81, 13824
  buffer_load_dwordx4 v[68:71], v120, s[16:19], s81 offen nt
  s_add_u32 s81, s81, 13824
  buffer_load_dwordx4 v[72:75], v120, s[16:19], s81 offen nt
  s_add_u32 s81, s81, 13824
  buffer_load_dwordx4 v[76:79], v120, s[16:19], s81 offen nt
L_nold:
  s_cmp_eq_u32 s2, 195
  s_cselect_b32 s10, 128, s10
  s_cmp_eq_u32 s2, 199
  s_cselect_b32 s10, 129, s10
  s_cmp_eq_u32 s2, 240
  s_cselect_b32 s10, 83, s10
  s_cmp_eq_u32 s2, 241
  s_cselect_b32 s10, 87, s10
  s_cmp_eq_u32 s2, 242
  s_cselect_b32 s10, 200, s10
  s_cmp_eq_u32 s2, 243
  s_cselect_b32 s10, 200, s10
  s_cmp_eq_u32 s2, 254
  s_cselect_b32 s10, 130, s10
  s_cmp_eq_u32 s2, 255
  s_cselect_b32 s10, 131, s10
  s_barrier
  s_waitcnt lgkmcnt(0)
  s_mul_i32 s11, s8, 1664525
  s_add_u32 s11, s11, 1013904223
  s_cmp_ge_u32 s3, 4
  s_cbranch_scc1 L_loader
  s_cmp_lt_u32 s2, 112
  s_cbranch_scc1 L_c_nogv
  s_call_b64 s[86:87], L_gemv2
L_c_nogv:
  s_lshr_b32 s90, s3, 1
  s_and_b32 s91, s3, 1
  s_mov_b32 s89, -1
  s_mov_b32 s98, 0
  s_mov_b32 s88, 0
  v_lshrrev_b32 v196, 4, v1
  v_lshrrev_b32 v198, 1, v1
  v_xor_b32 v198, v198, v1
  v_bfe_u32 v198, v198, 2, 1
  v_mul_u32_u24 v198, 3, v198
  v_xor_b32 v198, v198, v196
  v_and_b32 v197, 7, v1
  v_lshlrev_b32 v197, 6, v197
  v_lshl_add_u32 v198, v198, 4, v197
  v_bfe_u32 v197, v1, 3, 1
  v_mul_u32_u24 v197, 1040, v197
  v_add_u32 v198, v198, v197
  s_mul_i32 s92, s91, 6240
  s_add_u32 s92, s92, 16640
  v_add_u32 v3, s92, v198
  s_mul_i32 s93, s90, 8320
  s_sub_u32 s93, s93, s92
  v_mov_b32 v5, s93
  v_mul_u32_u24 v196, 2080, v196
  v_bfe_u32 v197, v1, 2, 2
  v_lshl_add_u32 v196, v197, 6, v196
  v_and_b32 v197, 3, v1
  v_lshl_add_u32 v196, v197, 3, v196
  s_lshl_b32 s93, s90, 9
  v_add_u32 v196, s93, v196
  v_sub_u32 v4, v196, v3
  v_and_b32 v198, 12, v1
  v_bfe_u32 v199, v1, 4, 1
  s_mul_i32 s92, s91, 48
  v_add3_u32 v10, v198, v199, s92
  v_and_b32 v198, 3, v1
  v_lshlrev_b32 v198, 5, v198
  v_lshrrev_b32 v199, 5, v1
  v_lshl_add_u32 v198, v199, 4, v198
  s_lshl_b32 s92, s90, 7
  v_add_u32 v11, s92, v198
  v_bfe_i32 v8, v1, 0, 1
  v_bfe_i32 v9, v1, 1, 1
  v_mov_b32 v12, 1
  v_mov_b32 v13, 0
  s_cmp_ge_u32 s10, 132
  s_cbranch_scc1 L_notab
  s_lshr_b32 s80, s10, 7
  s_lshr_b32 s81, s10, 6
  s_bfe_u32 s75, s10, 0x10001
  s_cmp_eq_u32 s80, 1
  s_cselect_b32 s81, s75, s81
  v_cmp_le_u32 vcc, 32, v0
  v_mov_b32 v14, 163536
  v_mov_b32 v223, 1.0
  v_cndmask_b32 v222, 0, v223, vcc
  s_mov_b32 s76, 151552
  s_mul_i32 s75, s80, 18432
  s_add_u32 s76, s76, s75
  s_mul_i32 s75, s81, 9216
  s_add_u32 s76, s76, s75
  v_lshlrev_b32 v180, 4, v0
  v_lshlrev_b32 v181, 4, v1
  s_lshl_b32 s75, s3, 8
  v_add_u32 v181, s75, v181
  v_mov_b32 v182, 163540
  s_mov_b32 s74, 16777216
L_lw_1:
  ds_read_b32 v183, v182
  s_waitcnt lgkmcnt(0)
  v_cmp_le_u32 vcc, 4, v183
  s_cbranch_vccnz L_lw_1_d
  s_sleep 1
  s_sub_u32 s74, s74, 1
  s_cmp_lg_u32 s74, 0
  s_cbranch_scc1 L_lw_1
L_lw_1_d:
  s_and_b32 s77, s11, 255
  s_mov_b32 s74, 0x80000
L_ln_p:
  v_mov_b32 v192, s77
  v_mov_b32 v193, s77
  v_mov_b32 v194, s77
  v_mov_b32 v195, s77
  v_mov_b32 v204, s77
  v_mov_b32 v205, s77
  v_mov_b32 v206, s77
  v_mov_b32 v207, s77
  v_mov_b32 v216, s77
  v_mov_b32 v217, s77
  v_mov_b32 v218, s77
  v_mov_b32 v219, s77
  s_add_u32 s75, s76, 0
  buffer_load_dwordx4 v[184:187], v180, s[12:15], s75 offen sc1
  s_add_u32 s75, s76, 4096
  buffer_load_dwordx4 v[188:191], v180, s[12:15], s75 offen sc1
  s_add_u32 s75, s76, 36864
  buffer_load_dwordx4 v[196:199], v180, s[12:15], s75 offen sc1
  s_add_u32 s75, s76, 40960
  buffer_load_dwordx4 v[200:203], v180, s[12:15], s75 offen sc1
  s_add_u32 s75, s76, 73728
  buffer_load_dwordx4 v[208:211], v180, s[12:15], s75 offen sc1
  s_add_u32 s75, s76, 77824
  buffer_load_dwordx4 v[212:215], v180, s[12:15], s75 offen sc1
  s_mov_b64 s[82:83], exec
  s_and_b64 exec, exec, 0xffff
  s_cbranch_execz L_ln_q
  s_add_u32 s75, s76, 8192
  buffer_load_dwordx4 v[192:195], v181, s[12:15], s75 offen sc1
  s_add_u32 s75, s76, 45056
  buffer_load_dwordx4 v[204:207], v181, s[12:15], s75 offen sc1
  s_add_u32 s75, s76, 81920
  buffer_load_dwordx4 v[216:219], v181, s[12:15], s75 offen sc1
L_ln_q:
  s_mov_b64 exec, s[82:83]
  s_waitcnt vmcnt(0)
  v_xor_b32 v184, s77, v184
  v_xor_b32 v185, s77, v185
  v_xor_b32 v186, s77, v186
  v_xor_b32 v187, s77, v187
  v_xor_b32 v188, s77, v188
  v_xor_b32 v189, s77, v189
  v_xor_b32 v190, s77, v190
  v_xor_b32 v191, s77, v191
  v_xor_b32 v192, s77, v192
  v_xor_b32 v193, s77, v193
  v_xor_b32 v194, s77, v194
  v_xor_b32 v195, s77, v195
  v_xor_b32 v196, s77, v196
  v_xor_b32 v197, s77, v197
  v_xor_b32 v198, s77, v198
  v_xor_b32 v199, s77, v199
  v_xor_b32 v200, s77, v200
  v_xor_b32 v201, s77, v201
  v_xor_b32 v202, s77, v202
  v_xor_b32 v203, s77, v203
  v_xor_b32 v204, s77, v204
  v_xor_b32 v205, s77, v205
  v_xor_b32 v206, s77, v206
  v_xor_b32 v207, s77, v207
  v_xor_b32 v208, s77, v208
  v_xor_b32 v209, s77, v209
  v_xor_b32 v210, s77, v210
  v_xor_b32 v211, s77, v211
  v_xor_b32 v212, s77, v212
  v_xor_b32 v213, s77, v213
  v_xor_b32 v214, s77, v214
  v_xor_b32 v215, s77, v215
  v_xor_b32 v216, s77, v216
  v_xor_b32 v217, s77, v217
  v_xor_b32 v218, s77, v218
  v_xor_b32 v219, s77, v219
  v_or_b32 v182, v184, v185
  v_or3_b32 v182, v182, v186, v187
  v_or3_b32 v182, v182, v188, v189
  v_or3_b32 v182, v182, v190, v191
  v_or3_b32 v182, v182, v192, v193
  v_or3_b32 v182, v182, v194, v195
  v_or3_b32 v182, v182, v196, v197
  v_or3_b32 v182, v182, v198, v199
  v_or3_b32 v182, v182, v200, v201
  v_or3_b32 v182, v182, v202, v203
  v_or3_b32 v182, v182, v204, v205
  v_or3_b32 v182, v182, v206, v207
  v_or3_b32 v182, v182, v208, v209
  v_or3_b32 v182, v182, v210, v211
  v_or3_b32 v182, v182, v212, v213
  v_or3_b32 v182, v182, v214, v215
  v_or3_b32 v182, v182, v216, v217
  v_or3_b32 v182, v182, v218, v219
  v_and_b32 v182, 255, v182
  v_cmp_ne_u32 vcc, 0, v182
  s_cbranch_vccz L_ln_g
  s_sub_u32 s74, s74, 1
  s_cmp_eq_u32 s74, 0
  s_cbranch_scc1 L_ln_g
  s_mov_b64 exec, vcc
  s_sleep 1
  s_branch L_ln_p
L_ln_g:
  s_mov_b64 exec, -1
  v_add_u32 v182, 153792, v180
  v_pk_add_f32 v[184:185], v[184:185], v[196:197]
  v_pk_add_f32 v[186:187], v[186:187], v[198:199]
  v_pk_add_f32 v[188:189], v[188:189], v[200:201]
  v_pk_add_f32 v[190:191], v[190:191], v[202:203]
  v_pk_add_f32 v[192:193], v[192:193], v[204:205]
  v_pk_add_f32 v[194:195], v[194:195], v[206:207]
  v_pk_add_f32 v[184:185], v[184:185], v[208:209]
  v_pk_add_f32 v[186:187], v[186:187], v[210:211]
  v_pk_add_f32 v[188:189], v[188:189], v[212:213]
  v_pk_add_f32 v[190:191], v[190:191], v[214:215]
  v_pk_add_f32 v[192:193], v[192:193], v[216:217]
  v_pk_add_f32 v[194:195], v[194:195], v[218:219]
  v_add_f32 v188, v188, v222
  v_add_f32 v189, v189, v222
  v_add_f32 v190, v190, v222
  v_add_f32 v191, v191, v222
  v_add_f32 v192, v192, v223
  v_add_f32 v193, v193, v223
  v_add_f32 v194, v194, v223
  v_add_f32 v195, v195, v223
  ds_write_b128 v182, v[184:187] offset:0
  ds_write_b128 v182, v[188:191] offset:4096
  v_add_u32 v181, 153792, v181
  s_mov_b64 exec, 0xffff
  ds_write_b128 v181, v[192:195] offset:8192
  s_mov_b64 exec, -1
  s_mov_b64 exec, 1
  ds_add_u32 v14, v12
  s_mov_b64 exec, -1
L_notab:
  s_mov_b32 s60, 0
  s_mov_b32 s62, 0
  s_mov_b32 s64, 0
  s_mov_b32 s65, 0
  s_movk_i32 s92, 2304
  v_add_u32 v216, 0, v10
  v_mad_u32_u24 v240, v216, s92, v11
  v_add_u32 v216, 2, v10
  v_mad_u32_u24 v241, v216, s92, v11
  v_add_u32 v216, 16, v10
  v_mad_u32_u24 v242, v216, s92, v11
  v_add_u32 v216, 18, v10
  v_mad_u32_u24 v243, v216, s92, v11
  v_add_u32 v216, 32, v10
  v_mad_u32_u24 v244, v216, s92, v11
  v_add_u32 v216, 34, v10
  v_mad_u32_u24 v245, v216, s92, v11
  v_bfe_u32 v217, v1, 4, 1
  v_lshlrev_b32 v217, 9, v217
  v_lshrrev_b32 v216, 5, v1
  v_lshl_add_u32 v217, v216, 8, v217
  v_and_b32 v216, 15, v1
  v_lshl_add_u32 v217, v216, 4, v217
  s_mul_i32 s92, s91, 110592
  s_lshl_b32 s93, s90, 11
  s_add_u32 s92, s92, s93
  v_add_u32 v10, s92, v217
  s_mul_i32 s92, s91, 6240
  s_add_u32 s92, s92, 16640
  v_lshl_add_u32 v14, v1, 4, s92
  v_sub_u32 v14, v14, v3
  s_cmp_ge_u32 s2, 200
  s_cbranch_scc1 L_caux
  s_cmp_ge_u32 s2, 112
  s_cbranch_scc1 L_c_nou
  s_and_b32 s92, s2, 7
  s_mul_i32 s92, s92, 14
  s_lshr_b32 s93, s2, 3
  s_add_u32 s92, s92, s93
  s_cmp_ge_u32 s92, 108
  s_cbranch_scc1 L_c_nou
  s_mul_hi_u32 s70, s92, 119304648
  s_mul_i32 s71, s70, 36
  s_sub_u32 s71, s92, s71
  s_mul_hi_u32 s62, s71, 1431655766
  s_mul_i32 s61, s62, 3
  s_sub_u32 s61, s71, s61
  s_mul_i32 s70, s70, 3
  s_add_u32 s61, s61, s70
  s_mov_b32 s60, 0
  s_lshl_b32 s65, s61, 8
  s_barrier
  s_call_b64 s[86:87], L_tk
  s_mov_b32 s70, 0
  s_mul_i32 s75, s62, 221184
  s_add_u32 s70, s70, s75
  s_mov_b32 s67, 26427392
  s_add_u32 s67, s67, s70
  s_add_u32 s67, s67, s65
  s_add_u32 s24, s58, s67
  s_addc_u32 s25, s59, 0
  s_mov_b32 s26, 221184
  s_mov_b32 s27, 0x20000
  s_call_b64 s[68:69], L_st3
  s_and_b32 s92, s2, 3
  s_lshr_b32 s93, s2, 3
  s_bfe_u32 s60, s2, 0x10002
  s_mul_hi_u32 s62, s93, 858993460
  s_mul_i32 s61, s62, 5
  s_sub_u32 s61, s93, s61
  s_lshr_b32 s70, s93, 2
  s_and_b32 s71, s93, 3
  s_bitcmp1_b32 s92, 0
  s_cselect_b32 s62, s70, s62
  s_cselect_b32 s61, s71, s61
  s_lshl_b32 s70, s92, 2
  s_lshr_b32 s71, 0x0650, s70
  s_and_b32 s71, s71, 15
  s_add_u32 s62, s62, s71
  s_lshr_b32 s71, 0x5400, s70
  s_and_b32 s71, s71, 15
  s_add_u32 s61, s61, s71
  s_mul_i32 s92, s92, 25
  s_add_u32 s92, s92, s93
  s_cmp_eq_u32 s92, 20
  s_cselect_b32 s61, 4, s61
  s_cselect_b32 s62, 5, s62
  s_cmp_eq_u32 s92, 49
  s_cselect_b32 s62, 4, s62
  s_mov_b32 s63, 0
  s_mul_i32 s75, s60, 2433024
  s_add_u32 s63, s63, s75
  s_mul_i32 s75, s62, 221184
  s_add_u32 s63, s63, s75
  s_mov_b32 s64, 221184
  s_cmp_eq_u32 s62, 10
  s_cselect_b32 s64, 147456, s64
  s_lshl_b32 s65, s61, 8
  s_barrier
  s_call_b64 s[86:87], L_qk
  s_branch L_c_k
L_c_nou:
  s_and_b32 s92, s2, 3
  s_lshr_b32 s93, s2, 3
  s_bfe_u32 s60, s2, 0x10002
  s_mul_hi_u32 s62, s93, 858993460
  s_mul_i32 s61, s62, 5
  s_sub_u32 s61, s93, s61
  s_lshr_b32 s70, s93, 2
  s_and_b32 s71, s93, 3
  s_bitcmp1_b32 s92, 0
  s_cselect_b32 s62, s70, s62
  s_cselect_b32 s61, s71, s61
  s_lshl_b32 s70, s92, 2
  s_lshr_b32 s71, 0x0650, s70
  s_and_b32 s71, s71, 15
  s_add_u32 s62, s62, s71
  s_lshr_b32 s71, 0x5400, s70
  s_and_b32 s71, s71, 15
  s_add_u32 s61, s61, s71
  s_mul_i32 s92, s92, 25
  s_add_u32 s92, s92, s93
  s_cmp_eq_u32 s92, 20
  s_cselect_b32 s61, 4, s61
  s_cselect_b32 s62, 5, s62
  s_cmp_eq_u32 s92, 49
  s_cselect_b32 s62, 4, s62
  s_mov_b32 s63, 0
  s_mul_i32 s75, s60, 2433024
  s_add_u32 s63, s63, s75
  s_mul_i32 s75, s62, 221184
  s_add_u32 s63, s63, s75
  s_mov_b32 s64, 221184
  s_cmp_eq_u32 s62, 10
  s_cselect_b32 s64, 147456, s64
  s_lshl_b32 s65, s61, 8
  s_cmp_ge_u32 s92, 99
  s_cbranch_scc1 L_fin
  s_barrier
  s_barrier
  s_call_b64 s[86:87], L_qk
L_c_k:
  s_lshl_b32 s70, s61, 12
  s_mov_b32 s67, 6963200
  s_add_u32 s67, s67, s63
  s_add_u32 s67, s67, s70
  s_add_u32 s24, s58, s67
  s_addc_u32 s25, s59, 0
  s_mov_b32 s26, s64
  s_mov_b32 s27, 0x20000
  s_mov_b32 s67, 11829248
  s_add_u32 s67, s67, s63
  s_add_u32 s67, s67, s70
  s_add_u32 s28, s58, s67
  s_addc_u32 s29, s59, 0
  s_mov_b32 s30, s64
  s_mov_b32 s31, 0x20000
  s_call_b64 s[68:69], L_st6
  s_barrier
  s_call_b64 s[86:87], L_tk
  s_mov_b32 s67, 16695296
  s_add_u32 s67, s67, s63
  s_add_u32 s67, s67, s65
  s_add_u32 s24, s58, s67
  s_addc_u32 s25, s59, 0
  s_mov_b32 s26, s64
  s_mov_b32 s27, 0x20000
  s_call_b64 s[68:69], L_st3
  v_add_u32 v3, v3, v14
  v_sub_u32 v4, v4, v14
  v_mov_b32 v14, 0
  s_mov_b32 s70, 327680
  s_mul_i32 s75, s60, 143616
  s_add_u32 s70, s70, s75
  s_mul_i32 s75, s61, 16896
  s_add_u32 s70, s70, s75
  s_mul_i32 s75, s90, 8448
  s_add_u32 s70, s70, s75
  s_mul_i32 s75, s62, 768
  s_add_u32 s70, s70, s75
  s_mul_hi_u32 s71, s64, 14913081
  s_add_u32 s28, s58, s70
  s_addc_u32 s29, s59, 0
  s_mov_b32 s30, s71
  s_mov_b32 s31, 0x20000
  s_lshl_b32 s70, s61, 12
  s_mov_b32 s67, 21561344
  s_add_u32 s67, s67, s63
  s_add_u32 s67, s67, s70
  s_add_u32 s4, s58, s67
  s_addc_u32 s5, s59, 0
  s_mov_b32 s6, s64
  s_mov_b32 s7, 0x20000
  s_barrier
  s_call_b64 s[86:87], L_kk
  s_call_b64 s[86:87], L_softmax
  s_mov_b32 s88, 95232
  s_mul_i32 s75, s60, 12672
  s_add_u32 s88, s88, s75
  s_mul_i32 s75, s62, 1152
  s_add_u32 s88, s88, s75
  s_mul_i32 s75, s61, 128
  s_add_u32 s88, s88, s75
  s_mul_i32 s75, s3, 4
  s_add_u32 s88, s88, s75
  s_waitcnt vmcnt(0)
  v_mov_b32 v254, 163548
  s_mov_b64 exec, 1
  ds_add_rtn_u32 v255, v254, v12
  s_andn2_b32 s88, s88, 15
  s_waitcnt lgkmcnt(0)
  v_and_b32 v255, 3, v255
  v_cmp_eq_u32 vcc, 3, v255
  s_mov_b64 exec, 15
  s_cbranch_vccz L_s1_2
  v_mov_b32 v255, s11
  v_lshlrev_b32 v254, 2, v1
  buffer_store_dword v255, v254, s[12:15], s88 offen sc1
L_s1_2:
  s_mov_b64 exec, -1
  v_add_u32 v3, v3, v14
  v_sub_u32 v4, v4, v14
  v_mov_b32 v14, 0
  v_bfe_u32 v246, v1, 2, 2
  v_mul_u32_u24 v246, 1040, v246
  v_and_b32 v247, 3, v1
  v_lshl_add_u32 v246, v247, 8, v246
  v_lshrrev_b32 v247, 4, v1
  v_lshl_add_u32 v246, v247, 3, v246
  v_lshlrev_b32 v247, 4, v1
  v_sub_u32 v246, v246, v247
  s_mul_i32 s92, s91, 6240
  s_lshl_b32 s93, s90, 7
  s_add_u32 s92, s92, s93
  s_sub_u32 s92, s92, 16640
  v_add3_u32 v246, v246, s92, v3
  v_add_u32 v6, 29120, v3
  v_add_u32 v7, 0xfffe3900, v3
  v_min_u32 v3, v7, v6
  v_add_u32 v2, v3, v4
  s_barrier
  ds_read_b64 v[216:217], v246 offset:0
  ds_read_b64 v[218:219], v246 offset:32
  ds_read_b64 v[220:221], v246 offset:64
  ds_read_b64 v[222:223], v246 offset:96
  ds_read_b64 v[224:225], v246 offset:4160
  ds_read_b64 v[226:227], v246 offset:4192
  ds_read_b64 v[228:229], v246 offset:4224
  ds_read_b64 v[230:231], v246 offset:4256
  ds_read_b64 v[232:233], v246 offset:8320
  ds_read_b64 v[234:235], v246 offset:8352
  ds_read_b64 v[236:237], v246 offset:8384
  ds_read_b64 v[238:239], v246 offset:8416
  s_mov_b32 s70, 0
  s_mul_i32 s75, s60, 2359296
  s_add_u32 s70, s70, s75
  s_mul_i32 s75, s62, 221184
  s_add_u32 s70, s70, s75
  s_mul_i32 s75, s65, 1
  s_add_u32 s70, s70, s75
  s_sub_u32 s71, s64, s65
  s_add_u32 s24, s54, s70
  s_addc_u32 s25, s55, 0
  s_mov_b32 s26, s71
  s_mov_b32 s27, 0x20000
  s_call_b64 s[86:87], L_pv
  v_and_b32 v246, 48, v1
  s_lshl_b32 s92, s90, 8
  s_add_u32 s92, s92, 158912
  v_add_u32 v246, s92, v246
  ds_read_b128 v[192:195], v246 offset:0
  ds_read_b128 v[196:199], v246 offset:64
  ds_read_b128 v[200:203], v246 offset:128
  ds_read_b128 v[204:207], v246 offset:192
  ds_read_b128 v[112:115], v246 offset:512
  ds_read_b128 v[116:119], v246 offset:576
  ds_read_b128 v[120:123], v246 offset:640
  ds_read_b128 v[124:127], v246 offset:704
  v_lshlrev_b32 v160, 4, v1
  v_sub_u32 v160, v3, v160
  s_mul_i32 s92, s91, 6240
  s_add_u32 s92, s92, 16640
  s_mul_i32 s93, s3, 6912
  s_sub_u32 s92, s93, s92
  v_add_u32 v160, s92, v160
  v_and_b32 v161, 15, v1
  v_mul_u32_u24 v161, 144, v161
  v_lshrrev_b32 v162, 4, v1
  v_lshl_add_u32 v161, v162, 3, v161
  v_add_u32 v161, v161, v160
  v_and_b32 v162, 12, v1
  v_bfe_u32 v163, v1, 4, 1
  v_add_u32 v162, v162, v163
  v_mul_u32_u24 v162, 144, v162
  v_and_b32 v163, 127, v11
  v_add3_u32 v160, v160, v162, v163
  v_pk_fma_f32 v[16:17], v[64:65], v[248:249], v[16:17] op_sel_hi:[1,0,1]
  v_pk_fma_f32 v[18:19], v[66:67], v[248:249], v[18:19] op_sel_hi:[1,0,1]
  v_pk_fma_f32 v[20:21], v[68:69], v[248:249], v[20:21] op_sel:[0,1,0]
  v_pk_fma_f32 v[22:23], v[70:71], v[248:249], v[22:23] op_sel:[0,1,0]
  v_pk_fma_f32 v[24:25], v[72:73], v[250:251], v[24:25] op_sel_hi:[1,0,1]
  v_pk_fma_f32 v[26:27], v[74:75], v[250:251], v[26:27] op_sel_hi:[1,0,1]
  v_pk_fma_f32 v[28:29], v[76:77], v[248:249], v[28:29] op_sel_hi:[1,0,1]
  v_pk_fma_f32 v[30:31], v[78:79], v[248:249], v[30:31] op_sel_hi:[1,0,1]
  v_pk_fma_f32 v[32:33], v[80:81], v[248:249], v[32:33] op_sel:[0,1,0]
  v_pk_fma_f32 v[34:35], v[82:83], v[248:249], v[34:35] op_sel:[0,1,0]
  v_pk_fma_f32 v[36:37], v[84:85], v[250:251], v[36:37] op_sel_hi:[1,0,1]
  v_pk_fma_f32 v[38:39], v[86:87], v[250:251], v[38:39] op_sel_hi:[1,0,1]
  v_pk_fma_f32 v[40:41], v[88:89], v[248:249], v[40:41] op_sel_hi:[1,0,1]
  v_pk_fma_f32 v[42:43], v[90:91], v[248:249], v[42:43] op_sel_hi:[1,0,1]
  v_pk_fma_f32 v[44:45], v[92:93], v[248:249], v[44:45] op_sel:[0,1,0]
  v_pk_fma_f32 v[46:47], v[94:95], v[248:249], v[46:47] op_sel:[0,1,0]
  v_pk_fma_f32 v[48:49], v[96:97], v[250:251], v[48:49] op_sel_hi:[1,0,1]
  v_pk_fma_f32 v[50:51], v[98:99], v[250:251], v[50:51] op_sel_hi:[1,0,1]
  v_pk_fma_f32 v[52:53], v[100:101], v[248:249], v[52:53] op_sel_hi:[1,0,1]
  v_pk_fma_f32 v[54:55], v[102:103], v[248:249], v[54:55] op_sel_hi:[1,0,1]
  v_pk_fma_f32 v[56:57], v[104:105], v[248:249], v[56:57] op_sel:[0,1,0]
  v_pk_fma_f32 v[58:59], v[106:107], v[248:249], v[58:59] op_sel:[0,1,0]
  v_pk_fma_f32 v[60:61], v[108:109], v[250:251], v[60:61] op_sel_hi:[1,0,1]
  v_pk_fma_f32 v[62:63], v[110:111], v[250:251], v[62:63] op_sel_hi:[1,0,1]
  s_waitcnt lgkmcnt(0)
  v_pk_add_f32 v[192:193], v[192:193], v[112:113]
  v_pk_add_f32 v[194:195], v[194:195], v[114:115]
  v_pk_add_f32 v[196:197], v[196:197], v[116:117]
  v_pk_add_f32 v[198:199], v[198:199], v[118:119]
  v_pk_add_f32 v[200:201], v[200:201], v[120:121]
  v_pk_add_f32 v[202:203], v[202:203], v[122:123]
  v_pk_add_f32 v[204:205], v[204:205], v[124:125]
  v_pk_add_f32 v[206:207], v[206:207], v[126:127]
  v_lshlrev_b32 v164, 16, v216
  v_and_b32 v165, 0xffff0000, v216
  v_lshlrev_b32 v166, 16, v217
  v_and_b32 v167, 0xffff0000, v217
  v_pk_fma_f32 v[164:165], v[16:17], v[192:193], v[164:165]
  v_pk_fma_f32 v[166:167], v[18:19], v[194:195], v[166:167]
  v_cvt_pk_bf16_f32 v216, v164, v165
  v_cvt_pk_bf16_f32 v217, v166, v167
  ds_write_b64 v161, v[216:217] offset:0
  v_lshlrev_b32 v168, 16, v218
  v_and_b32 v169, 0xffff0000, v218
  v_lshlrev_b32 v170, 16, v219
  v_and_b32 v171, 0xffff0000, v219
  v_pk_fma_f32 v[168:169], v[28:29], v[196:197], v[168:169]
  v_pk_fma_f32 v[170:171], v[30:31], v[198:199], v[170:171]
  v_cvt_pk_bf16_f32 v218, v168, v169
  v_cvt_pk_bf16_f32 v219, v170, v171
  ds_write_b64 v161, v[218:219] offset:32
  v_lshlrev_b32 v164, 16, v220
  v_and_b32 v165, 0xffff0000, v220
  v_lshlrev_b32 v166, 16, v221
  v_and_b32 v167, 0xffff0000, v221
  v_pk_fma_f32 v[164:165], v[40:41], v[200:201], v[164:165]
  v_pk_fma_f32 v[166:167], v[42:43], v[202:203], v[166:167]
  v_cvt_pk_bf16_f32 v220, v164, v165
  v_cvt_pk_bf16_f32 v221, v166, v167
  ds_write_b64 v161, v[220:221] offset:64
  v_lshlrev_b32 v168, 16, v222
  v_and_b32 v169, 0xffff0000, v222
  v_lshlrev_b32 v170, 16, v223
  v_and_b32 v171, 0xffff0000, v223
  v_pk_fma_f32 v[168:169], v[52:53], v[204:205], v[168:169]
  v_pk_fma_f32 v[170:171], v[54:55], v[206:207], v[170:171]
  v_cvt_pk_bf16_f32 v222, v168, v169
  v_cvt_pk_bf16_f32 v223, v170, v171
  ds_write_b64 v161, v[222:223] offset:96
  ds_read_b128 v[64:67], v160 offset:0
  ds_read_b128 v[68:71], v160 offset:288
  v_lshlrev_b32 v164, 16, v224
  v_and_b32 v165, 0xffff0000, v224
  v_lshlrev_b32 v166, 16, v225
  v_and_b32 v167, 0xffff0000, v225
  v_pk_fma_f32 v[164:165], v[20:21], v[192:193], v[164:165]
  v_pk_fma_f32 v[166:167], v[22:23], v[194:195], v[166:167]
  v_cvt_pk_bf16_f32 v224, v164, v165
  v_cvt_pk_bf16_f32 v225, v166, v167
  ds_write_b64 v161, v[224:225] offset:2304
  v_lshlrev_b32 v168, 16, v226
  v_and_b32 v169, 0xffff0000, v226
  v_lshlrev_b32 v170, 16, v227
  v_and_b32 v171, 0xffff0000, v227
  v_pk_fma_f32 v[168:169], v[32:33], v[196:197], v[168:169]
  v_pk_fma_f32 v[170:171], v[34:35], v[198:199], v[170:171]
  v_cvt_pk_bf16_f32 v226, v168, v169
  v_cvt_pk_bf16_f32 v227, v170, v171
  ds_write_b64 v161, v[226:227] offset:2336
  v_lshlrev_b32 v164, 16, v228
  v_and_b32 v165, 0xffff0000, v228
  v_lshlrev_b32 v166, 16, v229
  v_and_b32 v167, 0xffff0000, v229
  v_pk_fma_f32 v[164:165], v[44:45], v[200:201], v[164:165]
  v_pk_fma_f32 v[166:167], v[46:47], v[202:203], v[166:167]
  v_cvt_pk_bf16_f32 v228, v164, v165
  v_cvt_pk_bf16_f32 v229, v166, v167
  ds_write_b64 v161, v[228:229] offset:2368
  v_lshlrev_b32 v168, 16, v230
  v_and_b32 v169, 0xffff0000, v230
  v_lshlrev_b32 v170, 16, v231
  v_and_b32 v171, 0xffff0000, v231
  v_pk_fma_f32 v[168:169], v[56:57], v[204:205], v[168:169]
  v_pk_fma_f32 v[170:171], v[58:59], v[206:207], v[170:171]
  v_cvt_pk_bf16_f32 v230, v168, v169
  v_cvt_pk_bf16_f32 v231, v170, v171
  ds_write_b64 v161, v[230:231] offset:2400
  ds_read_b128 v[72:75], v160 offset:2304
  ds_read_b128 v[76:79], v160 offset:2592
  s_waitcnt lgkmcnt(6)
  buffer_store_dwordx4 v[64:67], v240, s[24:27], 0 offen sc1
  buffer_store_dwordx4 v[68:71], v241, s[24:27], 0 offen sc1
  v_lshlrev_b32 v164, 16, v232
  v_and_b32 v165, 0xffff0000, v232
  v_lshlrev_b32 v166, 16, v233
  v_and_b32 v167, 0xffff0000, v233
  v_pk_fma_f32 v[164:165], v[24:25], v[192:193], v[164:165]
  v_pk_fma_f32 v[166:167], v[26:27], v[194:195], v[166:167]
  v_cvt_pk_bf16_f32 v232, v164, v165
  v_cvt_pk_bf16_f32 v233, v166, v167
  ds_write_b64 v161, v[232:233] offset:4608
  v_lshlrev_b32 v168, 16, v234
  v_and_b32 v169, 0xffff0000, v234
  v_lshlrev_b32 v170, 16, v235
  v_and_b32 v171, 0xffff0000, v235
  v_pk_fma_f32 v[168:169], v[36:37], v[196:197], v[168:169]
  v_pk_fma_f32 v[170:171], v[38:39], v[198:199], v[170:171]
  v_cvt_pk_bf16_f32 v234, v168, v169
  v_cvt_pk_bf16_f32 v235, v170, v171
  ds_write_b64 v161, v[234:235] offset:4640
  v_lshlrev_b32 v164, 16, v236
  v_and_b32 v165, 0xffff0000, v236
  v_lshlrev_b32 v166, 16, v237
  v_and_b32 v167, 0xffff0000, v237
  v_pk_fma_f32 v[164:165], v[48:49], v[200:201], v[164:165]
  v_pk_fma_f32 v[166:167], v[50:51], v[202:203], v[166:167]
  v_cvt_pk_bf16_f32 v236, v164, v165
  v_cvt_pk_bf16_f32 v237, v166, v167
  ds_write_b64 v161, v[236:237] offset:4672
  v_lshlrev_b32 v168, 16, v238
  v_and_b32 v169, 0xffff0000, v238
  v_lshlrev_b32 v170, 16, v239
  v_and_b32 v171, 0xffff0000, v239
  v_pk_fma_f32 v[168:169], v[60:61], v[204:205], v[168:169]
  v_pk_fma_f32 v[170:171], v[62:63], v[206:207], v[170:171]
  v_cvt_pk_bf16_f32 v238, v168, v169
  v_cvt_pk_bf16_f32 v239, v170, v171
  ds_write_b64 v161, v[238:239] offset:4704
  ds_read_b128 v[80:83], v160 offset:4608
  ds_read_b128 v[84:87], v160 offset:4896
  s_waitcnt lgkmcnt(6)
  buffer_store_dwordx4 v[72:75], v242, s[24:27], 0 offen sc1
  buffer_store_dwordx4 v[76:79], v243, s[24:27], 0 offen sc1
  s_waitcnt lgkmcnt(0)
  buffer_store_dwordx4 v[80:83], v244, s[24:27], 0 offen sc1
  buffer_store_dwordx4 v[84:87], v245, s[24:27], 0 offen sc1
  s_branch L_fin
L_gemv:
  s_and_b32 s75, s3, 3
  s_mul_i32 s75, s75, 96
  s_add_u32 s70, s70, s75
  v_and_b32 v120, 7, v1
  v_lshrrev_b32 v121, 3, v1
  v_lshlrev_b32 v120, 4, v120
  s_mov_b32 s75, 165888
  v_mad_u32_u24 v120, v121, s75, v120
  v_add_u32 v120, s67, v120
  v_mul_u32_u24 v122, 24, v121
L_gemv1:
  s_cmp_eq_u32 s71, 1
  s_cselect_b32 s16, s52, s50
  s_cselect_b32 s17, s53, s51
  s_mov_b32 s18, 15925248
  s_mov_b32 s19, 0x20000
  s_add_u32 s20, s40, 0
  s_addc_u32 s21, s41, 0
  s_mov_b32 s22, 4608
  s_mov_b32 s23, 0x20000
  s_lshl_b32 s75, s70, 1
  buffer_load_dwordx2 v[204:205], v122, s[20:23], s75 offen offset:0
  buffer_load_dwordx2 v[206:207], v122, s[20:23], s75 offen offset:8
  buffer_load_dwordx2 v[208:209], v122, s[20:23], s75 offen offset:16
  buffer_load_dwordx2 v[210:211], v122, s[20:23], s75 offen offset:2304
  buffer_load_dwordx2 v[212:213], v122, s[20:23], s75 offen offset:2312
  buffer_load_dwordx2 v[214:215], v122, s[20:23], s75 offen offset:2320
  s_mul_i32 s81, s70, 13824
  buffer_load_dwordx4 v[32:35], v120, s[16:19], s81 offen nt
  s_add_u32 s81, s81, 13824
  buffer_load_dwordx4 v[36:39], v120, s[16:19], s81 offen nt
  s_add_u32 s81, s81, 13824
  buffer_load_dwordx4 v[40:43], v120, s[16:19], s81 offen nt
  s_add_u32 s81, s81, 13824
  buffer_load_dwordx4 v[44:47], v120, s[16:19], s81 offen nt
  s_add_u32 s81, s81, 13824
  buffer_load_dwordx4 v[48:51], v120, s[16:19], s81 offen nt
  s_add_u32 s81, s81, 13824
  buffer_load_dwordx4 v[52:55], v120, s[16:19], s81 offen nt
  s_add_u32 s81, s81, 13824
  buffer_load_dwordx4 v[56:59], v120, s[16:19], s81 offen nt
  s_add_u32 s81, s81, 13824
  buffer_load_dwordx4 v[60:63], v120, s[16:19], s81 offen nt
  s_add_u32 s81, s81, 13824
  buffer_load_dwordx4 v[64:67], v120, s[16:19], s81 offen nt
  s_add_u32 s81, s81, 13824
  buffer_load_dwordx4 v[68:71], v120, s[16:19], s81 offen nt
  s_add_u32 s81, s81, 13824
  buffer_load_dwordx4 v[72:75], v120, s[16:19], s81 offen nt
  s_add_u32 s81, s81, 13824
  buffer_load_dwordx4 v[76:79], v120, s[16:19], s81 offen nt
L_gemv2:
  v_mov_b32 v104, 0
  v_mov_b32 v105, 0
  v_mov_b32 v106, 0
  v_mov_b32 v107, 0
  v_mov_b32 v108, 0
  v_mov_b32 v109, 0
  v_mov_b32 v110, 0
  v_mov_b32 v111, 0
  v_mov_b32 v112, 0
  v_mov_b32 v113, 0
  v_mov_b32 v114, 0
  v_mov_b32 v115, 0
  v_mov_b32 v116, 0
  v_mov_b32 v117, 0
  v_mov_b32 v118, 0
  v_mov_b32 v119, 0
  s_waitcnt vmcnt(12)
  s_cmp_lg_u32 s66, 3
  s_cbranch_scc1 L_gv_l
  s_add_u32 s70, s70, 384
  s_lshl_b32 s75, s70, 1
  buffer_load_dwordx2 v[188:189], v122, s[20:23], s75 offen offset:0
  buffer_load_dwordx2 v[190:191], v122, s[20:23], s75 offen offset:8
  buffer_load_dwordx2 v[192:193], v122, s[20:23], s75 offen offset:16
  buffer_load_dwordx2 v[194:195], v122, s[20:23], s75 offen offset:2304
  buffer_load_dwordx2 v[196:197], v122, s[20:23], s75 offen offset:2312
  buffer_load_dwordx2 v[198:199], v122, s[20:23], s75 offen offset:2320
  s_mul_i32 s81, s70, 13824
  buffer_load_dwordx4 v[140:143], v120, s[16:19], s81 offen nt
  s_add_u32 s81, s81, 13824
  buffer_load_dwordx4 v[144:147], v120, s[16:19], s81 offen nt
  s_add_u32 s81, s81, 13824
  buffer_load_dwordx4 v[148:151], v120, s[16:19], s81 offen nt
  s_add_u32 s81, s81, 13824
  buffer_load_dwordx4 v[152:155], v120, s[16:19], s81 offen nt
  s_add_u32 s81, s81, 13824
  buffer_load_dwordx4 v[156:159], v120, s[16:19], s81 offen nt
  s_add_u32 s81, s81, 13824
  buffer_load_dwordx4 v[160:163], v120, s[16:19], s81 offen nt
  s_add_u32 s81, s81, 13824
  buffer_load_dwordx4 v[164:167], v120, s[16:19], s81 offen nt
  s_add_u32 s81, s81, 13824
  buffer_load_dwordx4 v[168:171], v120, s[16:19], s81 offen nt
  s_add_u32 s81, s81, 13824
  buffer_load_dwordx4 v[172:175], v120, s[16:19], s81 offen nt
  s_add_u32 s81, s81, 13824
  buffer_load_dwordx4 v[176:179], v120, s[16:19], s81 offen nt
  s_add_u32 s81, s81, 13824
  buffer_load_dwordx4 v[180:183], v120, s[16:19], s81 offen nt
  s_add_u32 s81, s81, 13824
  buffer_load_dwordx4 v[184:187], v120, s[16:19], s81 offen nt
  s_waitcnt vmcnt(18)
L_gv_l:
  s_cmp_lg_u32 s66, 3
  v_lshlrev_b32 v80, 16, v204
  v_lshlrev_b32 v81, 16, v210
  v_and_b32 v82, 0xffff0000, v204
  v_and_b32 v83, 0xffff0000, v210
  v_lshlrev_b32 v84, 16, v205
  v_lshlrev_b32 v85, 16, v211
  v_and_b32 v86, 0xffff0000, v205
  v_and_b32 v87, 0xffff0000, v211
  v_lshlrev_b32 v88, 16, v206
  v_lshlrev_b32 v89, 16, v212
  v_and_b32 v90, 0xffff0000, v206
  v_and_b32 v91, 0xffff0000, v212
  v_lshlrev_b32 v92, 16, v207
  v_lshlrev_b32 v93, 16, v213
  v_and_b32 v94, 0xffff0000, v207
  v_and_b32 v95, 0xffff0000, v213
  v_lshlrev_b32 v96, 16, v208
  v_lshlrev_b32 v97, 16, v214
  v_and_b32 v98, 0xffff0000, v208
  v_and_b32 v99, 0xffff0000, v214
  v_lshlrev_b32 v100, 16, v209
  v_lshlrev_b32 v101, 16, v215
  v_and_b32 v102, 0xffff0000, v209
  v_and_b32 v103, 0xffff0000, v215
  v_mul_f32 v216, 0xbfb8aa3b, v80
  v_mul_f32 v217, 0xbfb8aa3b, v81
  v_mul_f32 v218, 0xbfb8aa3b, v82
  v_mul_f32 v219, 0xbfb8aa3b, v83
  v_mul_f32 v220, 0xbfb8aa3b, v84
  v_mul_f32 v221, 0xbfb8aa3b, v85
  v_mul_f32 v222, 0xbfb8aa3b, v86
  v_mul_f32 v223, 0xbfb8aa3b, v87
  v_mul_f32 v224, 0xbfb8aa3b, v88
  v_mul_f32 v225, 0xbfb8aa3b, v89
  v_mul_f32 v226, 0xbfb8aa3b, v90
  v_mul_f32 v227, 0xbfb8aa3b, v91
  v_mul_f32 v228, 0xbfb8aa3b, v92
  v_mul_f32 v229, 0xbfb8aa3b, v93
  v_mul_f32 v230, 0xbfb8aa3b, v94
  v_mul_f32 v231, 0xbfb8aa3b, v95
  v_mul_f32 v232, 0xbfb8aa3b, v96
  v_mul_f32 v233, 0xbfb8aa3b, v97
  v_mul_f32 v234, 0xbfb8aa3b, v98
  v_mul_f32 v235, 0xbfb8aa3b, v99
  v_mul_f32 v236, 0xbfb8aa3b, v100
  v_mul_f32 v237, 0xbfb8aa3b, v101
  v_mul_f32 v238, 0xbfb8aa3b, v102
  v_mul_f32 v239, 0xbfb8aa3b, v103
  v_exp_f32 v216, v216
  v_exp_f32 v217, v217
  v_exp_f32 v218, v218
  v_exp_f32 v219, v219
  v_exp_f32 v220, v220
  v_exp_f32 v221, v221
  v_exp_f32 v222, v222
  v_exp_f32 v223, v223
  v_exp_f32 v224, v224
  v_exp_f32 v225, v225
  v_exp_f32 v226, v226
  v_exp_f32 v227, v227
  v_exp_f32 v228, v228
  v_exp_f32 v229, v229
  v_exp_f32 v230, v230
  v_exp_f32 v231, v231
  v_exp_f32 v232, v232
  v_exp_f32 v233, v233
  v_exp_f32 v234, v234
  v_exp_f32 v235, v235
  v_exp_f32 v236, v236
  v_exp_f32 v237, v237
  v_exp_f32 v238, v238
  v_exp_f32 v239, v239
  v_add_f32 v216, 1.0, v216
  v_add_f32 v217, 1.0, v217
  v_add_f32 v218, 1.0, v218
  v_add_f32 v219, 1.0, v219
  v_add_f32 v220, 1.0, v220
  v_add_f32 v221, 1.0, v221
  v_add_f32 v222, 1.0, v222
  v_add_f32 v223, 1.0, v223
  v_add_f32 v224, 1.0, v224
  v_add_f32 v225, 1.0, v225
  v_add_f32 v226, 1.0, v226
  v_add_f32 v227, 1.0, v227
  v_add_f32 v228, 1.0, v228
  v_add_f32 v229, 1.0, v229
  v_add_f32 v230, 1.0, v230
  v_add_f32 v231, 1.0, v231
  v_add_f32 v232, 1.0, v232
  v_add_f32 v233, 1.0, v233
  v_add_f32 v234, 1.0, v234
  v_add_f32 v235, 1.0, v235
  v_add_f32 v236, 1.0, v236
  v_add_f32 v237, 1.0, v237
  v_add_f32 v238, 1.0, v238
  v_add_f32 v239, 1.0, v239
  v_rcp_f32 v216, v216
  v_rcp_f32 v217, v217
  v_rcp_f32 v218, v218
  v_rcp_f32 v219, v219
  v_rcp_f32 v220, v220
  v_rcp_f32 v221, v221
  v_rcp_f32 v222, v222
  v_rcp_f32 v223, v223
  v_rcp_f32 v224, v224
  v_rcp_f32 v225, v225
  v_rcp_f32 v226, v226
  v_rcp_f32 v227, v227
  v_rcp_f32 v228, v228
  v_rcp_f32 v229, v229
  v_rcp_f32 v230, v230
  v_rcp_f32 v231, v231
  v_rcp_f32 v232, v232
  v_rcp_f32 v233, v233
  v_rcp_f32 v234, v234
  v_rcp_f32 v235, v235
  v_rcp_f32 v236, v236
  v_rcp_f32 v237, v237
  v_rcp_f32 v238, v238
  v_rcp_f32 v239, v239
  v_mul_f32 v80, v80, v216
  v_mul_f32 v81, v81, v217
  v_mul_f32 v82, v82, v218
  v_mul_f32 v83, v83, v219
  v_mul_f32 v84, v84, v220
  v_mul_f32 v85, v85, v221
  v_mul_f32 v86, v86, v222
  v_mul_f32 v87, v87, v223
  v_mul_f32 v88, v88, v224
  v_mul_f32 v89, v89, v225
  v_mul_f32 v90, v90, v226
  v_mul_f32 v91, v91, v227
  v_mul_f32 v92, v92, v228
  v_mul_f32 v93, v93, v229
  v_mul_f32 v94, v94, v230
  v_mul_f32 v95, v95, v231
  v_mul_f32 v96, v96, v232
  v_mul_f32 v97, v97, v233
  v_mul_f32 v98, v98, v234
  v_mul_f32 v99, v99, v235
  v_mul_f32 v100, v100, v236
  v_mul_f32 v101, v101, v237
  v_mul_f32 v102, v102, v238
  v_mul_f32 v103, v103, v239
  s_cbranch_scc0 L_gv_w0
  s_waitcnt vmcnt(11)
L_gv_w0:
  v_lshlrev_b32 v128, 16, v32
  v_and_b32 v129, 0xffff0000, v32
  v_lshlrev_b32 v130, 16, v33
  v_and_b32 v131, 0xffff0000, v33
  v_lshlrev_b32 v132, 16, v34
  v_and_b32 v133, 0xffff0000, v34
  v_lshlrev_b32 v134, 16, v35
  v_and_b32 v135, 0xffff0000, v35
  v_pk_fma_f32 v[104:105], v[128:129], v[80:81], v[104:105] op_sel_hi:[0,1,1]
  v_pk_fma_f32 v[106:107], v[128:129], v[80:81], v[106:107] op_sel:[1,0,0]
  v_pk_fma_f32 v[108:109], v[130:131], v[80:81], v[108:109] op_sel_hi:[0,1,1]
  v_pk_fma_f32 v[110:111], v[130:131], v[80:81], v[110:111] op_sel:[1,0,0]
  v_pk_fma_f32 v[112:113], v[132:133], v[80:81], v[112:113] op_sel_hi:[0,1,1]
  v_pk_fma_f32 v[114:115], v[132:133], v[80:81], v[114:115] op_sel:[1,0,0]
  v_pk_fma_f32 v[116:117], v[134:135], v[80:81], v[116:117] op_sel_hi:[0,1,1]
  v_pk_fma_f32 v[118:119], v[134:135], v[80:81], v[118:119] op_sel:[1,0,0]
  s_cbranch_scc0 L_gv_w1
  s_waitcnt vmcnt(10)
L_gv_w1:
  v_lshlrev_b32 v128, 16, v36
  v_and_b32 v129, 0xffff0000, v36
  v_lshlrev_b32 v130, 16, v37
  v_and_b32 v131, 0xffff0000, v37
  v_lshlrev_b32 v132, 16, v38
  v_and_b32 v133, 0xffff0000, v38
  v_lshlrev_b32 v134, 16, v39
  v_and_b32 v135, 0xffff0000, v39
  v_pk_fma_f32 v[104:105], v[128:129], v[82:83], v[104:105] op_sel_hi:[0,1,1]
  v_pk_fma_f32 v[106:107], v[128:129], v[82:83], v[106:107] op_sel:[1,0,0]
  v_pk_fma_f32 v[108:109], v[130:131], v[82:83], v[108:109] op_sel_hi:[0,1,1]
  v_pk_fma_f32 v[110:111], v[130:131], v[82:83], v[110:111] op_sel:[1,0,0]
  v_pk_fma_f32 v[112:113], v[132:133], v[82:83], v[112:113] op_sel_hi:[0,1,1]
  v_pk_fma_f32 v[114:115], v[132:133], v[82:83], v[114:115] op_sel:[1,0,0]
  v_pk_fma_f32 v[116:117], v[134:135], v[82:83], v[116:117] op_sel_hi:[0,1,1]
  v_pk_fma_f32 v[118:119], v[134:135], v[82:83], v[118:119] op_sel:[1,0,0]
  s_cbranch_scc0 L_gv_w2
  s_waitcnt vmcnt(9)
L_gv_w2:
  v_lshlrev_b32 v128, 16, v40
  v_and_b32 v129, 0xffff0000, v40
  v_lshlrev_b32 v130, 16, v41
  v_and_b32 v131, 0xffff0000, v41
  v_lshlrev_b32 v132, 16, v42
  v_and_b32 v133, 0xffff0000, v42
  v_lshlrev_b32 v134, 16, v43
  v_and_b32 v135, 0xffff0000, v43
  v_pk_fma_f32 v[104:105], v[128:129], v[84:85], v[104:105] op_sel_hi:[0,1,1]
  v_pk_fma_f32 v[106:107], v[128:129], v[84:85], v[106:107] op_sel:[1,0,0]
  v_pk_fma_f32 v[108:109], v[130:131], v[84:85], v[108:109] op_sel_hi:[0,1,1]
  v_pk_fma_f32 v[110:111], v[130:131], v[84:85], v[110:111] op_sel:[1,0,0]
  v_pk_fma_f32 v[112:113], v[132:133], v[84:85], v[112:113] op_sel_hi:[0,1,1]
  v_pk_fma_f32 v[114:115], v[132:133], v[84:85], v[114:115] op_sel:[1,0,0]
  v_pk_fma_f32 v[116:117], v[134:135], v[84:85], v[116:117] op_sel_hi:[0,1,1]
  v_pk_fma_f32 v[118:119], v[134:135], v[84:85], v[118:119] op_sel:[1,0,0]
  s_cbranch_scc0 L_gv_w3
  s_waitcnt vmcnt(8)
L_gv_w3:
  v_lshlrev_b32 v128, 16, v44
  v_and_b32 v129, 0xffff0000, v44
  v_lshlrev_b32 v130, 16, v45
  v_and_b32 v131, 0xffff0000, v45
  v_lshlrev_b32 v132, 16, v46
  v_and_b32 v133, 0xffff0000, v46
  v_lshlrev_b32 v134, 16, v47
  v_and_b32 v135, 0xffff0000, v47
  v_pk_fma_f32 v[104:105], v[128:129], v[86:87], v[104:105] op_sel_hi:[0,1,1]
  v_pk_fma_f32 v[106:107], v[128:129], v[86:87], v[106:107] op_sel:[1,0,0]
  v_pk_fma_f32 v[108:109], v[130:131], v[86:87], v[108:109] op_sel_hi:[0,1,1]
  v_pk_fma_f32 v[110:111], v[130:131], v[86:87], v[110:111] op_sel:[1,0,0]
  v_pk_fma_f32 v[112:113], v[132:133], v[86:87], v[112:113] op_sel_hi:[0,1,1]
  v_pk_fma_f32 v[114:115], v[132:133], v[86:87], v[114:115] op_sel:[1,0,0]
  v_pk_fma_f32 v[116:117], v[134:135], v[86:87], v[116:117] op_sel_hi:[0,1,1]
  v_pk_fma_f32 v[118:119], v[134:135], v[86:87], v[118:119] op_sel:[1,0,0]
  s_cbranch_scc0 L_gv_w4
  s_waitcnt vmcnt(7)
L_gv_w4:
  v_lshlrev_b32 v128, 16, v48
  v_and_b32 v129, 0xffff0000, v48
  v_lshlrev_b32 v130, 16, v49
  v_and_b32 v131, 0xffff0000, v49
  v_lshlrev_b32 v132, 16, v50
  v_and_b32 v133, 0xffff0000, v50
  v_lshlrev_b32 v134, 16, v51
  v_and_b32 v135, 0xffff0000, v51
  v_pk_fma_f32 v[104:105], v[128:129], v[88:89], v[104:105] op_sel_hi:[0,1,1]
  v_pk_fma_f32 v[106:107], v[128:129], v[88:89], v[106:107] op_sel:[1,0,0]
  v_pk_fma_f32 v[108:109], v[130:131], v[88:89], v[108:109] op_sel_hi:[0,1,1]
  v_pk_fma_f32 v[110:111], v[130:131], v[88:89], v[110:111] op_sel:[1,0,0]
  v_pk_fma_f32 v[112:113], v[132:133], v[88:89], v[112:113] op_sel_hi:[0,1,1]
  v_pk_fma_f32 v[114:115], v[132:133], v[88:89], v[114:115] op_sel:[1,0,0]
  v_pk_fma_f32 v[116:117], v[134:135], v[88:89], v[116:117] op_sel_hi:[0,1,1]
  v_pk_fma_f32 v[118:119], v[134:135], v[88:89], v[118:119] op_sel:[1,0,0]
  s_cbranch_scc0 L_gv_w5
  s_waitcnt vmcnt(6)
L_gv_w5:
  v_lshlrev_b32 v128, 16, v52
  v_and_b32 v129, 0xffff0000, v52
  v_lshlrev_b32 v130, 16, v53
  v_and_b32 v131, 0xffff0000, v53
  v_lshlrev_b32 v132, 16, v54
  v_and_b32 v133, 0xffff0000, v54
  v_lshlrev_b32 v134, 16, v55
  v_and_b32 v135, 0xffff0000, v55
  v_pk_fma_f32 v[104:105], v[128:129], v[90:91], v[104:105] op_sel_hi:[0,1,1]
  v_pk_fma_f32 v[106:107], v[128:129], v[90:91], v[106:107] op_sel:[1,0,0]
  v_pk_fma_f32 v[108:109], v[130:131], v[90:91], v[108:109] op_sel_hi:[0,1,1]
  v_pk_fma_f32 v[110:111], v[130:131], v[90:91], v[110:111] op_sel:[1,0,0]
  v_pk_fma_f32 v[112:113], v[132:133], v[90:91], v[112:113] op_sel_hi:[0,1,1]
  v_pk_fma_f32 v[114:115], v[132:133], v[90:91], v[114:115] op_sel:[1,0,0]
  v_pk_fma_f32 v[116:117], v[134:135], v[90:91], v[116:117] op_sel_hi:[0,1,1]
  v_pk_fma_f32 v[118:119], v[134:135], v[90:91], v[118:119] op_sel:[1,0,0]
  s_cbranch_scc0 L_gv_w6
  s_waitcnt vmcnt(5)
L_gv_w6:
  v_lshlrev_b32 v128, 16, v56
  v_and_b32 v129, 0xffff0000, v56
  v_lshlrev_b32 v130, 16, v57
  v_and_b32 v131, 0xffff0000, v57
  v_lshlrev_b32 v132, 16, v58
  v_and_b32 v133, 0xffff0000, v58
  v_lshlrev_b32 v134, 16, v59
  v_and_b32 v135, 0xffff0000, v59
  v_pk_fma_f32 v[104:105], v[128:129], v[92:93], v[104:105] op_sel_hi:[0,1,1]
  v_pk_fma_f32 v[106:107], v[128:129], v[92:93], v[106:107] op_sel:[1,0,0]
  v_pk_fma_f32 v[108:109], v[130:131], v[92:93], v[108:109] op_sel_hi:[0,1,1]
  v_pk_fma_f32 v[110:111], v[130:131], v[92:93], v[110:111] op_sel:[1,0,0]
  v_pk_fma_f32 v[112:113], v[132:133], v[92:93], v[112:113] op_sel_hi:[0,1,1]
  v_pk_fma_f32 v[114:115], v[132:133], v[92:93], v[114:115] op_sel:[1,0,0]
  v_pk_fma_f32 v[116:117], v[134:135], v[92:93], v[116:117] op_sel_hi:[0,1,1]
  v_pk_fma_f32 v[118:119], v[134:135], v[92:93], v[118:119] op_sel:[1,0,0]
  s_cbranch_scc0 L_gv_w7
  s_waitcnt vmcnt(4)
L_gv_w7:
  v_lshlrev_b32 v128, 16, v60
  v_and_b32 v129, 0xffff0000, v60
  v_lshlrev_b32 v130, 16, v61
  v_and_b32 v131, 0xffff0000, v61
  v_lshlrev_b32 v132, 16, v62
  v_and_b32 v133, 0xffff0000, v62
  v_lshlrev_b32 v134, 16, v63
  v_and_b32 v135, 0xffff0000, v63
  v_pk_fma_f32 v[104:105], v[128:129], v[94:95], v[104:105] op_sel_hi:[0,1,1]
  v_pk_fma_f32 v[106:107], v[128:129], v[94:95], v[106:107] op_sel:[1,0,0]
  v_pk_fma_f32 v[108:109], v[130:131], v[94:95], v[108:109] op_sel_hi:[0,1,1]
  v_pk_fma_f32 v[110:111], v[130:131], v[94:95], v[110:111] op_sel:[1,0,0]
  v_pk_fma_f32 v[112:113], v[132:133], v[94:95], v[112:113] op_sel_hi:[0,1,1]
  v_pk_fma_f32 v[114:115], v[132:133], v[94:95], v[114:115] op_sel:[1,0,0]
  v_pk_fma_f32 v[116:117], v[134:135], v[94:95], v[116:117] op_sel_hi:[0,1,1]
  v_pk_fma_f32 v[118:119], v[134:135], v[94:95], v[118:119] op_sel:[1,0,0]
  s_cbranch_scc0 L_gv_w8
  s_waitcnt vmcnt(3)
L_gv_w8:
  v_lshlrev_b32 v128, 16, v64
  v_and_b32 v129, 0xffff0000, v64
  v_lshlrev_b32 v130, 16, v65
  v_and_b32 v131, 0xffff0000, v65
  v_lshlrev_b32 v132, 16, v66
  v_and_b32 v133, 0xffff0000, v66
  v_lshlrev_b32 v134, 16, v67
  v_and_b32 v135, 0xffff0000, v67
  v_pk_fma_f32 v[104:105], v[128:129], v[96:97], v[104:105] op_sel_hi:[0,1,1]
  v_pk_fma_f32 v[106:107], v[128:129], v[96:97], v[106:107] op_sel:[1,0,0]
  v_pk_fma_f32 v[108:109], v[130:131], v[96:97], v[108:109] op_sel_hi:[0,1,1]
  v_pk_fma_f32 v[110:111], v[130:131], v[96:97], v[110:111] op_sel:[1,0,0]
  v_pk_fma_f32 v[112:113], v[132:133], v[96:97], v[112:113] op_sel_hi:[0,1,1]
  v_pk_fma_f32 v[114:115], v[132:133], v[96:97], v[114:115] op_sel:[1,0,0]
  v_pk_fma_f32 v[116:117], v[134:135], v[96:97], v[116:117] op_sel_hi:[0,1,1]
  v_pk_fma_f32 v[118:119], v[134:135], v[96:97], v[118:119] op_sel:[1,0,0]
  s_cbranch_scc0 L_gv_w9
  s_waitcnt vmcnt(2)
L_gv_w9:
  v_lshlrev_b32 v128, 16, v68
  v_and_b32 v129, 0xffff0000, v68
  v_lshlrev_b32 v130, 16, v69
  v_and_b32 v131, 0xffff0000, v69
  v_lshlrev_b32 v132, 16, v70
  v_and_b32 v133, 0xffff0000, v70
  v_lshlrev_b32 v134, 16, v71
  v_and_b32 v135, 0xffff0000, v71
  v_pk_fma_f32 v[104:105], v[128:129], v[98:99], v[104:105] op_sel_hi:[0,1,1]
  v_pk_fma_f32 v[106:107], v[128:129], v[98:99], v[106:107] op_sel:[1,0,0]
  v_pk_fma_f32 v[108:109], v[130:131], v[98:99], v[108:109] op_sel_hi:[0,1,1]
  v_pk_fma_f32 v[110:111], v[130:131], v[98:99], v[110:111] op_sel:[1,0,0]
  v_pk_fma_f32 v[112:113], v[132:133], v[98:99], v[112:113] op_sel_hi:[0,1,1]
  v_pk_fma_f32 v[114:115], v[132:133], v[98:99], v[114:115] op_sel:[1,0,0]
  v_pk_fma_f32 v[116:117], v[134:135], v[98:99], v[116:117] op_sel_hi:[0,1,1]
  v_pk_fma_f32 v[118:119], v[134:135], v[98:99], v[118:119] op_sel:[1,0,0]
  s_cbranch_scc0 L_gv_w10
  s_waitcnt vmcnt(1)
L_gv_w10:
  v_lshlrev_b32 v128, 16, v72
  v_and_b32 v129, 0xffff0000, v72
  v_lshlrev_b32 v130, 16, v73
  v_and_b32 v131, 0xffff0000, v73
  v_lshlrev_b32 v132, 16, v74
  v_and_b32 v133, 0xffff0000, v74
  v_lshlrev_b32 v134, 16, v75
  v_and_b32 v135, 0xffff0000, v75
  v_pk_fma_f32 v[104:105], v[128:129], v[100:101], v[104:105] op_sel_hi:[0,1,1]
  v_pk_fma_f32 v[106:107], v[128:129], v[100:101], v[106:107] op_sel:[1,0,0]
  v_pk_fma_f32 v[108:109], v[130:131], v[100:101], v[108:109] op_sel_hi:[0,1,1]
  v_pk_fma_f32 v[110:111], v[130:131], v[100:101], v[110:111] op_sel:[1,0,0]
  v_pk_fma_f32 v[112:113], v[132:133], v[100:101], v[112:113] op_sel_hi:[0,1,1]
  v_pk_fma_f32 v[114:115], v[132:133], v[100:101], v[114:115] op_sel:[1,0,0]
  v_pk_fma_f32 v[116:117], v[134:135], v[100:101], v[116:117] op_sel_hi:[0,1,1]
  v_pk_fma_f32 v[118:119], v[134:135], v[100:101], v[118:119] op_sel:[1,0,0]
  s_cbranch_scc0 L_gv_w11
  s_waitcnt vmcnt(0)
L_gv_w11:
  v_lshlrev_b32 v128, 16, v76
  v_and_b32 v129, 0xffff0000, v76
  v_lshlrev_b32 v130, 16, v77
  v_and_b32 v131, 0xffff0000, v77
  v_lshlrev_b32 v132, 16, v78
  v_and_b32 v133, 0xffff0000, v78
  v_lshlrev_b32 v134, 16, v79
  v_and_b32 v135, 0xffff0000, v79
  v_pk_fma_f32 v[104:105], v[128:129], v[102:103], v[104:105] op_sel_hi:[0,1,1]
  v_pk_fma_f32 v[106:107], v[128:129], v[102:103], v[106:107] op_sel:[1,0,0]
  v_pk_fma_f32 v[108:109], v[130:131], v[102:103], v[108:109] op_sel_hi:[0,1,1]
  v_pk_fma_f32 v[110:111], v[130:131], v[102:103], v[110:111] op_sel:[1,0,0]
  v_pk_fma_f32 v[112:113], v[132:133], v[102:103], v[112:113] op_sel_hi:[0,1,1]
  v_pk_fma_f32 v[114:115], v[132:133], v[102:103], v[114:115] op_sel:[1,0,0]
  v_pk_fma_f32 v[116:117], v[134:135], v[102:103], v[116:117] op_sel_hi:[0,1,1]
  v_pk_fma_f32 v[118:119], v[134:135], v[102:103], v[118:119] op_sel:[1,0,0]
  s_cbranch_scc1 L_gv_done
  s_mov_b32 s66, 1
  s_waitcnt vmcnt(0)
  v_mov_b32 v32, v140
  v_mov_b32 v33, v141
  v_mov_b32 v34, v142
  v_mov_b32 v35, v143
  v_mov_b32 v36, v144
  v_mov_b32 v37, v145
  v_mov_b32 v38, v146
  v_mov_b32 v39, v147
  v_mov_b32 v40, v148
  v_mov_b32 v41, v149
  v_mov_b32 v42, v150
  v_mov_b32 v43, v151
  v_mov_b32 v44, v152
  v_mov_b32 v45, v153
  v_mov_b32 v46, v154
  v_mov_b32 v47, v155
  v_mov_b32 v48, v156
  v_mov_b32 v49, v157
  v_mov_b32 v50, v158
  v_mov_b32 v51, v159
  v_mov_b32 v52, v160
  v_mov_b32 v53, v161
  v_mov_b32 v54, v162
  v_mov_b32 v55, v163
  v_mov_b32 v56, v164
  v_mov_b32 v57, v165
  v_mov_b32 v58, v166
  v_mov_b32 v59, v167
  v_mov_b32 v60, v168
  v_mov_b32 v61, v169
  v_mov_b32 v62, v170
  v_mov_b32 v63, v171
  v_mov_b32 v64, v172
  v_mov_b32 v65, v173
  v_mov_b32 v66, v174
  v_mov_b32 v67, v175
  v_mov_b32 v68, v176
  v_mov_b32 v69, v177
  v_mov_b32 v70, v178
  v_mov_b32 v71, v179
  v_mov_b32 v72, v180
  v_mov_b32 v73, v181
  v_mov_b32 v74, v182
  v_mov_b32 v75, v183
  v_mov_b32 v76, v184
  v_mov_b32 v77, v185
  v_mov_b32 v78, v186
  v_mov_b32 v79, v187
  v_mov_b32 v204, v188
  v_mov_b32 v205, v189
  v_mov_b32 v206, v190
  v_mov_b32 v207, v191
  v_mov_b32 v208, v192
  v_mov_b32 v209, v193
  v_mov_b32 v210, v194
  v_mov_b32 v211, v195
  v_mov_b32 v212, v196
  v_mov_b32 v213, v197
  v_mov_b32 v214, v198
  v_mov_b32 v215, v199
  s_branch L_gv_l
L_gv_done:
  v_permlane32_swap_b32 v104, v112
  v_permlane32_swap_b32 v105, v113
  v_permlane32_swap_b32 v106, v114
  v_permlane32_swap_b32 v107, v115
  v_permlane32_swap_b32 v108, v116
  v_permlane32_swap_b32 v109, v117
  v_permlane32_swap_b32 v110, v118
  v_permlane32_swap_b32 v111, v119
  v_add_f32 v104, v104, v112
  v_add_f32 v105, v105, v113
  v_add_f32 v106, v106, v114
  v_add_f32 v107, v107, v115
  v_add_f32 v108, v108, v116
  v_add_f32 v109, v109, v117
  v_add_f32 v110, v110, v118
  v_add_f32 v111, v111, v119
  s_nop 1
  v_permlane16_swap_b32 v104, v108
  v_permlane16_swap_b32 v105, v109
  v_permlane16_swap_b32 v106, v110
  v_permlane16_swap_b32 v107, v111
  v_add_f32 v104, v104, v108
  v_add_f32 v105, v105, v109
  v_add_f32 v106, v106, v110
  v_add_f32 v107, v107, v111
  s_nop 1
  v_add_f32_dpp v108, v104, v104 row_ror:8 row_mask:0xf bank_mask:0xf
  v_add_f32_dpp v109, v105, v105 row_ror:8 row_mask:0xf bank_mask:0xf
  v_add_f32_dpp v110, v106, v106 row_ror:8 row_mask:0xf bank_mask:0xf
  v_add_f32_dpp v111, v107, v107 row_ror:8 row_mask:0xf bank_mask:0xf
  s_and_b32 s81, s3, 3
  s_lshl_b32 s81, s81, 9
  s_add_u32 s81, s81, s79
  v_and_b32 v120, 7, v1
  v_lshlrev_b32 v120, 6, v120
  v_lshrrev_b32 v121, 4, v1
  v_lshl_add_u32 v120, v121, 4, v120
  v_add_u32 v120, s81, v120
  v_mov_b32 v124, s80
  v_mov_b32 v125, 1
  v_mov_b32 v126, 0
  ds_write_b128 v120, v[108:111]
  s_mov_b64 exec, 1
  ds_add_u32 v124, v125
  s_mov_b64 exec, -1
  s_and_b32 s75, s3, 3
  s_cmp_lg_u32 s75, 3
  s_cbranch_scc1 L_gv_ret
  s_mov_b32 s74, 16777216
L_lw_10001:
  ds_read_b32 v120, v124
  s_waitcnt lgkmcnt(0)
  v_cmp_le_u32 vcc, s77, v120
  s_cbranch_vccnz L_lw_10001_d
  s_sleep 1
  s_sub_u32 s74, s74, 1
  s_cmp_lg_u32 s74, 0
  s_cbranch_scc1 L_lw_10001
L_lw_10001_d:
  v_lshl_add_u32 v120, v1, 3, s79
  ds_read_b64 v[104:105], v120 offset:0
  ds_read_b64 v[106:107], v120 offset:512
  ds_read_b64 v[108:109], v120 offset:1024
  ds_read_b64 v[110:111], v120 offset:1536
  v_lshlrev_b32 v120, 2, v1
  s_add_u32 s78, s78, s76
  s_waitcnt lgkmcnt(0)
  v_pk_add_f32 v[104:105], v[104:105], v[106:107]
  v_pk_add_f32 v[108:109], v[108:109], v[110:111]
  v_pk_add_f32 v[104:105], v[104:105], v[108:109]
  s_and_b32 s75, s11, 255
  s_cmp_eq_u32 s6, -1
  s_cselect_b32 s75, s75, 0
  v_mov_b32 v125, s11
  v_and_b32 v104, 0xffffff00, v104
  v_or_b32 v104, s75, v104
  v_and_b32 v105, 0xffffff00, v105
  v_or_b32 v105, s75, v105
  buffer_store_dword v104, v120, s[12:15], s76 offen sc1
  buffer_store_dword v105, v120, s[12:15], s78 offen sc1
  s_cmp_eq_u32 s6, -1
  s_cbranch_scc1 L_gv_ret
  s_waitcnt vmcnt(0)
  s_mov_b64 exec, 15
  buffer_store_dword v125, v120, s[12:15], s6 offen sc1
  s_mov_b64 exec, -1
L_gv_ret:
  s_setpc_b64 s[86:87]
L_tk:
  v_add_u32 v2, v3, v4
  ds_read_b64_tr_b16 v[160:161], v2 offset:0
  ds_read_b64_tr_b16 v[162:163], v2 offset:1040
  ds_read_b128 v[192:195], v3 offset:0
  ds_read_b128 v[196:199], v3 offset:2080
  ds_read_b128 v[200:203], v3 offset:4160
  ds_read_b64_tr_b16 v[164:165], v2 offset:32
  ds_read_b64_tr_b16 v[166:167], v2 offset:1072
  ds_read_b64_tr_b16 v[168:169], v2 offset:256
  ds_read_b64_tr_b16 v[170:171], v2 offset:1296
  ds_read_b64_tr_b16 v[172:173], v2 offset:288
  ds_read_b64_tr_b16 v[174:175], v2 offset:1328
  v_mov_b32 v64, 0
  v_mov_b32 v65, 0
  v_mov_b32 v66, 0
  v_mov_b32 v67, 0
  v_mov_b32 v68, 0
  v_mov_b32 v69, 0
  v_mov_b32 v70, 0
  v_mov_b32 v71, 0
  v_mov_b32 v72, 0
  v_mov_b32 v73, 0
  v_mov_b32 v74, 0
  v_mov_b32 v75, 0
  v_mov_b32 v76, 0
  v_mov_b32 v77, 0
  v_mov_b32 v78, 0
  v_mov_b32 v79, 0
  v_mov_b32 v80, 0
  v_mov_b32 v81, 0
  v_mov_b32 v82, 0
  v_mov_b32 v83, 0
  v_mov_b32 v84, 0
  v_mov_b32 v85, 0
  v_mov_b32 v86, 0
  v_mov_b32 v87, 0
  v_mov_b32 v88, 0
  v_mov_b32 v89, 0
  v_mov_b32 v90, 0
  v_mov_b32 v91, 0
  v_mov_b32 v92, 0
  v_mov_b32 v93, 0
  v_mov_b32 v94, 0
  v_mov_b32 v95, 0
  v_mov_b32 v96, 0
  v_mov_b32 v97, 0
  v_mov_b32 v98, 0
  v_mov_b32 v99, 0
  v_mov_b32 v100, 0
  v_mov_b32 v101, 0
  v_mov_b32 v102, 0
  v_mov_b32 v103, 0
  v_mov_b32 v104, 0
  v_mov_b32 v105, 0
  v_mov_b32 v106, 0
  v_mov_b32 v107, 0
  v_mov_b32 v108, 0
  v_mov_b32 v109, 0
  v_mov_b32 v110, 0
  v_mov_b32 v111, 0
  s_mov_b32 s94, 9
  .p2align 6
L_tk_l:
  s_waitcnt lgkmcnt(8)
  v_mfma_f32_16x16x32_bf16 v[64:67], v[160:163], v[192:195], v[64:67]
  ds_read_b64_tr_b16 v[176:177], v2 offset:8320
  v_add_u32 v6, 29120, v3
  s_waitcnt lgkmcnt(8)
  v_mfma_f32_16x16x32_bf16 v[68:71], v[160:163], v[196:199], v[68:71]
  ds_read_b64_tr_b16 v[178:179], v2 offset:9360
  s_waitcnt lgkmcnt(8)
  v_mfma_f32_16x16x32_bf16 v[72:75], v[160:163], v[200:203], v[72:75]
  ds_read_b128 v[204:207], v3 offset:512
  s_waitcnt lgkmcnt(7)
  v_mfma_f32_16x16x32_bf16 v[76:79], v[164:167], v[192:195], v[76:79]
  ds_read_b128 v[208:211], v3 offset:2592
  v_mfma_f32_16x16x32_bf16 v[80:83], v[164:167], v[196:199], v[80:83]
  ds_read_b128 v[212:215], v3 offset:4672
  v_mfma_f32_16x16x32_bf16 v[84:87], v[164:167], v[200:203], v[84:87]
  ds_read_b64_tr_b16 v[180:181], v2 offset:8352
  s_waitcnt lgkmcnt(8)
  v_mfma_f32_16x16x32_bf16 v[88:91], v[168:171], v[192:195], v[88:91]
  ds_read_b64_tr_b16 v[182:183], v2 offset:9392
  v_add_u32 v7, 0xfffe3900, v3
  v_mfma_f32_16x16x32_bf16 v[92:95], v[168:171], v[196:199], v[92:95]
  ds_read_b64_tr_b16 v[184:185], v2 offset:8576
  v_mfma_f32_16x16x32_bf16 v[96:99], v[168:171], v[200:203], v[96:99]
  ds_read_b64_tr_b16 v[186:187], v2 offset:9616
  s_waitcnt lgkmcnt(9)
  v_mfma_f32_16x16x32_bf16 v[100:103], v[172:175], v[192:195], v[100:103]
  ds_read_b64_tr_b16 v[188:189], v2 offset:8608
  v_mfma_f32_16x16x32_bf16 v[104:107], v[172:175], v[196:199], v[104:107]
  ds_read_b64_tr_b16 v[190:191], v2 offset:9648
  v_mfma_f32_16x16x32_bf16 v[108:111], v[172:175], v[200:203], v[108:111]
  v_min_u32 v3, v7, v6
  v_add_u32 v2, v3, v4
  s_waitcnt lgkmcnt(8)
  v_mfma_f32_16x16x32_bf16 v[64:67], v[176:179], v[204:207], v[64:67]
  s_barrier
  ds_read_b64_tr_b16 v[160:161], v2 offset:0
  s_waitcnt lgkmcnt(8)
  v_mfma_f32_16x16x32_bf16 v[68:71], v[176:179], v[208:211], v[68:71]
  ds_read_b64_tr_b16 v[162:163], v2 offset:1040
  s_waitcnt lgkmcnt(8)
  v_mfma_f32_16x16x32_bf16 v[72:75], v[176:179], v[212:215], v[72:75]
  ds_read_b128 v[192:195], v3 offset:0
  s_waitcnt lgkmcnt(7)
  v_mfma_f32_16x16x32_bf16 v[76:79], v[180:183], v[204:207], v[76:79]
  ds_read_b128 v[196:199], v3 offset:2080
  v_mfma_f32_16x16x32_bf16 v[80:83], v[180:183], v[208:211], v[80:83]
  ds_read_b128 v[200:203], v3 offset:4160
  v_mfma_f32_16x16x32_bf16 v[84:87], v[180:183], v[212:215], v[84:87]
  ds_read_b64_tr_b16 v[164:165], v2 offset:32
  s_waitcnt lgkmcnt(8)
  v_mfma_f32_16x16x32_bf16 v[88:91], v[184:187], v[204:207], v[88:91]
  ds_read_b64_tr_b16 v[166:167], v2 offset:1072
  v_mfma_f32_16x16x32_bf16 v[92:95], v[184:187], v[208:211], v[92:95]
  ds_read_b64_tr_b16 v[168:169], v2 offset:256
  v_mfma_f32_16x16x32_bf16 v[96:99], v[184:187], v[212:215], v[96:99]
  ds_read_b64_tr_b16 v[170:171], v2 offset:1296
  s_waitcnt lgkmcnt(9)
  v_mfma_f32_16x16x32_bf16 v[100:103], v[188:191], v[204:207], v[100:103]
  ds_read_b64_tr_b16 v[172:173], v2 offset:288
  v_mfma_f32_16x16x32_bf16 v[104:107], v[188:191], v[208:211], v[104:107]
  ds_read_b64_tr_b16 v[174:175], v2 offset:1328
  v_mfma_f32_16x16x32_bf16 v[108:111], v[188:191], v[212:215], v[108:111]
  s_waitcnt lgkmcnt(8)
  v_mfma_f32_16x16x32_bf16 v[64:67], v[160:163], v[192:195], v[64:67]
  ds_read_b64_tr_b16 v[176:177], v2 offset:8320
  v_add_u32 v6, 29120, v3
  s_waitcnt lgkmcnt(8)
  v_mfma_f32_16x16x32_bf16 v[68:71], v[160:163], v[196:199], v[68:71]
  ds_read_b64_tr_b16 v[178:179], v2 offset:9360
  s_waitcnt lgkmcnt(8)
  v_mfma_f32_16x16x32_bf16 v[72:75], v[160:163], v[200:203], v[72:75]
  ds_read_b128 v[204:207], v3 offset:512
  v_add_u32 v7, 0xfffe3900, v3
  s_waitcnt lgkmcnt(7)
  v_mfma_f32_16x16x32_bf16 v[76:79], v[164:167], v[192:195], v[76:79]
  ds_read_b128 v[208:211], v3 offset:2592
  v_mfma_f32_16x16x32_bf16 v[80:83], v[164:167], v[196:199], v[80:83]
  ds_read_b128 v[212:215], v3 offset:4672
  v_mfma_f32_16x16x32_bf16 v[84:87], v[164:167], v[200:203], v[84:87]
  ds_read_b64_tr_b16 v[180:181], v2 offset:8352
  s_waitcnt lgkmcnt(8)
  v_mfma_f32_16x16x32_bf16 v[88:91], v[168:171], v[192:195], v[88:91]
  ds_read_b64_tr_b16 v[182:183], v2 offset:9392
  v_mfma_f32_16x16x32_bf16 v[92:95], v[168:171], v[196:199], v[92:95]
  ds_read_b64_tr_b16 v[184:185], v2 offset:8576
  v_mfma_f32_16x16x32_bf16 v[96:99], v[168:171], v[200:203], v[96:99]
  ds_read_b64_tr_b16 v[186:187], v2 offset:9616
  s_waitcnt lgkmcnt(9)
  v_mfma_f32_16x16x32_bf16 v[100:103], v[172:175], v[192:195], v[100:103]
  ds_read_b64_tr_b16 v[188:189], v2 offset:8608
  v_mfma_f32_16x16x32_bf16 v[104:107], v[172:175], v[196:199], v[104:107]
  ds_read_b64_tr_b16 v[190:191], v2 offset:9648
  s_waitcnt vmcnt(0)
  v_mfma_f32_16x16x32_bf16 v[108:111], v[172:175], v[200:203], v[108:111]
  v_min_u32 v3, v7, v6
  v_add_u32 v2, v3, v4
  s_waitcnt lgkmcnt(8)
  v_mfma_f32_16x16x32_bf16 v[64:67], v[176:179], v[204:207], v[64:67]
  s_barrier
  ds_read_b64_tr_b16 v[160:161], v2 offset:0
  s_sub_u32 s94, s94, 1
  s_waitcnt lgkmcnt(8)
  v_mfma_f32_16x16x32_bf16 v[68:71], v[176:179], v[208:211], v[68:71]
  ds_read_b64_tr_b16 v[162:163], v2 offset:1040
  s_waitcnt lgkmcnt(8)
  v_mfma_f32_16x16x32_bf16 v[72:75], v[176:179], v[212:215], v[72:75]
  ds_read_b128 v[192:195], v3 offset:0
  s_waitcnt lgkmcnt(7)
  v_mfma_f32_16x16x32_bf16 v[76:79], v[180:183], v[204:207], v[76:79]
  ds_read_b128 v[196:199], v3 offset:2080
  v_mfma_f32_16x16x32_bf16 v[80:83], v[180:183], v[208:211], v[80:83]
  ds_read_b128 v[200:203], v3 offset:4160
  v_mfma_f32_16x16x32_bf16 v[84:87], v[180:183], v[212:215], v[84:87]
  ds_read_b64_tr_b16 v[164:165], v2 offset:32
  s_waitcnt lgkmcnt(8)
  v_mfma_f32_16x16x32_bf16 v[88:91], v[184:187], v[204:207], v[88:91]
  ds_read_b64_tr_b16 v[166:167], v2 offset:1072
  s_cmp_lg_u32 s94, 0
  v_mfma_f32_16x16x32_bf16 v[92:95], v[184:187], v[208:211], v[92:95]
  ds_read_b64_tr_b16 v[168:169], v2 offset:256
  v_mfma_f32_16x16x32_bf16 v[96:99], v[184:187], v[212:215], v[96:99]
  ds_read_b64_tr_b16 v[170:171], v2 offset:1296
  s_waitcnt lgkmcnt(9)
  v_mfma_f32_16x16x32_bf16 v[100:103], v[188:191], v[204:207], v[100:103]
  ds_read_b64_tr_b16 v[172:173], v2 offset:288
  v_mfma_f32_16x16x32_bf16 v[104:107], v[188:191], v[208:211], v[104:107]
  ds_read_b64_tr_b16 v[174:175], v2 offset:1328
  v_mfma_f32_16x16x32_bf16 v[108:111], v[188:191], v[212:215], v[108:111]
  s_cbranch_scc1 L_tk_l
  s_waitcnt lgkmcnt(0)
  s_nop 6
  s_setpc_b64 s[86:87]
L_qk:
  v_add_u32 v2, v3, v4
  ds_read_b64_tr_b16 v[160:161], v2 offset:0
  ds_read_b64_tr_b16 v[162:163], v2 offset:1040
  ds_read_b128 v[192:195], v3 offset:0
  ds_read_b128 v[196:199], v3 offset:2080
  ds_read_b128 v[200:203], v3 offset:4160
  ds_read_b64_tr_b16 v[164:165], v2 offset:32
  ds_read_b64_tr_b16 v[166:167], v2 offset:1072
  ds_read_b64_tr_b16 v[168:169], v2 offset:256
  ds_read_b64_tr_b16 v[170:171], v2 offset:1296
  ds_read_b64_tr_b16 v[172:173], v2 offset:288
  ds_read_b64_tr_b16 v[174:175], v2 offset:1328
  v_mov_b32 v16, 0
  v_mov_b32 v17, 0
  v_mov_b32 v18, 0
  v_mov_b32 v19, 0
  v_mov_b32 v20, 0
  v_mov_b32 v21, 0
  v_mov_b32 v22, 0
  v_mov_b32 v23, 0
  v_mov_b32 v24, 0
  v_mov_b32 v25, 0
  v_mov_b32 v26, 0
  v_mov_b32 v27, 0
  v_mov_b32 v28, 0
  v_mov_b32 v29, 0
  v_mov_b32 v30, 0
  v_mov_b32 v31, 0
  v_mov_b32 v32, 0
  v_mov_b32 v33, 0
  v_mov_b32 v34, 0
  v_mov_b32 v35, 0
  v_mov_b32 v36, 0
  v_mov_b32 v37, 0
  v_mov_b32 v38, 0
  v_mov_b32 v39, 0
  v_mov_b32 v40, 0
  v_mov_b32 v41, 0
  v_mov_b32 v42, 0
  v_mov_b32 v43, 0
  v_mov_b32 v44, 0
  v_mov_b32 v45, 0
  v_mov_b32 v46, 0
  v_mov_b32 v47, 0
  v_mov_b32 v48, 0
  v_mov_b32 v49, 0
  v_mov_b32 v50, 0
  v_mov_b32 v51, 0
  v_mov_b32 v52, 0
  v_mov_b32 v53, 0
  v_mov_b32 v54, 0
  v_mov_b32 v55, 0
  v_mov_b32 v56, 0
  v_mov_b32 v57, 0
  v_mov_b32 v58, 0
  v_mov_b32 v59, 0
  v_mov_b32 v60, 0
  v_mov_b32 v61, 0
  v_mov_b32 v62, 0
  v_mov_b32 v63, 0
  v_mov_b32 v112, 0
  v_mov_b32 v113, 0
  v_mov_b32 v114, 0
  v_mov_b32 v115, 0
  v_mov_b32 v116, 0
  v_mov_b32 v117, 0
  v_mov_b32 v118, 0
  v_mov_b32 v119, 0
  v_mov_b32 v120, 0
  v_mov_b32 v121, 0
  v_mov_b32 v122, 0
  v_mov_b32 v123, 0
  v_mov_b32 v124, 0
  v_mov_b32 v125, 0
  v_mov_b32 v126, 0
  v_mov_b32 v127, 0
  v_mov_b32 v128, 0
  v_mov_b32 v129, 0
  v_mov_b32 v130, 0
  v_mov_b32 v131, 0
  v_mov_b32 v132, 0
  v_mov_b32 v133, 0
  v_mov_b32 v134, 0
  v_mov_b32 v135, 0
  v_mov_b32 v136, 0
  v_mov_b32 v137, 0
  v_mov_b32 v138, 0
  v_mov_b32 v139, 0
  v_mov_b32 v140, 0
  v_mov_b32 v141, 0
  v_mov_b32 v142, 0
  v_mov_b32 v143, 0
  v_mov_b32 v144, 0
  v_mov_b32 v145, 0
  v_mov_b32 v146, 0
  v_mov_b32 v147, 0
  v_mov_b32 v148, 0
  v_mov_b32 v149, 0
  v_mov_b32 v150, 0
  v_mov_b32 v151, 0
  v_mov_b32 v152, 0
  v_mov_b32 v153, 0
  v_mov_b32 v154, 0
  v_mov_b32 v155, 0
  v_mov_b32 v156, 0
  v_mov_b32 v157, 0
  v_mov_b32 v158, 0
  v_mov_b32 v159, 0
  s_mov_b32 s94, 18
  .p2align 6
L_qk_l:
  s_waitcnt lgkmcnt(8)
  v_mfma_f32_16x16x32_bf16 v[16:19], v[160:163], v[192:195], v[16:19]
  ds_read_b64_tr_b16 v[176:177], v2 offset:8320
  v_add_u32 v6, 29120, v3
  s_waitcnt lgkmcnt(8)
  v_mfma_f32_16x16x32_bf16 v[20:23], v[160:163], v[196:199], v[20:23]
  ds_read_b64_tr_b16 v[178:179], v2 offset:9360
  s_waitcnt lgkmcnt(8)
  v_mfma_f32_16x16x32_bf16 v[24:27], v[160:163], v[200:203], v[24:27]
  ds_read_b128 v[204:207], v3 offset:512
  s_waitcnt lgkmcnt(7)
  v_mfma_f32_16x16x32_bf16 v[28:31], v[164:167], v[192:195], v[28:31]
  ds_read_b128 v[208:211], v3 offset:2592
  v_mfma_f32_16x16x32_bf16 v[32:35], v[164:167], v[196:199], v[32:35]
  ds_read_b128 v[212:215], v3 offset:4672
  v_mfma_f32_16x16x32_bf16 v[36:39], v[164:167], v[200:203], v[36:39]
  ds_read_b64_tr_b16 v[180:181], v2 offset:8352
  s_waitcnt lgkmcnt(8)
  v_mfma_f32_16x16x32_bf16 v[40:43], v[168:171], v[192:195], v[40:43]
  ds_read_b64_tr_b16 v[182:183], v2 offset:9392
  v_add_u32 v7, 0xfffe3900, v3
  v_mfma_f32_16x16x32_bf16 v[44:47], v[168:171], v[196:199], v[44:47]
  ds_read_b64_tr_b16 v[184:185], v2 offset:8576
  v_mfma_f32_16x16x32_bf16 v[48:51], v[168:171], v[200:203], v[48:51]
  ds_read_b64_tr_b16 v[186:187], v2 offset:9616
  s_waitcnt lgkmcnt(9)
  v_mfma_f32_16x16x32_bf16 v[52:55], v[172:175], v[192:195], v[52:55]
  ds_read_b64_tr_b16 v[188:189], v2 offset:8608
  v_mfma_f32_16x16x32_bf16 v[56:59], v[172:175], v[196:199], v[56:59]
  ds_read_b64_tr_b16 v[190:191], v2 offset:9648
  v_mfma_f32_16x16x32_bf16 v[60:63], v[172:175], v[200:203], v[60:63]
  v_min_u32 v3, v7, v6
  v_add_u32 v2, v3, v4
  s_waitcnt lgkmcnt(8)
  v_mfma_f32_16x16x32_bf16 v[16:19], v[176:179], v[204:207], v[16:19]
  s_barrier
  ds_read_b64_tr_b16 v[160:161], v2 offset:0
  s_waitcnt lgkmcnt(8)
  v_mfma_f32_16x16x32_bf16 v[20:23], v[176:179], v[208:211], v[20:23]
  ds_read_b64_tr_b16 v[162:163], v2 offset:1040
  s_waitcnt lgkmcnt(8)
  v_mfma_f32_16x16x32_bf16 v[24:27], v[176:179], v[212:215], v[24:27]
  ds_read_b64_tr_b16 v[164:165], v2 offset:32
  s_waitcnt lgkmcnt(7)
  v_mfma_f32_16x16x32_bf16 v[28:31], v[180:183], v[204:207], v[28:31]
  v_mfma_f32_16x16x32_bf16 v[32:35], v[180:183], v[208:211], v[32:35]
  ds_read_b64_tr_b16 v[166:167], v2 offset:1072
  v_mfma_f32_16x16x32_bf16 v[36:39], v[180:183], v[212:215], v[36:39]
  ds_read_b64_tr_b16 v[168:169], v2 offset:256
  s_waitcnt lgkmcnt(7)
  v_mfma_f32_16x16x32_bf16 v[40:43], v[184:187], v[204:207], v[40:43]
  ds_read_b64_tr_b16 v[170:171], v2 offset:1296
  v_mfma_f32_16x16x32_bf16 v[44:47], v[184:187], v[208:211], v[44:47]
  v_mfma_f32_16x16x32_bf16 v[48:51], v[184:187], v[212:215], v[48:51]
  ds_read_b64_tr_b16 v[172:173], v2 offset:288
  s_waitcnt lgkmcnt(7)
  v_mfma_f32_16x16x32_bf16 v[52:55], v[188:191], v[204:207], v[52:55]
  ds_read_b64_tr_b16 v[174:175], v2 offset:1328
  v_mfma_f32_16x16x32_bf16 v[56:59], v[188:191], v[208:211], v[56:59]
  v_mfma_f32_16x16x32_bf16 v[60:63], v[188:191], v[212:215], v[60:63]
  s_waitcnt lgkmcnt(6)
  v_mfma_f32_16x16x32_bf16 v[112:115], v[160:163], v[192:195], v[112:115]
  ds_read_b64_tr_b16 v[176:177], v2 offset:8320
  v_add_u32 v6, 29120, v3
  v_mfma_f32_16x16x32_bf16 v[116:119], v[160:163], v[196:199], v[116:119]
  ds_read_b64_tr_b16 v[178:179], v2 offset:9360
  v_mfma_f32_16x16x32_bf16 v[120:123], v[160:163], v[200:203], v[120:123]
  ds_read_b64_tr_b16 v[180:181], v2 offset:8352
  s_waitcnt lgkmcnt(7)
  v_mfma_f32_16x16x32_bf16 v[124:127], v[164:167], v[192:195], v[124:127]
  v_mfma_f32_16x16x32_bf16 v[128:131], v[164:167], v[196:199], v[128:131]
  ds_read_b64_tr_b16 v[182:183], v2 offset:9392
  v_mfma_f32_16x16x32_bf16 v[132:135], v[164:167], v[200:203], v[132:135]
  ds_read_b64_tr_b16 v[184:185], v2 offset:8576
  s_waitcnt lgkmcnt(7)
  v_mfma_f32_16x16x32_bf16 v[136:139], v[168:171], v[192:195], v[136:139]
  ds_read_b64_tr_b16 v[186:187], v2 offset:9616
  v_add_u32 v7, 0xfffe3900, v3
  v_mfma_f32_16x16x32_bf16 v[140:143], v[168:171], v[196:199], v[140:143]
  v_mfma_f32_16x16x32_bf16 v[144:147], v[168:171], v[200:203], v[144:147]
  ds_read_b64_tr_b16 v[188:189], v2 offset:8608
  s_waitcnt lgkmcnt(7)
  v_mfma_f32_16x16x32_bf16 v[148:151], v[172:175], v[192:195], v[148:151]
  ds_read_b64_tr_b16 v[190:191], v2 offset:9648
  v_mfma_f32_16x16x32_bf16 v[152:155], v[172:175], v[196:199], v[152:155]
  v_mfma_f32_16x16x32_bf16 v[156:159], v[172:175], v[200:203], v[156:159]
  v_min_u32 v3, v7, v6
  v_add_u32 v2, v3, v4
  s_waitcnt lgkmcnt(6)
  v_mfma_f32_16x16x32_bf16 v[112:115], v[176:179], v[204:207], v[112:115]
  s_barrier
  ds_read_b64_tr_b16 v[160:161], v2 offset:0
  v_mfma_f32_16x16x32_bf16 v[116:119], v[176:179], v[208:211], v[116:119]
  ds_read_b64_tr_b16 v[162:163], v2 offset:1040
  v_mfma_f32_16x16x32_bf16 v[120:123], v[176:179], v[212:215], v[120:123]
  ds_read_b128 v[192:195], v3 offset:0
  s_waitcnt lgkmcnt(7)
  v_mfma_f32_16x16x32_bf16 v[124:127], v[180:183], v[204:207], v[124:127]
  ds_read_b128 v[196:199], v3 offset:2080
  v_mfma_f32_16x16x32_bf16 v[128:131], v[180:183], v[208:211], v[128:131]
  ds_read_b128 v[200:203], v3 offset:4160
  v_mfma_f32_16x16x32_bf16 v[132:135], v[180:183], v[212:215], v[132:135]
  ds_read_b64_tr_b16 v[164:165], v2 offset:32
  s_waitcnt lgkmcnt(8)
  v_mfma_f32_16x16x32_bf16 v[136:139], v[184:187], v[204:207], v[136:139]
  ds_read_b64_tr_b16 v[166:167], v2 offset:1072
  v_mfma_f32_16x16x32_bf16 v[140:143], v[184:187], v[208:211], v[140:143]
  ds_read_b64_tr_b16 v[168:169], v2 offset:256
  v_mfma_f32_16x16x32_bf16 v[144:147], v[184:187], v[212:215], v[144:147]
  ds_read_b64_tr_b16 v[170:171], v2 offset:1296
  s_waitcnt lgkmcnt(9)
  v_mfma_f32_16x16x32_bf16 v[148:151], v[188:191], v[204:207], v[148:151]
  ds_read_b64_tr_b16 v[172:173], v2 offset:288
  v_mfma_f32_16x16x32_bf16 v[152:155], v[188:191], v[208:211], v[152:155]
  ds_read_b64_tr_b16 v[174:175], v2 offset:1328
  v_mfma_f32_16x16x32_bf16 v[156:159], v[188:191], v[212:215], v[156:159]
  s_waitcnt lgkmcnt(8)
  v_mfma_f32_16x16x32_bf16 v[16:19], v[160:163], v[192:195], v[16:19]
  ds_read_b64_tr_b16 v[176:177], v2 offset:8320
  v_add_u32 v6, 29120, v3
  s_waitcnt lgkmcnt(8)
  v_mfma_f32_16x16x32_bf16 v[20:23], v[160:163], v[196:199], v[20:23]
  ds_read_b64_tr_b16 v[178:179], v2 offset:9360
  s_waitcnt lgkmcnt(8)
  v_mfma_f32_16x16x32_bf16 v[24:27], v[160:163], v[200:203], v[24:27]
  ds_read_b128 v[204:207], v3 offset:512
  s_waitcnt lgkmcnt(7)
  v_mfma_f32_16x16x32_bf16 v[28:31], v[164:167], v[192:195], v[28:31]
  ds_read_b128 v[208:211], v3 offset:2592
  v_mfma_f32_16x16x32_bf16 v[32:35], v[164:167], v[196:199], v[32:35]
  ds_read_b128 v[212:215], v3 offset:4672
  v_mfma_f32_16x16x32_bf16 v[36:39], v[164:167], v[200:203], v[36:39]
  ds_read_b64_tr_b16 v[180:181], v2 offset:8352
  s_waitcnt lgkmcnt(8)
  v_mfma_f32_16x16x32_bf16 v[40:43], v[168:171], v[192:195], v[40:43]
  ds_read_b64_tr_b16 v[182:183], v2 offset:9392
  v_add_u32 v7, 0xfffe3900, v3
  v_mfma_f32_16x16x32_bf16 v[44:47], v[168:171], v[196:199], v[44:47]
  ds_read_b64_tr_b16 v[184:185], v2 offset:8576
  v_mfma_f32_16x16x32_bf16 v[48:51], v[168:171], v[200:203], v[48:51]
  ds_read_b64_tr_b16 v[186:187], v2 offset:9616
  s_waitcnt lgkmcnt(9)
  v_mfma_f32_16x16x32_bf16 v[52:55], v[172:175], v[192:195], v[52:55]
  ds_read_b64_tr_b16 v[188:189], v2 offset:8608
  v_mfma_f32_16x16x32_bf16 v[56:59], v[172:175], v[196:199], v[56:59]
  ds_read_b64_tr_b16 v[190:191], v2 offset:9648
  v_mfma_f32_16x16x32_bf16 v[60:63], v[172:175], v[200:203], v[60:63]
  v_min_u32 v3, v7, v6
  v_add_u32 v2, v3, v4
  s_waitcnt lgkmcnt(8)
  v_mfma_f32_16x16x32_bf16 v[16:19], v[176:179], v[204:207], v[16:19]
  s_barrier
  ds_read_b64_tr_b16 v[160:161], v2 offset:0
  s_waitcnt lgkmcnt(8)
  v_mfma_f32_16x16x32_bf16 v[20:23], v[176:179], v[208:211], v[20:23]
  ds_read_b64_tr_b16 v[162:163], v2 offset:1040
  s_waitcnt lgkmcnt(8)
  v_mfma_f32_16x16x32_bf16 v[24:27], v[176:179], v[212:215], v[24:27]
  ds_read_b64_tr_b16 v[164:165], v2 offset:32
  s_waitcnt lgkmcnt(7)
  v_mfma_f32_16x16x32_bf16 v[28:31], v[180:183], v[204:207], v[28:31]
  v_mfma_f32_16x16x32_bf16 v[32:35], v[180:183], v[208:211], v[32:35]
  ds_read_b64_tr_b16 v[166:167], v2 offset:1072
  v_mfma_f32_16x16x32_bf16 v[36:39], v[180:183], v[212:215], v[36:39]
  ds_read_b64_tr_b16 v[168:169], v2 offset:256
  s_waitcnt lgkmcnt(7)
  v_mfma_f32_16x16x32_bf16 v[40:43], v[184:187], v[204:207], v[40:43]
  ds_read_b64_tr_b16 v[170:171], v2 offset:1296
  v_mfma_f32_16x16x32_bf16 v[44:47], v[184:187], v[208:211], v[44:47]
  v_mfma_f32_16x16x32_bf16 v[48:51], v[184:187], v[212:215], v[48:51]
  ds_read_b64_tr_b16 v[172:173], v2 offset:288
  s_waitcnt lgkmcnt(7)
  v_mfma_f32_16x16x32_bf16 v[52:55], v[188:191], v[204:207], v[52:55]
  ds_read_b64_tr_b16 v[174:175], v2 offset:1328
  v_mfma_f32_16x16x32_bf16 v[56:59], v[188:191], v[208:211], v[56:59]
  v_mfma_f32_16x16x32_bf16 v[60:63], v[188:191], v[212:215], v[60:63]
  s_waitcnt lgkmcnt(6)
  v_mfma_f32_16x16x32_bf16 v[112:115], v[160:163], v[192:195], v[112:115]
  ds_read_b64_tr_b16 v[176:177], v2 offset:8320
  v_add_u32 v6, 29120, v3
  v_mfma_f32_16x16x32_bf16 v[116:119], v[160:163], v[196:199], v[116:119]
  ds_read_b64_tr_b16 v[178:179], v2 offset:9360
  v_mfma_f32_16x16x32_bf16 v[120:123], v[160:163], v[200:203], v[120:123]
  ds_read_b64_tr_b16 v[180:181], v2 offset:8352
  v_add_u32 v7, 0xfffe3900, v3
  s_waitcnt lgkmcnt(7)
  v_mfma_f32_16x16x32_bf16 v[124:127], v[164:167], v[192:195], v[124:127]
  v_mfma_f32_16x16x32_bf16 v[128:131], v[164:167], v[196:199], v[128:131]
  ds_read_b64_tr_b16 v[182:183], v2 offset:9392
  v_mfma_f32_16x16x32_bf16 v[132:135], v[164:167], v[200:203], v[132:135]
  ds_read_b64_tr_b16 v[184:185], v2 offset:8576
  s_waitcnt lgkmcnt(7)
  v_mfma_f32_16x16x32_bf16 v[136:139], v[168:171], v[192:195], v[136:139]
  ds_read_b64_tr_b16 v[186:187], v2 offset:9616
  v_mfma_f32_16x16x32_bf16 v[140:143], v[168:171], v[196:199], v[140:143]
  v_mfma_f32_16x16x32_bf16 v[144:147], v[168:171], v[200:203], v[144:147]
  ds_read_b64_tr_b16 v[188:189], v2 offset:8608
  s_waitcnt lgkmcnt(7)
  v_mfma_f32_16x16x32_bf16 v[148:151], v[172:175], v[192:195], v[148:151]
  ds_read_b64_tr_b16 v[190:191], v2 offset:9648
  v_mfma_f32_16x16x32_bf16 v[152:155], v[172:175], v[196:199], v[152:155]
  s_waitcnt vmcnt(0)
  v_mfma_f32_16x16x32_bf16 v[156:159], v[172:175], v[200:203], v[156:159]
  v_min_u32 v3, v7, v6
  v_add_u32 v2, v3, v4
  s_waitcnt lgkmcnt(6)
  v_mfma_f32_16x16x32_bf16 v[112:115], v[176:179], v[204:207], v[112:115]
  s_barrier
  ds_read_b64_tr_b16 v[160:161], v2 offset:0
  s_sub_u32 s94, s94, 2
  v_mfma_f32_16x16x32_bf16 v[116:119], v[176:179], v[208:211], v[116:119]
  ds_read_b64_tr_b16 v[162:163], v2 offset:1040
  v_mfma_f32_16x16x32_bf16 v[120:123], v[176:179], v[212:215], v[120:123]
  ds_read_b128 v[192:195], v3 offset:0
  s_waitcnt lgkmcnt(7)
  v_mfma_f32_16x16x32_bf16 v[124:127], v[180:183], v[204:207], v[124:127]
  ds_read_b128 v[196:199], v3 offset:2080
  v_mfma_f32_16x16x32_bf16 v[128:131], v[180:183], v[208:211], v[128:131]
  ds_read_b128 v[200:203], v3 offset:4160
  v_mfma_f32_16x16x32_bf16 v[132:135], v[180:183], v[212:215], v[132:135]
  ds_read_b64_tr_b16 v[164:165], v2 offset:32
  s_waitcnt lgkmcnt(8)
  v_mfma_f32_16x16x32_bf16 v[136:139], v[184:187], v[204:207], v[136:139]
  ds_read_b64_tr_b16 v[166:167], v2 offset:1072
  s_cmp_lg_u32 s94, 0
  v_mfma_f32_16x16x32_bf16 v[140:143], v[184:187], v[208:211], v[140:143]
  ds_read_b64_tr_b16 v[168:169], v2 offset:256
  v_mfma_f32_16x16x32_bf16 v[144:147], v[184:187], v[212:215], v[144:147]
  ds_read_b64_tr_b16 v[170:171], v2 offset:1296
  s_waitcnt lgkmcnt(9)
  v_mfma_f32_16x16x32_bf16 v[148:151], v[188:191], v[204:207], v[148:151]
  ds_read_b64_tr_b16 v[172:173], v2 offset:288
  v_mfma_f32_16x16x32_bf16 v[152:155], v[188:191], v[208:211], v[152:155]
  ds_read_b64_tr_b16 v[174:175], v2 offset:1328
  v_mfma_f32_16x16x32_bf16 v[156:159], v[188:191], v[212:215], v[156:159]
  s_cbranch_scc1 L_qk_l
  s_waitcnt lgkmcnt(0)
  s_nop 6
  s_setpc_b64 s[86:87]
L_st3:
  v_cvt_pk_bf16_f32 v160, v64, v65
  v_cvt_pk_bf16_f32 v161, v66, v67
  v_cvt_pk_bf16_f32 v162, v76, v77
  v_cvt_pk_bf16_f32 v163, v78, v79
  v_cvt_pk_bf16_f32 v164, v88, v89
  v_cvt_pk_bf16_f32 v165, v90, v91
  v_cvt_pk_bf16_f32 v166, v100, v101
  v_cvt_pk_bf16_f32 v167, v102, v103
  v_cvt_pk_bf16_f32 v168, v68, v69
  v_cvt_pk_bf16_f32 v169, v70, v71
  v_cvt_pk_bf16_f32 v170, v80, v81
  v_cvt_pk_bf16_f32 v171, v82, v83
  v_cvt_pk_bf16_f32 v172, v92, v93
  v_cvt_pk_bf16_f32 v173, v94, v95
  v_cvt_pk_bf16_f32 v174, v104, v105
  v_cvt_pk_bf16_f32 v175, v106, v107
  v_cvt_pk_bf16_f32 v176, v72, v73
  v_cvt_pk_bf16_f32 v177, v74, v75
  v_cvt_pk_bf16_f32 v178, v84, v85
  v_cvt_pk_bf16_f32 v179, v86, v87
  v_cvt_pk_bf16_f32 v180, v96, v97
  v_cvt_pk_bf16_f32 v181, v98, v99
  v_cvt_pk_bf16_f32 v182, v108, v109
  v_cvt_pk_bf16_f32 v183, v110, v111
  s_nop 1
  v_bfi_b32 v64, v8, v160, v162
  v_bfi_b32 v65, v8, v161, v163
  v_bfi_b32 v66, v8, v164, v166
  v_bfi_b32 v67, v8, v165, v167
  v_bfi_b32 v68, v8, v168, v170
  v_bfi_b32 v69, v8, v169, v171
  v_bfi_b32 v70, v8, v172, v174
  v_bfi_b32 v71, v8, v173, v175
  v_bfi_b32 v72, v8, v176, v178
  v_bfi_b32 v73, v8, v177, v179
  v_bfi_b32 v74, v8, v180, v182
  v_bfi_b32 v75, v8, v181, v183
  v_mov_b32_dpp v76, v64 quad_perm:[1,0,3,2] row_mask:0xf bank_mask:0xf
  v_mov_b32_dpp v77, v65 quad_perm:[1,0,3,2] row_mask:0xf bank_mask:0xf
  v_mov_b32_dpp v78, v66 quad_perm:[1,0,3,2] row_mask:0xf bank_mask:0xf
  v_mov_b32_dpp v79, v67 quad_perm:[1,0,3,2] row_mask:0xf bank_mask:0xf
  v_mov_b32_dpp v80, v68 quad_perm:[1,0,3,2] row_mask:0xf bank_mask:0xf
  v_mov_b32_dpp v81, v69 quad_perm:[1,0,3,2] row_mask:0xf bank_mask:0xf
  v_mov_b32_dpp v82, v70 quad_perm:[1,0,3,2] row_mask:0xf bank_mask:0xf
  v_mov_b32_dpp v83, v71 quad_perm:[1,0,3,2] row_mask:0xf bank_mask:0xf
  v_mov_b32_dpp v84, v72 quad_perm:[1,0,3,2] row_mask:0xf bank_mask:0xf
  v_mov_b32_dpp v85, v73 quad_perm:[1,0,3,2] row_mask:0xf bank_mask:0xf
  v_mov_b32_dpp v86, v74 quad_perm:[1,0,3,2] row_mask:0xf bank_mask:0xf
  v_mov_b32_dpp v87, v75 quad_perm:[1,0,3,2] row_mask:0xf bank_mask:0xf
  v_bfi_b32 v160, v8, v76, v160
  v_bfi_b32 v162, v8, v162, v76
  v_bfi_b32 v161, v8, v77, v161
  v_bfi_b32 v163, v8, v163, v77
  v_bfi_b32 v164, v8, v78, v164
  v_bfi_b32 v166, v8, v166, v78
  v_bfi_b32 v165, v8, v79, v165
  v_bfi_b32 v167, v8, v167, v79
  v_bfi_b32 v168, v8, v80, v168
  v_bfi_b32 v170, v8, v170, v80
  v_bfi_b32 v169, v8, v81, v169
  v_bfi_b32 v171, v8, v171, v81
  v_bfi_b32 v172, v8, v82, v172
  v_bfi_b32 v174, v8, v174, v82
  v_bfi_b32 v173, v8, v83, v173
  v_bfi_b32 v175, v8, v175, v83
  v_bfi_b32 v176, v8, v84, v176
  v_bfi_b32 v178, v8, v178, v84
  v_bfi_b32 v177, v8, v85, v177
  v_bfi_b32 v179, v8, v179, v85
  v_bfi_b32 v180, v8, v86, v180
  v_bfi_b32 v182, v8, v182, v86
  v_bfi_b32 v181, v8, v87, v181
  v_bfi_b32 v183, v8, v183, v87
  v_bfi_b32 v64, v9, v160, v164
  v_bfi_b32 v65, v9, v161, v165
  v_bfi_b32 v66, v9, v162, v166
  v_bfi_b32 v67, v9, v163, v167
  v_bfi_b32 v68, v9, v168, v172
  v_bfi_b32 v69, v9, v169, v173
  v_bfi_b32 v70, v9, v170, v174
  v_bfi_b32 v71, v9, v171, v175
  v_bfi_b32 v72, v9, v176, v180
  v_bfi_b32 v73, v9, v177, v181
  v_bfi_b32 v74, v9, v178, v182
  v_bfi_b32 v75, v9, v179, v183
  v_mov_b32_dpp v76, v64 quad_perm:[2,3,0,1] row_mask:0xf bank_mask:0xf
  v_mov_b32_dpp v77, v65 quad_perm:[2,3,0,1] row_mask:0xf bank_mask:0xf
  v_mov_b32_dpp v78, v66 quad_perm:[2,3,0,1] row_mask:0xf bank_mask:0xf
  v_mov_b32_dpp v79, v67 quad_perm:[2,3,0,1] row_mask:0xf bank_mask:0xf
  v_mov_b32_dpp v80, v68 quad_perm:[2,3,0,1] row_mask:0xf bank_mask:0xf
  v_mov_b32_dpp v81, v69 quad_perm:[2,3,0,1] row_mask:0xf bank_mask:0xf
  v_mov_b32_dpp v82, v70 quad_perm:[2,3,0,1] row_mask:0xf bank_mask:0xf
  v_mov_b32_dpp v83, v71 quad_perm:[2,3,0,1] row_mask:0xf bank_mask:0xf
  v_mov_b32_dpp v84, v72 quad_perm:[2,3,0,1] row_mask:0xf bank_mask:0xf
  v_mov_b32_dpp v85, v73 quad_perm:[2,3,0,1] row_mask:0xf bank_mask:0xf
  v_mov_b32_dpp v86, v74 quad_perm:[2,3,0,1] row_mask:0xf bank_mask:0xf
  v_mov_b32_dpp v87, v75 quad_perm:[2,3,0,1] row_mask:0xf bank_mask:0xf
  v_bfi_b32 v160, v9, v76, v160
  v_bfi_b32 v164, v9, v164, v76
  v_bfi_b32 v161, v9, v77, v161
  v_bfi_b32 v165, v9, v165, v77
  v_bfi_b32 v162, v9, v78, v162
  v_bfi_b32 v166, v9, v166, v78
  v_bfi_b32 v163, v9, v79, v163
  v_bfi_b32 v167, v9, v167, v79
  v_bfi_b32 v168, v9, v80, v168
  v_bfi_b32 v172, v9, v172, v80
  v_bfi_b32 v169, v9, v81, v169
  v_bfi_b32 v173, v9, v173, v81
  v_bfi_b32 v170, v9, v82, v170
  v_bfi_b32 v174, v9, v174, v82
  v_bfi_b32 v171, v9, v83, v171
  v_bfi_b32 v175, v9, v175, v83
  v_bfi_b32 v176, v9, v84, v176
  v_bfi_b32 v180, v9, v180, v84
  v_bfi_b32 v177, v9, v85, v177
  v_bfi_b32 v181, v9, v181, v85
  v_bfi_b32 v178, v9, v86, v178
  v_bfi_b32 v182, v9, v182, v86
  v_bfi_b32 v179, v9, v87, v179
  v_bfi_b32 v183, v9, v183, v87
  s_nop 1
  v_permlane16_swap_b32 v160, v162
  v_permlane16_swap_b32 v161, v163
  v_permlane16_swap_b32 v164, v166
  v_permlane16_swap_b32 v165, v167
  v_permlane16_swap_b32 v168, v170
  v_permlane16_swap_b32 v169, v171
  v_permlane16_swap_b32 v172, v174
  v_permlane16_swap_b32 v173, v175
  v_permlane16_swap_b32 v176, v178
  v_permlane16_swap_b32 v177, v179
  v_permlane16_swap_b32 v180, v182
  v_permlane16_swap_b32 v181, v183
  buffer_store_dwordx4 v[160:163], v240, s[24:27], 0 offen sc1
  buffer_store_dwordx4 v[164:167], v241, s[24:27], 0 offen sc1
  buffer_store_dwordx4 v[168:171], v242, s[24:27], 0 offen sc1
  buffer_store_dwordx4 v[172:175], v243, s[24:27], 0 offen sc1
  buffer_store_dwordx4 v[176:179], v244, s[24:27], 0 offen sc1
  buffer_store_dwordx4 v[180:183], v245, s[24:27], 0 offen sc1
  s_setpc_b64 s[68:69]
L_st6:
  v_cvt_pk_bf16_f32 v160, v112, v113
  v_cvt_pk_bf16_f32 v161, v114, v115
  v_cvt_pk_bf16_f32 v162, v124, v125
  v_cvt_pk_bf16_f32 v163, v126, v127
  v_cvt_pk_bf16_f32 v164, v136, v137
  v_cvt_pk_bf16_f32 v165, v138, v139
  v_cvt_pk_bf16_f32 v166, v148, v149
  v_cvt_pk_bf16_f32 v167, v150, v151
  v_cvt_pk_bf16_f32 v168, v116, v117
  v_cvt_pk_bf16_f32 v169, v118, v119
  v_cvt_pk_bf16_f32 v170, v128, v129
  v_cvt_pk_bf16_f32 v171, v130, v131
  v_cvt_pk_bf16_f32 v172, v140, v141
  v_cvt_pk_bf16_f32 v173, v142, v143
  v_cvt_pk_bf16_f32 v174, v152, v153
  v_cvt_pk_bf16_f32 v175, v154, v155
  v_cvt_pk_bf16_f32 v176, v120, v121
  v_cvt_pk_bf16_f32 v177, v122, v123
  v_cvt_pk_bf16_f32 v178, v132, v133
  v_cvt_pk_bf16_f32 v179, v134, v135
  v_cvt_pk_bf16_f32 v180, v144, v145
  v_cvt_pk_bf16_f32 v181, v146, v147
  v_cvt_pk_bf16_f32 v182, v156, v157
  v_cvt_pk_bf16_f32 v183, v158, v159
  v_add_u32 v246, 36864, v10
  v_add_u32 v247, 73728, v10
  v_permlane16_swap_b32 v160, v162
  v_permlane16_swap_b32 v161, v163
  buffer_store_dwordx4 v[160:163], v10, s[28:31], 0 offen offset:0 sc1
  v_permlane16_swap_b32 v164, v166
  v_permlane16_swap_b32 v165, v167
  buffer_store_dwordx4 v[164:167], v10, s[28:31], 0 offen offset:1024 sc1
  v_permlane16_swap_b32 v168, v170
  v_permlane16_swap_b32 v169, v171
  buffer_store_dwordx4 v[168:171], v246, s[28:31], 0 offen offset:0 sc1
  v_permlane16_swap_b32 v172, v174
  v_permlane16_swap_b32 v173, v175
  buffer_store_dwordx4 v[172:175], v246, s[28:31], 0 offen offset:1024 sc1
  v_permlane16_swap_b32 v176, v178
  v_permlane16_swap_b32 v177, v179
  buffer_store_dwordx4 v[176:179], v247, s[28:31], 0 offen offset:0 sc1
  v_permlane16_swap_b32 v180, v182
  v_permlane16_swap_b32 v181, v183
  buffer_store_dwordx4 v[180:183], v247, s[28:31], 0 offen offset:1024 sc1
  v_cvt_pk_bf16_f32 v112, v16, v17
  v_cvt_pk_bf16_f32 v113, v18, v19
  v_cvt_pk_bf16_f32 v114, v28, v29
  v_cvt_pk_bf16_f32 v115, v30, v31
  v_cvt_pk_bf16_f32 v116, v40, v41
  v_cvt_pk_bf16_f32 v117, v42, v43
  v_cvt_pk_bf16_f32 v118, v52, v53
  v_cvt_pk_bf16_f32 v119, v54, v55
  v_cvt_pk_bf16_f32 v120, v20, v21
  v_cvt_pk_bf16_f32 v121, v22, v23
  v_cvt_pk_bf16_f32 v122, v32, v33
  v_cvt_pk_bf16_f32 v123, v34, v35
  v_cvt_pk_bf16_f32 v124, v44, v45
  v_cvt_pk_bf16_f32 v125, v46, v47
  v_cvt_pk_bf16_f32 v126, v56, v57
  v_cvt_pk_bf16_f32 v127, v58, v59
  v_cvt_pk_bf16_f32 v128, v24, v25
  v_cvt_pk_bf16_f32 v129, v26, v27
  v_cvt_pk_bf16_f32 v130, v36, v37
  v_cvt_pk_bf16_f32 v131, v38, v39
  v_cvt_pk_bf16_f32 v132, v48, v49
  v_cvt_pk_bf16_f32 v133, v50, v51
  v_cvt_pk_bf16_f32 v134, v60, v61
  v_cvt_pk_bf16_f32 v135, v62, v63
  v_add_u32 v246, 36864, v10
  v_add_u32 v247, 73728, v10
  v_permlane16_swap_b32 v112, v114
  v_permlane16_swap_b32 v113, v115
  buffer_store_dwordx4 v[112:115], v10, s[24:27], 0 offen offset:0 sc1
  v_permlane16_swap_b32 v116, v118
  v_permlane16_swap_b32 v117, v119
  buffer_store_dwordx4 v[116:119], v10, s[24:27], 0 offen offset:1024 sc1
  v_permlane16_swap_b32 v120, v122
  v_permlane16_swap_b32 v121, v123
  buffer_store_dwordx4 v[120:123], v246, s[24:27], 0 offen offset:0 sc1
  v_permlane16_swap_b32 v124, v126
  v_permlane16_swap_b32 v125, v127
  buffer_store_dwordx4 v[124:127], v246, s[24:27], 0 offen offset:1024 sc1
  v_permlane16_swap_b32 v128, v130
  v_permlane16_swap_b32 v129, v131
  buffer_store_dwordx4 v[128:131], v247, s[24:27], 0 offen offset:0 sc1
  v_permlane16_swap_b32 v132, v134
  v_permlane16_swap_b32 v133, v135
  buffer_store_dwordx4 v[132:135], v247, s[24:27], 0 offen offset:1024 sc1
  s_setpc_b64 s[68:69]
L_kk:
  v_add_u32 v2, v3, v5
  ds_read_b128 v[160:163], v2 offset:0
  ds_read_b128 v[192:195], v3 offset:0
  ds_read_b128 v[196:199], v3 offset:2080
  ds_read_b128 v[200:203], v3 offset:4160
  ds_read_b128 v[164:167], v2 offset:2080
  ds_read_b128 v[168:171], v2 offset:4160
  ds_read_b128 v[172:175], v2 offset:6240
  v_mov_b32 v16, 0
  v_mov_b32 v17, 0
  v_mov_b32 v18, 0
  v_mov_b32 v19, 0
  v_mov_b32 v20, 0
  v_mov_b32 v21, 0
  v_mov_b32 v22, 0
  v_mov_b32 v23, 0
  v_mov_b32 v24, 0
  v_mov_b32 v25, 0
  v_mov_b32 v26, 0
  v_mov_b32 v27, 0
  v_mov_b32 v28, 0
  v_mov_b32 v29, 0
  v_mov_b32 v30, 0
  v_mov_b32 v31, 0
  v_mov_b32 v32, 0
  v_mov_b32 v33, 0
  v_mov_b32 v34, 0
  v_mov_b32 v35, 0
  v_mov_b32 v36, 0
  v_mov_b32 v37, 0
  v_mov_b32 v38, 0
  v_mov_b32 v39, 0
  v_mov_b32 v40, 0
  v_mov_b32 v41, 0
  v_mov_b32 v42, 0
  v_mov_b32 v43, 0
  v_mov_b32 v44, 0
  v_mov_b32 v45, 0
  v_mov_b32 v46, 0
  v_mov_b32 v47, 0
  v_mov_b32 v48, 0
  v_mov_b32 v49, 0
  v_mov_b32 v50, 0
  v_mov_b32 v51, 0
  v_mov_b32 v52, 0
  v_mov_b32 v53, 0
  v_mov_b32 v54, 0
  v_mov_b32 v55, 0
  v_mov_b32 v56, 0
  v_mov_b32 v57, 0
  v_mov_b32 v58, 0
  v_mov_b32 v59, 0
  v_mov_b32 v60, 0
  v_mov_b32 v61, 0
  v_mov_b32 v62, 0
  v_mov_b32 v63, 0
  s_mov_b32 s94, 9
  .p2align 6
L_kk_l:
  s_waitcnt lgkmcnt(5)
  v_mfma_f32_16x16x32_bf16 v[16:19], v[160:163], v[192:195], v[16:19]
  ds_read_b128 v[176:179], v2 offset:1040
  v_add_u32 v6, 29120, v3
  s_waitcnt lgkmcnt(5)
  v_mfma_f32_16x16x32_bf16 v[20:23], v[160:163], v[196:199], v[20:23]
  ds_read_b128 v[204:207], v3 offset:1040
  s_waitcnt lgkmcnt(5)
  v_mfma_f32_16x16x32_bf16 v[24:27], v[160:163], v[200:203], v[24:27]
  s_waitcnt lgkmcnt(4)
  v_mfma_f32_16x16x32_bf16 v[28:31], v[164:167], v[192:195], v[28:31]
  ds_read_b128 v[208:211], v3 offset:3120
  v_mfma_f32_16x16x32_bf16 v[32:35], v[164:167], v[196:199], v[32:35]
  ds_read_b128 v[212:215], v3 offset:5200
  v_mfma_f32_16x16x32_bf16 v[36:39], v[164:167], v[200:203], v[36:39]
  s_waitcnt lgkmcnt(5)
  v_mfma_f32_16x16x32_bf16 v[40:43], v[168:171], v[192:195], v[40:43]
  ds_read_b128 v[180:183], v2 offset:3120
  v_add_u32 v7, 0xfffe3900, v3
  v_mfma_f32_16x16x32_bf16 v[44:47], v[168:171], v[196:199], v[44:47]
  ds_read_b128 v[184:187], v2 offset:5200
  v_mfma_f32_16x16x32_bf16 v[48:51], v[168:171], v[200:203], v[48:51]
  s_waitcnt lgkmcnt(6)
  v_mfma_f32_16x16x32_bf16 v[52:55], v[172:175], v[192:195], v[52:55]
  ds_read_b128 v[188:191], v2 offset:7280
  v_mfma_f32_16x16x32_bf16 v[56:59], v[172:175], v[196:199], v[56:59]
  v_mfma_f32_16x16x32_bf16 v[60:63], v[172:175], v[200:203], v[60:63]
  v_min_u32 v3, v7, v6
  v_add_u32 v2, v3, v5
  s_waitcnt lgkmcnt(5)
  v_mfma_f32_16x16x32_bf16 v[16:19], v[176:179], v[204:207], v[16:19]
  s_barrier
  ds_read_b128 v[160:163], v2 offset:0
  s_waitcnt lgkmcnt(5)
  v_mfma_f32_16x16x32_bf16 v[20:23], v[176:179], v[208:211], v[20:23]
  ds_read_b128 v[192:195], v3 offset:0
  s_waitcnt lgkmcnt(5)
  v_mfma_f32_16x16x32_bf16 v[24:27], v[176:179], v[212:215], v[24:27]
  s_waitcnt lgkmcnt(4)
  v_mfma_f32_16x16x32_bf16 v[28:31], v[180:183], v[204:207], v[28:31]
  ds_read_b128 v[196:199], v3 offset:2080
  v_mfma_f32_16x16x32_bf16 v[32:35], v[180:183], v[208:211], v[32:35]
  ds_read_b128 v[200:203], v3 offset:4160
  v_mfma_f32_16x16x32_bf16 v[36:39], v[180:183], v[212:215], v[36:39]
  s_waitcnt lgkmcnt(5)
  v_mfma_f32_16x16x32_bf16 v[40:43], v[184:187], v[204:207], v[40:43]
  ds_read_b128 v[164:167], v2 offset:2080
  v_mfma_f32_16x16x32_bf16 v[44:47], v[184:187], v[208:211], v[44:47]
  ds_read_b128 v[168:171], v2 offset:4160
  v_mfma_f32_16x16x32_bf16 v[48:51], v[184:187], v[212:215], v[48:51]
  s_waitcnt lgkmcnt(6)
  v_mfma_f32_16x16x32_bf16 v[52:55], v[188:191], v[204:207], v[52:55]
  ds_read_b128 v[172:175], v2 offset:6240
  v_mfma_f32_16x16x32_bf16 v[56:59], v[188:191], v[208:211], v[56:59]
  v_mfma_f32_16x16x32_bf16 v[60:63], v[188:191], v[212:215], v[60:63]
  s_waitcnt lgkmcnt(5)
  v_mfma_f32_16x16x32_bf16 v[16:19], v[160:163], v[192:195], v[16:19]
  ds_read_b128 v[176:179], v2 offset:1040
  v_add_u32 v6, 29120, v3
  s_waitcnt lgkmcnt(5)
  v_mfma_f32_16x16x32_bf16 v[20:23], v[160:163], v[196:199], v[20:23]
  ds_read_b128 v[204:207], v3 offset:1040
  s_waitcnt lgkmcnt(5)
  v_mfma_f32_16x16x32_bf16 v[24:27], v[160:163], v[200:203], v[24:27]
  v_add_u32 v7, 0xfffe3900, v3
  s_waitcnt lgkmcnt(4)
  v_mfma_f32_16x16x32_bf16 v[28:31], v[164:167], v[192:195], v[28:31]
  ds_read_b128 v[208:211], v3 offset:3120
  v_mfma_f32_16x16x32_bf16 v[32:35], v[164:167], v[196:199], v[32:35]
  ds_read_b128 v[212:215], v3 offset:5200
  v_mfma_f32_16x16x32_bf16 v[36:39], v[164:167], v[200:203], v[36:39]
  s_waitcnt lgkmcnt(5)
  v_mfma_f32_16x16x32_bf16 v[40:43], v[168:171], v[192:195], v[40:43]
  ds_read_b128 v[180:183], v2 offset:3120
  v_mfma_f32_16x16x32_bf16 v[44:47], v[168:171], v[196:199], v[44:47]
  ds_read_b128 v[184:187], v2 offset:5200
  v_mfma_f32_16x16x32_bf16 v[48:51], v[168:171], v[200:203], v[48:51]
  s_waitcnt lgkmcnt(6)
  v_mfma_f32_16x16x32_bf16 v[52:55], v[172:175], v[192:195], v[52:55]
  ds_read_b128 v[188:191], v2 offset:7280
  v_mfma_f32_16x16x32_bf16 v[56:59], v[172:175], v[196:199], v[56:59]
  s_waitcnt vmcnt(0)
  v_mfma_f32_16x16x32_bf16 v[60:63], v[172:175], v[200:203], v[60:63]
  v_min_u32 v3, v7, v6
  v_add_u32 v2, v3, v5
  s_waitcnt lgkmcnt(5)
  v_mfma_f32_16x16x32_bf16 v[16:19], v[176:179], v[204:207], v[16:19]
  s_barrier
  ds_read_b128 v[160:163], v2 offset:0
  s_sub_u32 s94, s94, 1
  s_waitcnt lgkmcnt(5)
  v_mfma_f32_16x16x32_bf16 v[20:23], v[176:179], v[208:211], v[20:23]
  ds_read_b128 v[192:195], v3 offset:0
  s_waitcnt lgkmcnt(5)
  v_mfma_f32_16x16x32_bf16 v[24:27], v[176:179], v[212:215], v[24:27]
  s_waitcnt lgkmcnt(4)
  v_mfma_f32_16x16x32_bf16 v[28:31], v[180:183], v[204:207], v[28:31]
  ds_read_b128 v[196:199], v3 offset:2080
  v_mfma_f32_16x16x32_bf16 v[32:35], v[180:183], v[208:211], v[32:35]
  ds_read_b128 v[200:203], v3 offset:4160
  v_mfma_f32_16x16x32_bf16 v[36:39], v[180:183], v[212:215], v[36:39]
  s_waitcnt lgkmcnt(5)
  v_mfma_f32_16x16x32_bf16 v[40:43], v[184:187], v[204:207], v[40:43]
  ds_read_b128 v[164:167], v2 offset:2080
  s_cmp_lg_u32 s94, 0
  v_mfma_f32_16x16x32_bf16 v[44:47], v[184:187], v[208:211], v[44:47]
  ds_read_b128 v[168:171], v2 offset:4160
  v_mfma_f32_16x16x32_bf16 v[48:51], v[184:187], v[212:215], v[48:51]
  s_waitcnt lgkmcnt(6)
  v_mfma_f32_16x16x32_bf16 v[52:55], v[188:191], v[204:207], v[52:55]
  ds_read_b128 v[172:175], v2 offset:6240
  v_mfma_f32_16x16x32_bf16 v[56:59], v[188:191], v[208:211], v[56:59]
  v_mfma_f32_16x16x32_bf16 v[60:63], v[188:191], v[212:215], v[60:63]
  s_cbranch_scc1 L_kk_l
  s_waitcnt lgkmcnt(0)
  s_nop 6
  s_setpc_b64 s[86:87]
L_softmax:
  s_cmp_lg_u32 s61, 8
  s_cbranch_scc1 L_sm_go
  s_cmp_lg_u32 s90, 0
  s_cbranch_scc1 L_sm_ret
  v_mov_b32 v40, 0xff800000
  v_mov_b32 v41, 0xff800000
  v_mov_b32 v42, 0xff800000
  v_mov_b32 v43, 0xff800000
  v_mov_b32 v44, 0xff800000
  v_mov_b32 v45, 0xff800000
  v_mov_b32 v46, 0xff800000
  v_mov_b32 v47, 0xff800000
  v_mov_b32 v48, 0xff800000
  v_mov_b32 v49, 0xff800000
  v_mov_b32 v50, 0xff800000
  v_mov_b32 v51, 0xff800000
  v_mov_b32 v52, 0xff800000
  v_mov_b32 v53, 0xff800000
  v_mov_b32 v54, 0xff800000
  v_mov_b32 v55, 0xff800000
  v_mov_b32 v56, 0xff800000
  v_mov_b32 v57, 0xff800000
  v_mov_b32 v58, 0xff800000
  v_mov_b32 v59, 0xff800000
  v_mov_b32 v60, 0xff800000
  v_mov_b32 v61, 0xff800000
  v_mov_b32 v62, 0xff800000
  v_mov_b32 v63, 0xff800000
L_sm_go:
  v_max_f32 v64, v16, v17
  v_max_f32 v65, v20, v21
  v_max_f32 v66, v24, v25
  v_max3_f32 v64, v64, v18, v19
  v_max3_f32 v65, v65, v22, v23
  v_max3_f32 v66, v66, v26, v27
  v_max3_f32 v64, v64, v28, v29
  v_max3_f32 v65, v65, v32, v33
  v_max3_f32 v66, v66, v36, v37
  v_max3_f32 v64, v64, v30, v31
  v_max3_f32 v65, v65, v34, v35
  v_max3_f32 v66, v66, v38, v39
  v_max3_f32 v64, v64, v40, v41
  v_max3_f32 v65, v65, v44, v45
  v_max3_f32 v66, v66, v48, v49
  v_max3_f32 v64, v64, v42, v43
  v_max3_f32 v65, v65, v46, v47
  v_max3_f32 v66, v66, v50, v51
  v_max3_f32 v64, v64, v52, v53
  v_max3_f32 v65, v65, v56, v57
  v_max3_f32 v66, v66, v60, v61
  v_max3_f32 v64, v64, v54, v55
  v_max3_f32 v65, v65, v58, v59
  v_max3_f32 v66, v66, v62, v63
  v_mov_b32 v67, v64
  v_mov_b32 v68, v65
  v_mov_b32 v69, v66
  s_nop 1
  v_permlane16_swap_b32 v64, v67
  v_permlane16_swap_b32 v65, v68
  v_permlane16_swap_b32 v66, v69
  v_max_f32 v64, v64, v67
  v_max_f32 v65, v65, v68
  v_max_f32 v66, v66, v69
  v_mov_b32 v67, v64
  v_mov_b32 v68, v65
  v_mov_b32 v69, v66
  s_nop 1
  v_permlane32_swap_b32 v64, v67
  v_permlane32_swap_b32 v65, v68
  v_permlane32_swap_b32 v66, v69
  v_max_f32 v64, v64, v67
  v_max_f32 v65, v65, v68
  v_max_f32 v66, v66, v69
  s_cmp_eq_u32 s61, 8
  s_cbranch_scc1 L_sm_x
  s_mul_i32 s92, s3, 768
  s_add_u32 s92, s92, 145600
  v_lshl_add_u32 v74, v1, 2, s92
  ds_write_b32 v74, v64 offset:0
  ds_write_b32 v74, v65 offset:256
  ds_write_b32 v74, v66 offset:512
  s_lshl_b32 s92, s91, 2
  s_add_u32 s92, s92, 163576
  v_mov_b32 v75, s92
  s_mov_b64 exec, 1
  ds_add_u32 v75, v12
  s_mov_b64 exec, -1
  s_xor_b32 s92, s3, 2
  s_mul_i32 s92, s92, 768
  s_add_u32 s92, s92, 145600
  v_lshl_add_u32 v74, v1, 2, s92
  s_mov_b32 s74, 16777216
L_lw_10002:
  ds_read_b32 v76, v75
  s_waitcnt lgkmcnt(0)
  v_cmp_le_u32 vcc, 2, v76
  s_cbranch_vccnz L_lw_10002_d
  s_sub_u32 s74, s74, 1
  s_cmp_lg_u32 s74, 0
  s_cbranch_scc1 L_lw_10002
L_lw_10002_d:
  ds_read_b32 v67, v74 offset:0
  ds_read_b32 v68, v74 offset:256
  ds_read_b32 v69, v74 offset:512
  s_waitcnt lgkmcnt(0)
  v_max_f32 v64, v64, v67
  v_max_f32 v65, v65, v68
  v_max_f32 v66, v66, v69
L_sm_x:
  s_mov_b32 s92, 0x3d2e1a93
  v_mul_f32 v64, s92, v64
  v_mov_b32 v78, s92
  v_mul_f32 v65, s92, v65
  v_mov_b32 v80, s92
  v_mul_f32 v66, s92, v66
  v_mov_b32 v82, s92
  v_sub_f32 v79, 0, v64
  v_sub_f32 v81, 0, v65
  v_sub_f32 v83, 0, v66
  v_add_u32 v246, 36864, v10
  v_add_u32 v247, 73728, v10
  v_pk_fma_f32 v[16:17], v[16:17], v[78:79], v[78:79] op_sel:[0,0,1] op_sel_hi:[1,0,1]
  v_pk_fma_f32 v[18:19], v[18:19], v[78:79], v[78:79] op_sel:[0,0,1] op_sel_hi:[1,0,1]
  v_pk_fma_f32 v[28:29], v[28:29], v[78:79], v[78:79] op_sel:[0,0,1] op_sel_hi:[1,0,1]
  v_pk_fma_f32 v[30:31], v[30:31], v[78:79], v[78:79] op_sel:[0,0,1] op_sel_hi:[1,0,1]
  v_pk_fma_f32 v[40:41], v[40:41], v[78:79], v[78:79] op_sel:[0,0,1] op_sel_hi:[1,0,1]
  v_pk_fma_f32 v[42:43], v[42:43], v[78:79], v[78:79] op_sel:[0,0,1] op_sel_hi:[1,0,1]
  v_pk_fma_f32 v[52:53], v[52:53], v[78:79], v[78:79] op_sel:[0,0,1] op_sel_hi:[1,0,1]
  v_pk_fma_f32 v[54:55], v[54:55], v[78:79], v[78:79] op_sel:[0,0,1] op_sel_hi:[1,0,1]
  v_exp_f32 v16, v16
  v_exp_f32 v17, v17
  v_exp_f32 v18, v18
  v_exp_f32 v19, v19
  v_exp_f32 v28, v28
  v_exp_f32 v29, v29
  v_exp_f32 v30, v30
  v_exp_f32 v31, v31
  v_exp_f32 v40, v40
  v_exp_f32 v41, v41
  v_exp_f32 v42, v42
  v_exp_f32 v43, v43
  v_exp_f32 v52, v52
  v_exp_f32 v53, v53
  v_exp_f32 v54, v54
  v_exp_f32 v55, v55
  v_cvt_pk_bf16_f32 v160, v16, v17
  v_cvt_pk_bf16_f32 v161, v18, v19
  v_cvt_pk_bf16_f32 v162, v28, v29
  v_cvt_pk_bf16_f32 v163, v30, v31
  v_cvt_pk_bf16_f32 v164, v40, v41
  v_cvt_pk_bf16_f32 v165, v42, v43
  v_cvt_pk_bf16_f32 v166, v52, v53
  v_cvt_pk_bf16_f32 v167, v54, v55
  v_pk_add_f32 v[78:79], v[16:17], v[18:19]
  v_permlane16_swap_b32 v160, v162
  v_permlane16_swap_b32 v161, v163
  buffer_store_dwordx4 v[160:163], v10, s[4:7], 0 offen offset:0 sc1
  v_permlane16_swap_b32 v164, v166
  v_permlane16_swap_b32 v165, v167
  buffer_store_dwordx4 v[164:167], v10, s[4:7], 0 offen offset:1024 sc1
  v_pk_fma_f32 v[20:21], v[20:21], v[80:81], v[80:81] op_sel:[0,0,1] op_sel_hi:[1,0,1]
  v_pk_fma_f32 v[22:23], v[22:23], v[80:81], v[80:81] op_sel:[0,0,1] op_sel_hi:[1,0,1]
  v_pk_fma_f32 v[32:33], v[32:33], v[80:81], v[80:81] op_sel:[0,0,1] op_sel_hi:[1,0,1]
  v_pk_fma_f32 v[34:35], v[34:35], v[80:81], v[80:81] op_sel:[0,0,1] op_sel_hi:[1,0,1]
  v_pk_fma_f32 v[44:45], v[44:45], v[80:81], v[80:81] op_sel:[0,0,1] op_sel_hi:[1,0,1]
  v_pk_fma_f32 v[46:47], v[46:47], v[80:81], v[80:81] op_sel:[0,0,1] op_sel_hi:[1,0,1]
  v_pk_fma_f32 v[56:57], v[56:57], v[80:81], v[80:81] op_sel:[0,0,1] op_sel_hi:[1,0,1]
  v_pk_fma_f32 v[58:59], v[58:59], v[80:81], v[80:81] op_sel:[0,0,1] op_sel_hi:[1,0,1]
  v_exp_f32 v20, v20
  v_exp_f32 v21, v21
  v_exp_f32 v22, v22
  v_exp_f32 v23, v23
  v_exp_f32 v32, v32
  v_exp_f32 v33, v33
  v_exp_f32 v34, v34
  v_exp_f32 v35, v35
  v_exp_f32 v44, v44
  v_exp_f32 v45, v45
  v_exp_f32 v46, v46
  v_exp_f32 v47, v47
  v_exp_f32 v56, v56
  v_exp_f32 v57, v57
  v_exp_f32 v58, v58
  v_exp_f32 v59, v59
  v_cvt_pk_bf16_f32 v168, v20, v21
  v_cvt_pk_bf16_f32 v169, v22, v23
  v_cvt_pk_bf16_f32 v170, v32, v33
  v_cvt_pk_bf16_f32 v171, v34, v35
  v_cvt_pk_bf16_f32 v172, v44, v45
  v_cvt_pk_bf16_f32 v173, v46, v47
  v_cvt_pk_bf16_f32 v174, v56, v57
  v_cvt_pk_bf16_f32 v175, v58, v59
  v_pk_add_f32 v[80:81], v[20:21], v[22:23]
  v_permlane16_swap_b32 v168, v170
  v_permlane16_swap_b32 v169, v171
  buffer_store_dwordx4 v[168:171], v246, s[4:7], 0 offen offset:0 sc1
  v_permlane16_swap_b32 v172, v174
  v_permlane16_swap_b32 v173, v175
  buffer_store_dwordx4 v[172:175], v246, s[4:7], 0 offen offset:1024 sc1
  v_pk_fma_f32 v[24:25], v[24:25], v[82:83], v[82:83] op_sel:[0,0,1] op_sel_hi:[1,0,1]
  v_pk_fma_f32 v[26:27], v[26:27], v[82:83], v[82:83] op_sel:[0,0,1] op_sel_hi:[1,0,1]
  v_pk_fma_f32 v[36:37], v[36:37], v[82:83], v[82:83] op_sel:[0,0,1] op_sel_hi:[1,0,1]
  v_pk_fma_f32 v[38:39], v[38:39], v[82:83], v[82:83] op_sel:[0,0,1] op_sel_hi:[1,0,1]
  v_pk_fma_f32 v[48:49], v[48:49], v[82:83], v[82:83] op_sel:[0,0,1] op_sel_hi:[1,0,1]
  v_pk_fma_f32 v[50:51], v[50:51], v[82:83], v[82:83] op_sel:[0,0,1] op_sel_hi:[1,0,1]
  v_pk_fma_f32 v[60:61], v[60:61], v[82:83], v[82:83] op_sel:[0,0,1] op_sel_hi:[1,0,1]
  v_pk_fma_f32 v[62:63], v[62:63], v[82:83], v[82:83] op_sel:[0,0,1] op_sel_hi:[1,0,1]
  v_exp_f32 v24, v24
  v_exp_f32 v25, v25
  v_exp_f32 v26, v26
  v_exp_f32 v27, v27
  v_exp_f32 v36, v36
  v_exp_f32 v37, v37
  v_exp_f32 v38, v38
  v_exp_f32 v39, v39
  v_exp_f32 v48, v48
  v_exp_f32 v49, v49
  v_exp_f32 v50, v50
  v_exp_f32 v51, v51
  v_exp_f32 v60, v60
  v_exp_f32 v61, v61
  v_exp_f32 v62, v62
  v_exp_f32 v63, v63
  v_cvt_pk_bf16_f32 v176, v24, v25
  v_cvt_pk_bf16_f32 v177, v26, v27
  v_cvt_pk_bf16_f32 v178, v36, v37
  v_cvt_pk_bf16_f32 v179, v38, v39
  v_cvt_pk_bf16_f32 v180, v48, v49
  v_cvt_pk_bf16_f32 v181, v50, v51
  v_cvt_pk_bf16_f32 v182, v60, v61
  v_cvt_pk_bf16_f32 v183, v62, v63
  v_pk_add_f32 v[82:83], v[24:25], v[26:27]
  v_permlane16_swap_b32 v176, v178
  v_permlane16_swap_b32 v177, v179
  buffer_store_dwordx4 v[176:179], v247, s[4:7], 0 offen offset:0 sc1
  v_permlane16_swap_b32 v180, v182
  v_permlane16_swap_b32 v181, v183
  buffer_store_dwordx4 v[180:183], v247, s[4:7], 0 offen offset:1024 sc1
  v_pk_add_f32 v[78:79], v[78:79], v[28:29]
  v_pk_add_f32 v[80:81], v[80:81], v[32:33]
  v_pk_add_f32 v[82:83], v[82:83], v[36:37]
  v_pk_add_f32 v[78:79], v[78:79], v[30:31]
  v_pk_add_f32 v[80:81], v[80:81], v[34:35]
  v_pk_add_f32 v[82:83], v[82:83], v[38:39]
  v_pk_add_f32 v[78:79], v[78:79], v[40:41]
  v_pk_add_f32 v[80:81], v[80:81], v[44:45]
  v_pk_add_f32 v[82:83], v[82:83], v[48:49]
  v_pk_add_f32 v[78:79], v[78:79], v[42:43]
  v_pk_add_f32 v[80:81], v[80:81], v[46:47]
  v_pk_add_f32 v[82:83], v[82:83], v[50:51]
  v_pk_add_f32 v[78:79], v[78:79], v[52:53]
  v_pk_add_f32 v[80:81], v[80:81], v[56:57]
  v_pk_add_f32 v[82:83], v[82:83], v[60:61]
  v_pk_add_f32 v[78:79], v[78:79], v[54:55]
  v_pk_add_f32 v[80:81], v[80:81], v[58:59]
  v_pk_add_f32 v[82:83], v[82:83], v[62:63]
  v_add_f32 v70, v78, v79
  v_add_f32 v71, v80, v81
  v_add_f32 v72, v82, v83
  v_mov_b32 v67, v70
  v_mov_b32 v68, v71
  v_mov_b32 v69, v72
  s_nop 1
  v_permlane16_swap_b32 v70, v67
  v_permlane16_swap_b32 v71, v68
  v_permlane16_swap_b32 v72, v69
  v_add_f32 v70, v70, v67
  v_add_f32 v71, v71, v68
  v_add_f32 v72, v72, v69
  v_mov_b32 v67, v70
  v_mov_b32 v68, v71
  v_mov_b32 v69, v72
  s_nop 1
  v_permlane32_swap_b32 v70, v67
  v_permlane32_swap_b32 v71, v68
  v_permlane32_swap_b32 v72, v69
  v_add_f32 v70, v70, v67
  v_add_f32 v71, v71, v68
  v_add_f32 v72, v72, v69
  s_mul_i32 s92, s91, 48
  v_add_lshl_u32 v67, v1, s92, 3
  v_mov_b32 v74, v64
  v_mov_b32 v75, v70
  s_mov_b64 exec, 0xffff0000
  s_mov_b32 exec_hi, 0
  v_mov_b32 v74, v65
  v_mov_b32 v75, v71
  s_mov_b32 exec_lo, 0
  s_mov_b32 exec_hi, 0xffff
  v_mov_b32 v74, v66
  v_mov_b32 v75, v72
  s_mov_b32 exec_lo, -1
  buffer_store_dwordx2 v[74:75], v67, s[28:31], 0 offen sc1
  s_mov_b64 exec, -1
L_sm_ret:
  s_setpc_b64 s[86:87]
L_pv:
  v_add_u32 v3, v3, v14
  v_sub_u32 v4, v4, v14
  v_mov_b32 v14, 0
  v_add_u32 v2, v3, v4
  v_mov_b32 v16, 0
  v_mov_b32 v17, 0
  v_mov_b32 v18, 0
  v_mov_b32 v19, 0
  v_mov_b32 v20, 0
  v_mov_b32 v21, 0
  v_mov_b32 v22, 0
  v_mov_b32 v23, 0
  v_mov_b32 v24, 0
  v_mov_b32 v25, 0
  v_mov_b32 v26, 0
  v_mov_b32 v27, 0
  v_mov_b32 v28, 0
  v_mov_b32 v29, 0
  v_mov_b32 v30, 0
  v_mov_b32 v31, 0
  v_mov_b32 v32, 0
  v_mov_b32 v33, 0
  v_mov_b32 v34, 0
  v_mov_b32 v35, 0
  v_mov_b32 v36, 0
  v_mov_b32 v37, 0
  v_mov_b32 v38, 0
  v_mov_b32 v39, 0
  v_mov_b32 v40, 0
  v_mov_b32 v41, 0
  v_mov_b32 v42, 0
  v_mov_b32 v43, 0
  v_mov_b32 v44, 0
  v_mov_b32 v45, 0
  v_mov_b32 v46, 0
  v_mov_b32 v47, 0
  v_mov_b32 v48, 0
  v_mov_b32 v49, 0
  v_mov_b32 v50, 0
  v_mov_b32 v51, 0
  v_mov_b32 v52, 0
  v_mov_b32 v53, 0
  v_mov_b32 v54, 0
  v_mov_b32 v55, 0
  v_mov_b32 v56, 0
  v_mov_b32 v57, 0
  v_mov_b32 v58, 0
  v_mov_b32 v59, 0
  v_mov_b32 v60, 0
  v_mov_b32 v61, 0
  v_mov_b32 v62, 0
  v_mov_b32 v63, 0
  v_mov_b32 v112, 0
  v_mov_b32 v113, 0
  v_mov_b32 v114, 0
  v_mov_b32 v115, 0
  v_mov_b32 v116, 0
  v_mov_b32 v117, 0
  v_mov_b32 v118, 0
  v_mov_b32 v119, 0
  v_mov_b32 v120, 0
  v_mov_b32 v121, 0
  v_mov_b32 v122, 0
  v_mov_b32 v123, 0
  v_mov_b32 v124, 0
  v_mov_b32 v125, 0
  v_mov_b32 v126, 0
  v_mov_b32 v127, 0
  v_mov_b32 v128, 0
  v_mov_b32 v129, 0
  v_mov_b32 v130, 0
  v_mov_b32 v131, 0
  v_mov_b32 v132, 0
  v_mov_b32 v133, 0
  v_mov_b32 v134, 0
  v_mov_b32 v135, 0
  v_mov_b32 v136, 0
  v_mov_b32 v137, 0
  v_mov_b32 v138, 0
  v_mov_b32 v139, 0
  v_mov_b32 v140, 0
  v_mov_b32 v141, 0
  v_mov_b32 v142, 0
  v_mov_b32 v143, 0
  v_mov_b32 v144, 0
  v_mov_b32 v145, 0
  v_mov_b32 v146, 0
  v_mov_b32 v147, 0
  v_mov_b32 v148, 0
  v_mov_b32 v149, 0
  v_mov_b32 v150, 0
  v_mov_b32 v151, 0
  v_mov_b32 v152, 0
  v_mov_b32 v153, 0
  v_mov_b32 v154, 0
  v_mov_b32 v155, 0
  v_mov_b32 v156, 0
  v_mov_b32 v157, 0
  v_mov_b32 v158, 0
  v_mov_b32 v159, 0
  v_and_b32 v251, 15, v1
  s_mul_i32 s92, s91, 1728
  s_add_u32 s92, s92, 149696
  v_lshl_add_u32 v251, v251, 2, s92
  v_mov_b32 v252, 163584
  s_waitcnt lgkmcnt(0)
  s_barrier
  ds_read_b64_tr_b16 v[160:161], v2 offset:0
  ds_read_b64_tr_b16 v[162:163], v2 offset:1040
  ds_read_b128 v[192:195], v3 offset:0
  ds_read_b128 v[196:199], v3 offset:2080
  ds_read_b128 v[200:203], v3 offset:4160
  ds_read_b64_tr_b16 v[164:165], v2 offset:32
  ds_read_b64_tr_b16 v[166:167], v2 offset:1072
  ds_read_b64_tr_b16 v[168:169], v2 offset:256
  ds_read_b64_tr_b16 v[170:171], v2 offset:1296
  ds_read_b64_tr_b16 v[172:173], v2 offset:288
  ds_read_b64_tr_b16 v[174:175], v2 offset:1328
  s_mov_b32 s94, 4
  .p2align 6
L_pv_l:
  s_waitcnt lgkmcnt(8)
  v_mfma_f32_16x16x32_bf16 v[64:67], v[160:163], v[192:195], 0
  ds_read_b64_tr_b16 v[176:177], v2 offset:8320
  v_add_u32 v6, 29120, v3
  s_waitcnt lgkmcnt(8)
  v_mfma_f32_16x16x32_bf16 v[68:71], v[160:163], v[196:199], 0
  ds_read_b64_tr_b16 v[178:179], v2 offset:9360
  s_waitcnt lgkmcnt(8)
  v_mfma_f32_16x16x32_bf16 v[72:75], v[160:163], v[200:203], 0
  ds_read_b128 v[204:207], v3 offset:1040
  s_waitcnt lgkmcnt(7)
  v_mfma_f32_16x16x32_bf16 v[76:79], v[164:167], v[192:195], 0
  ds_read_b128 v[208:211], v3 offset:3120
  v_mfma_f32_16x16x32_bf16 v[80:83], v[164:167], v[196:199], 0
  ds_read_b128 v[212:215], v3 offset:5200
  v_mfma_f32_16x16x32_bf16 v[84:87], v[164:167], v[200:203], 0
  ds_read_b64_tr_b16 v[180:181], v2 offset:8352
  s_waitcnt lgkmcnt(8)
  v_mfma_f32_16x16x32_bf16 v[88:91], v[168:171], v[192:195], 0
  ds_read_b64_tr_b16 v[182:183], v2 offset:9392
  v_add_u32 v7, 0xfffe3900, v3
  v_mfma_f32_16x16x32_bf16 v[92:95], v[168:171], v[196:199], 0
  ds_read_b64_tr_b16 v[184:185], v2 offset:8576
  v_mfma_f32_16x16x32_bf16 v[96:99], v[168:171], v[200:203], 0
  ds_read_b64_tr_b16 v[186:187], v2 offset:9616
  s_waitcnt lgkmcnt(9)
  v_mfma_f32_16x16x32_bf16 v[100:103], v[172:175], v[192:195], 0
  ds_read_b64_tr_b16 v[188:189], v2 offset:8608
  v_mfma_f32_16x16x32_bf16 v[104:107], v[172:175], v[196:199], 0
  ds_read_b64_tr_b16 v[190:191], v2 offset:9648
  v_mfma_f32_16x16x32_bf16 v[108:111], v[172:175], v[200:203], 0
  v_min_u32 v3, v7, v6
  v_add_u32 v2, v3, v4
  s_waitcnt lgkmcnt(8)
  v_mfma_f32_16x16x32_bf16 v[64:67], v[176:179], v[204:207], v[64:67]
  s_barrier
  ds_read_b64_tr_b16 v[160:161], v2 offset:0
  ds_read_b32 v248, v252 offset:0
  ds_read_b32 v249, v252 offset:64
  s_waitcnt lgkmcnt(10)
  v_mfma_f32_16x16x32_bf16 v[68:71], v[176:179], v[208:211], v[68:71]
  ds_read_b64_tr_b16 v[162:163], v2 offset:1040
  ds_read_b32 v250, v252 offset:128
  s_waitcnt lgkmcnt(11)
  v_mfma_f32_16x16x32_bf16 v[72:75], v[176:179], v[212:215], v[72:75]
  ds_read_b128 v[192:195], v3 offset:0
  v_mov_b32 v252, v251
  v_add_u32 v251, 192, v251
  s_waitcnt lgkmcnt(10)
  v_mfma_f32_16x16x32_bf16 v[76:79], v[180:183], v[204:207], v[76:79]
  ds_read_b128 v[196:199], v3 offset:2080
  v_mfma_f32_16x16x32_bf16 v[80:83], v[180:183], v[208:211], v[80:83]
  ds_read_b128 v[200:203], v3 offset:4160
  v_mfma_f32_16x16x32_bf16 v[84:87], v[180:183], v[212:215], v[84:87]
  ds_read_b64_tr_b16 v[164:165], v2 offset:32
  s_waitcnt lgkmcnt(7)
  v_fmac_f32 v16, v112, v248
  v_mfma_f32_16x16x32_bf16 v[88:91], v[184:187], v[204:207], v[88:91]
  ds_read_b64_tr_b16 v[166:167], v2 offset:1072
  v_fmac_f32 v17, v113, v248
  v_fmac_f32 v18, v114, v248
  v_mfma_f32_16x16x32_bf16 v[92:95], v[184:187], v[208:211], v[92:95]
  ds_read_b64_tr_b16 v[168:169], v2 offset:256
  v_fmac_f32 v19, v115, v248
  v_mfma_f32_16x16x32_bf16 v[96:99], v[184:187], v[212:215], v[96:99]
  ds_read_b64_tr_b16 v[170:171], v2 offset:1296
  s_waitcnt lgkmcnt(9)
  v_fmac_f32 v20, v116, v249
  v_fmac_f32 v21, v117, v249
  v_mfma_f32_16x16x32_bf16 v[100:103], v[188:191], v[204:207], v[100:103]
  ds_read_b64_tr_b16 v[172:173], v2 offset:288
  v_fmac_f32 v22, v118, v249
  v_mfma_f32_16x16x32_bf16 v[104:107], v[188:191], v[208:211], v[104:107]
  ds_read_b64_tr_b16 v[174:175], v2 offset:1328
  v_fmac_f32 v23, v119, v249
  s_waitcnt lgkmcnt(9)
  v_fmac_f32 v24, v120, v250
  v_mfma_f32_16x16x32_bf16 v[108:111], v[188:191], v[212:215], v[108:111]
  v_fmac_f32 v25, v121, v250
  s_waitcnt lgkmcnt(8)
  v_mfma_f32_16x16x32_bf16 v[64:67], v[160:163], v[192:195], v[64:67]
  ds_read_b64_tr_b16 v[176:177], v2 offset:8320
  v_add_u32 v6, 29120, v3
  v_add_u32 v7, 0xfffe3900, v3
  s_waitcnt lgkmcnt(8)
  v_mfma_f32_16x16x32_bf16 v[68:71], v[160:163], v[196:199], v[68:71]
  ds_read_b64_tr_b16 v[178:179], v2 offset:9360
  v_fmac_f32 v26, v122, v250
  v_fmac_f32 v27, v123, v250
  s_waitcnt lgkmcnt(8)
  v_mfma_f32_16x16x32_bf16 v[72:75], v[160:163], v[200:203], v[72:75]
  ds_read_b128 v[204:207], v3 offset:1040
  v_fmac_f32 v28, v124, v248
  s_waitcnt lgkmcnt(7)
  v_mfma_f32_16x16x32_bf16 v[76:79], v[164:167], v[192:195], v[76:79]
  ds_read_b128 v[208:211], v3 offset:3120
  v_fmac_f32 v29, v125, v248
  v_fmac_f32 v30, v126, v248
  v_mfma_f32_16x16x32_bf16 v[80:83], v[164:167], v[196:199], v[80:83]
  ds_read_b128 v[212:215], v3 offset:5200
  v_fmac_f32 v31, v127, v248
  v_fmac_f32 v32, v128, v249
  v_mfma_f32_16x16x32_bf16 v[84:87], v[164:167], v[200:203], v[84:87]
  ds_read_b64_tr_b16 v[180:181], v2 offset:8352
  v_fmac_f32 v33, v129, v249
  s_waitcnt lgkmcnt(8)
  v_mfma_f32_16x16x32_bf16 v[88:91], v[168:171], v[192:195], v[88:91]
  ds_read_b64_tr_b16 v[182:183], v2 offset:9392
  v_fmac_f32 v34, v130, v249
  v_fmac_f32 v35, v131, v249
  v_mfma_f32_16x16x32_bf16 v[92:95], v[168:171], v[196:199], v[92:95]
  ds_read_b64_tr_b16 v[184:185], v2 offset:8576
  v_fmac_f32 v36, v132, v250
  v_fmac_f32 v37, v133, v250
  v_mfma_f32_16x16x32_bf16 v[96:99], v[168:171], v[200:203], v[96:99]
  ds_read_b64_tr_b16 v[186:187], v2 offset:9616
  v_fmac_f32 v38, v134, v250
  s_waitcnt lgkmcnt(9)
  v_mfma_f32_16x16x32_bf16 v[100:103], v[172:175], v[192:195], v[100:103]
  ds_read_b64_tr_b16 v[188:189], v2 offset:8608
  v_fmac_f32 v39, v135, v250
  v_fmac_f32 v40, v136, v248
  v_mfma_f32_16x16x32_bf16 v[104:107], v[172:175], v[196:199], v[104:107]
  ds_read_b64_tr_b16 v[190:191], v2 offset:9648
  v_fmac_f32 v41, v137, v248
  v_fmac_f32 v42, v138, v248
  v_mfma_f32_16x16x32_bf16 v[108:111], v[172:175], v[200:203], v[108:111]
  v_fmac_f32 v43, v139, v248
  v_min_u32 v3, v7, v6
  v_add_u32 v2, v3, v4
  s_waitcnt lgkmcnt(8)
  v_mfma_f32_16x16x32_bf16 v[64:67], v[176:179], v[204:207], v[64:67]
  s_barrier
  ds_read_b64_tr_b16 v[160:161], v2 offset:0
  v_fmac_f32 v44, v140, v249
  v_fmac_f32 v45, v141, v249
  s_waitcnt lgkmcnt(8)
  v_mfma_f32_16x16x32_bf16 v[68:71], v[176:179], v[208:211], v[68:71]
  ds_read_b64_tr_b16 v[162:163], v2 offset:1040
  v_fmac_f32 v46, v142, v249
  v_fmac_f32 v47, v143, v249
  s_waitcnt lgkmcnt(8)
  v_mfma_f32_16x16x32_bf16 v[72:75], v[176:179], v[212:215], v[72:75]
  ds_read_b128 v[192:195], v3 offset:0
  v_fmac_f32 v48, v144, v250
  s_waitcnt lgkmcnt(7)
  v_mfma_f32_16x16x32_bf16 v[76:79], v[180:183], v[204:207], v[76:79]
  ds_read_b128 v[196:199], v3 offset:2080
  v_fmac_f32 v49, v145, v250
  v_fmac_f32 v50, v146, v250
  v_mfma_f32_16x16x32_bf16 v[80:83], v[180:183], v[208:211], v[80:83]
  ds_read_b128 v[200:203], v3 offset:4160
  v_fmac_f32 v51, v147, v250
  v_fmac_f32 v52, v148, v248
  v_mfma_f32_16x16x32_bf16 v[84:87], v[180:183], v[212:215], v[84:87]
  ds_read_b64_tr_b16 v[164:165], v2 offset:32
  v_fmac_f32 v53, v149, v248
  s_waitcnt lgkmcnt(8)
  v_mfma_f32_16x16x32_bf16 v[88:91], v[184:187], v[204:207], v[88:91]
  ds_read_b64_tr_b16 v[166:167], v2 offset:1072
  v_fmac_f32 v54, v150, v248
  v_fmac_f32 v55, v151, v248
  v_mfma_f32_16x16x32_bf16 v[92:95], v[184:187], v[208:211], v[92:95]
  ds_read_b64_tr_b16 v[168:169], v2 offset:256
  v_fmac_f32 v56, v152, v249
  v_fmac_f32 v57, v153, v249
  v_mfma_f32_16x16x32_bf16 v[96:99], v[184:187], v[212:215], v[96:99]
  ds_read_b64_tr_b16 v[170:171], v2 offset:1296
  v_fmac_f32 v58, v154, v249
  s_waitcnt lgkmcnt(9)
  v_mfma_f32_16x16x32_bf16 v[100:103], v[188:191], v[204:207], v[100:103]
  ds_read_b64_tr_b16 v[172:173], v2 offset:288
  v_fmac_f32 v59, v155, v249
  v_fmac_f32 v60, v156, v250
  v_mfma_f32_16x16x32_bf16 v[104:107], v[188:191], v[208:211], v[104:107]
  ds_read_b64_tr_b16 v[174:175], v2 offset:1328
  v_fmac_f32 v61, v157, v250
  v_fmac_f32 v62, v158, v250
  v_mfma_f32_16x16x32_bf16 v[108:111], v[188:191], v[212:215], v[108:111]
  v_fmac_f32 v63, v159, v250
  s_waitcnt lgkmcnt(8)
  v_mfma_f32_16x16x32_bf16 v[112:115], v[160:163], v[192:195], 0
  ds_read_b64_tr_b16 v[176:177], v2 offset:8320
  v_add_u32 v6, 29120, v3
  s_waitcnt lgkmcnt(8)
  v_mfma_f32_16x16x32_bf16 v[116:119], v[160:163], v[196:199], 0
  ds_read_b64_tr_b16 v[178:179], v2 offset:9360
  s_waitcnt lgkmcnt(8)
  v_mfma_f32_16x16x32_bf16 v[120:123], v[160:163], v[200:203], 0
  ds_read_b128 v[204:207], v3 offset:1040
  s_waitcnt lgkmcnt(7)
  v_mfma_f32_16x16x32_bf16 v[124:127], v[164:167], v[192:195], 0
  ds_read_b128 v[208:211], v3 offset:3120
  v_mfma_f32_16x16x32_bf16 v[128:131], v[164:167], v[196:199], 0
  ds_read_b128 v[212:215], v3 offset:5200
  v_mfma_f32_16x16x32_bf16 v[132:135], v[164:167], v[200:203], 0
  ds_read_b64_tr_b16 v[180:181], v2 offset:8352
  s_waitcnt lgkmcnt(8)
  v_mfma_f32_16x16x32_bf16 v[136:139], v[168:171], v[192:195], 0
  ds_read_b64_tr_b16 v[182:183], v2 offset:9392
  v_add_u32 v7, 0xfffe3900, v3
  v_mfma_f32_16x16x32_bf16 v[140:143], v[168:171], v[196:199], 0
  ds_read_b64_tr_b16 v[184:185], v2 offset:8576
  v_mfma_f32_16x16x32_bf16 v[144:147], v[168:171], v[200:203], 0
  ds_read_b64_tr_b16 v[186:187], v2 offset:9616
  s_waitcnt lgkmcnt(9)
  v_mfma_f32_16x16x32_bf16 v[148:151], v[172:175], v[192:195], 0
  ds_read_b64_tr_b16 v[188:189], v2 offset:8608
  v_mfma_f32_16x16x32_bf16 v[152:155], v[172:175], v[196:199], 0
  ds_read_b64_tr_b16 v[190:191], v2 offset:9648
  v_mfma_f32_16x16x32_bf16 v[156:159], v[172:175], v[200:203], 0
  v_min_u32 v3, v7, v6
  v_add_u32 v2, v3, v4
  s_waitcnt lgkmcnt(8)
  v_mfma_f32_16x16x32_bf16 v[112:115], v[176:179], v[204:207], v[112:115]
  s_barrier
  ds_read_b64_tr_b16 v[160:161], v2 offset:0
  ds_read_b32 v248, v252 offset:0
  ds_read_b32 v249, v252 offset:64
  s_waitcnt lgkmcnt(10)
  v_mfma_f32_16x16x32_bf16 v[116:119], v[176:179], v[208:211], v[116:119]
  ds_read_b64_tr_b16 v[162:163], v2 offset:1040
  ds_read_b32 v250, v252 offset:128
  s_waitcnt lgkmcnt(11)
  v_mfma_f32_16x16x32_bf16 v[120:123], v[176:179], v[212:215], v[120:123]
  ds_read_b128 v[192:195], v3 offset:0
  v_mov_b32 v252, v251
  v_add_u32 v251, 192, v251
  s_waitcnt lgkmcnt(10)
  v_mfma_f32_16x16x32_bf16 v[124:127], v[180:183], v[204:207], v[124:127]
  ds_read_b128 v[196:199], v3 offset:2080
  v_mfma_f32_16x16x32_bf16 v[128:131], v[180:183], v[208:211], v[128:131]
  ds_read_b128 v[200:203], v3 offset:4160
  v_mfma_f32_16x16x32_bf16 v[132:135], v[180:183], v[212:215], v[132:135]
  ds_read_b64_tr_b16 v[164:165], v2 offset:32
  s_waitcnt lgkmcnt(7)
  v_fmac_f32 v16, v64, v248
  v_mfma_f32_16x16x32_bf16 v[136:139], v[184:187], v[204:207], v[136:139]
  ds_read_b64_tr_b16 v[166:167], v2 offset:1072
  v_fmac_f32 v17, v65, v248
  v_fmac_f32 v18, v66, v248
  v_mfma_f32_16x16x32_bf16 v[140:143], v[184:187], v[208:211], v[140:143]
  ds_read_b64_tr_b16 v[168:169], v2 offset:256
  v_fmac_f32 v19, v67, v248
  v_mfma_f32_16x16x32_bf16 v[144:147], v[184:187], v[212:215], v[144:147]
  ds_read_b64_tr_b16 v[170:171], v2 offset:1296
  s_waitcnt lgkmcnt(9)
  v_fmac_f32 v20, v68, v249
  v_fmac_f32 v21, v69, v249
  v_mfma_f32_16x16x32_bf16 v[148:151], v[188:191], v[204:207], v[148:151]
  ds_read_b64_tr_b16 v[172:173], v2 offset:288
  v_fmac_f32 v22, v70, v249
  v_mfma_f32_16x16x32_bf16 v[152:155], v[188:191], v[208:211], v[152:155]
  ds_read_b64_tr_b16 v[174:175], v2 offset:1328
  v_fmac_f32 v23, v71, v249
  s_waitcnt lgkmcnt(9)
  v_fmac_f32 v24, v72, v250
  v_mfma_f32_16x16x32_bf16 v[156:159], v[188:191], v[212:215], v[156:159]
  v_fmac_f32 v25, v73, v250
  s_waitcnt lgkmcnt(8)
  v_mfma_f32_16x16x32_bf16 v[112:115], v[160:163], v[192:195], v[112:115]
  ds_read_b64_tr_b16 v[176:177], v2 offset:8320
  v_add_u32 v6, 29120, v3
  v_add_u32 v7, 0xfffe3900, v3
  s_waitcnt lgkmcnt(8)
  v_mfma_f32_16x16x32_bf16 v[116:119], v[160:163], v[196:199], v[116:119]
  ds_read_b64_tr_b16 v[178:179], v2 offset:9360
  v_fmac_f32 v26, v74, v250
  v_fmac_f32 v27, v75, v250
  s_waitcnt lgkmcnt(8)
  v_mfma_f32_16x16x32_bf16 v[120:123], v[160:163], v[200:203], v[120:123]
  ds_read_b128 v[204:207], v3 offset:1040
  v_fmac_f32 v28, v76, v248
  s_waitcnt lgkmcnt(7)
  v_mfma_f32_16x16x32_bf16 v[124:127], v[164:167], v[192:195], v[124:127]
  ds_read_b128 v[208:211], v3 offset:3120
  v_fmac_f32 v29, v77, v248
  v_fmac_f32 v30, v78, v248
  v_mfma_f32_16x16x32_bf16 v[128:131], v[164:167], v[196:199], v[128:131]
  ds_read_b128 v[212:215], v3 offset:5200
  v_fmac_f32 v31, v79, v248
  v_fmac_f32 v32, v80, v249
  v_mfma_f32_16x16x32_bf16 v[132:135], v[164:167], v[200:203], v[132:135]
  ds_read_b64_tr_b16 v[180:181], v2 offset:8352
  v_fmac_f32 v33, v81, v249
  s_waitcnt lgkmcnt(8)
  v_mfma_f32_16x16x32_bf16 v[136:139], v[168:171], v[192:195], v[136:139]
  ds_read_b64_tr_b16 v[182:183], v2 offset:9392
  v_fmac_f32 v34, v82, v249
  v_fmac_f32 v35, v83, v249
  v_mfma_f32_16x16x32_bf16 v[140:143], v[168:171], v[196:199], v[140:143]
  ds_read_b64_tr_b16 v[184:185], v2 offset:8576
  v_fmac_f32 v36, v84, v250
  v_fmac_f32 v37, v85, v250
  v_mfma_f32_16x16x32_bf16 v[144:147], v[168:171], v[200:203], v[144:147]
  ds_read_b64_tr_b16 v[186:187], v2 offset:9616
  v_fmac_f32 v38, v86, v250
  s_waitcnt lgkmcnt(9)
  v_mfma_f32_16x16x32_bf16 v[148:151], v[172:175], v[192:195], v[148:151]
  ds_read_b64_tr_b16 v[188:189], v2 offset:8608
  v_fmac_f32 v39, v87, v250
  v_fmac_f32 v40, v88, v248
  v_mfma_f32_16x16x32_bf16 v[152:155], v[172:175], v[196:199], v[152:155]
  ds_read_b64_tr_b16 v[190:191], v2 offset:9648
  v_fmac_f32 v41, v89, v248
  v_fmac_f32 v42, v90, v248
  v_mfma_f32_16x16x32_bf16 v[156:159], v[172:175], v[200:203], v[156:159]
  v_fmac_f32 v43, v91, v248
  v_min_u32 v3, v7, v6
  v_add_u32 v2, v3, v4
  s_waitcnt lgkmcnt(8)
  v_mfma_f32_16x16x32_bf16 v[112:115], v[176:179], v[204:207], v[112:115]
  s_barrier
  ds_read_b64_tr_b16 v[160:161], v2 offset:0
  v_fmac_f32 v44, v92, v249
  v_fmac_f32 v45, v93, v249
  s_waitcnt lgkmcnt(8)
  v_mfma_f32_16x16x32_bf16 v[116:119], v[176:179], v[208:211], v[116:119]
  ds_read_b64_tr_b16 v[162:163], v2 offset:1040
  v_fmac_f32 v46, v94, v249
  v_fmac_f32 v47, v95, v249
  s_waitcnt lgkmcnt(8)
  v_mfma_f32_16x16x32_bf16 v[120:123], v[176:179], v[212:215], v[120:123]
  ds_read_b128 v[192:195], v3 offset:0
  v_fmac_f32 v48, v96, v250
  v_fmac_f32 v49, v97, v250
  s_waitcnt lgkmcnt(7)
  v_mfma_f32_16x16x32_bf16 v[124:127], v[180:183], v[204:207], v[124:127]
  ds_read_b128 v[196:199], v3 offset:2080
  v_fmac_f32 v50, v98, v250
  v_fmac_f32 v51, v99, v250
  v_mfma_f32_16x16x32_bf16 v[128:131], v[180:183], v[208:211], v[128:131]
  ds_read_b128 v[200:203], v3 offset:4160
  v_fmac_f32 v52, v100, v248
  v_fmac_f32 v53, v101, v248
  v_mfma_f32_16x16x32_bf16 v[132:135], v[180:183], v[212:215], v[132:135]
  ds_read_b64_tr_b16 v[164:165], v2 offset:32
  v_fmac_f32 v54, v102, v248
  s_waitcnt lgkmcnt(8)
  v_mfma_f32_16x16x32_bf16 v[136:139], v[184:187], v[204:207], v[136:139]
  ds_read_b64_tr_b16 v[166:167], v2 offset:1072
  v_fmac_f32 v55, v103, v248
  v_fmac_f32 v56, v104, v249
  v_mfma_f32_16x16x32_bf16 v[140:143], v[184:187], v[208:211], v[140:143]
  ds_read_b64_tr_b16 v[168:169], v2 offset:256
  v_fmac_f32 v57, v105, v249
  v_fmac_f32 v58, v106, v249
  v_mfma_f32_16x16x32_bf16 v[144:147], v[184:187], v[212:215], v[144:147]
  ds_read_b64_tr_b16 v[170:171], v2 offset:1296
  v_fmac_f32 v59, v107, v249
  v_fmac_f32 v60, v108, v250
  s_waitcnt lgkmcnt(9)
  v_mfma_f32_16x16x32_bf16 v[148:151], v[188:191], v[204:207], v[148:151]
  ds_read_b64_tr_b16 v[172:173], v2 offset:288
  v_fmac_f32 v61, v109, v250
  v_fmac_f32 v62, v110, v250
  v_mfma_f32_16x16x32_bf16 v[152:155], v[188:191], v[208:211], v[152:155]
  ds_read_b64_tr_b16 v[174:175], v2 offset:1328
  v_fmac_f32 v63, v111, v250
  s_sub_u32 s94, s94, 1
  v_mfma_f32_16x16x32_bf16 v[156:159], v[188:191], v[212:215], v[156:159]
  s_cmp_lg_u32 s94, 0
  s_cbranch_scc1 L_pv_l
  ds_read_b32 v248, v252 offset:0
  ds_read_b32 v249, v252 offset:64
  ds_read_b32 v250, v252 offset:128
  v_mov_b32 v252, v251
  v_add_u32 v251, 192, v251
  s_waitcnt lgkmcnt(11)
  v_mfma_f32_16x16x32_bf16 v[64:67], v[160:163], v[192:195], 0
  s_barrier
  v_add_u32 v6, 29120, v3
  v_add_u32 v7, 0xfffe3900, v3
  v_min_u32 v3, v7, v6
  v_add_u32 v2, v3, v4
  s_waitcnt lgkmcnt(2)
  v_fmac_f32 v16, v112, v248
  v_mfma_f32_16x16x32_bf16 v[68:71], v[160:163], v[196:199], 0
  v_fmac_f32 v17, v113, v248
  v_fmac_f32 v18, v114, v248
  v_fmac_f32 v19, v115, v248
  s_waitcnt lgkmcnt(1)
  v_fmac_f32 v20, v116, v249
  v_mfma_f32_16x16x32_bf16 v[72:75], v[160:163], v[200:203], 0
  v_fmac_f32 v21, v117, v249
  v_fmac_f32 v22, v118, v249
  v_fmac_f32 v23, v119, v249
  s_waitcnt lgkmcnt(0)
  v_fmac_f32 v24, v120, v250
  v_mfma_f32_16x16x32_bf16 v[76:79], v[164:167], v[192:195], 0
  v_fmac_f32 v25, v121, v250
  v_fmac_f32 v26, v122, v250
  v_fmac_f32 v27, v123, v250
  v_fmac_f32 v28, v124, v248
  v_fmac_f32 v29, v125, v248
  v_mfma_f32_16x16x32_bf16 v[80:83], v[164:167], v[196:199], 0
  v_fmac_f32 v30, v126, v248
  v_fmac_f32 v31, v127, v248
  v_fmac_f32 v32, v128, v249
  v_fmac_f32 v33, v129, v249
  v_mfma_f32_16x16x32_bf16 v[84:87], v[164:167], v[200:203], 0
  v_fmac_f32 v34, v130, v249
  v_fmac_f32 v35, v131, v249
  v_fmac_f32 v36, v132, v250
  v_fmac_f32 v37, v133, v250
  v_mfma_f32_16x16x32_bf16 v[88:91], v[168:171], v[192:195], 0
  v_fmac_f32 v38, v134, v250
  v_fmac_f32 v39, v135, v250
  v_fmac_f32 v40, v136, v248
  v_fmac_f32 v41, v137, v248
  v_fmac_f32 v42, v138, v248
  v_mfma_f32_16x16x32_bf16 v[92:95], v[168:171], v[196:199], 0
  v_fmac_f32 v43, v139, v248
  v_fmac_f32 v44, v140, v249
  v_fmac_f32 v45, v141, v249
  v_fmac_f32 v46, v142, v249
  v_mfma_f32_16x16x32_bf16 v[96:99], v[168:171], v[200:203], 0
  v_fmac_f32 v47, v143, v249
  v_fmac_f32 v48, v144, v250
  v_fmac_f32 v49, v145, v250
  v_fmac_f32 v50, v146, v250
  v_mfma_f32_16x16x32_bf16 v[100:103], v[172:175], v[192:195], 0
  v_fmac_f32 v51, v147, v250
  v_fmac_f32 v52, v148, v248
  v_fmac_f32 v53, v149, v248
  v_fmac_f32 v54, v150, v248
  v_fmac_f32 v55, v151, v248
  v_mfma_f32_16x16x32_bf16 v[104:107], v[172:175], v[196:199], 0
  v_fmac_f32 v56, v152, v249
  v_fmac_f32 v57, v153, v249
  v_fmac_f32 v58, v154, v249
  v_fmac_f32 v59, v155, v249
  v_mfma_f32_16x16x32_bf16 v[108:111], v[172:175], v[200:203], 0
  v_fmac_f32 v60, v156, v250
  v_fmac_f32 v61, v157, v250
  v_fmac_f32 v62, v158, v250
  v_fmac_f32 v63, v159, v250
  ds_read_b32 v248, v252 offset:0
  ds_read_b32 v249, v252 offset:64
  ds_read_b32 v250, v252 offset:128
  v_mov_b32 v252, v251
  v_add_u32 v251, 192, v251
  s_waitcnt lgkmcnt(0)
  s_nop 5
  s_setpc_b64 s[86:87]
L_caux:
  s_barrier
  s_mov_b32 s8, 0
  s_mov_b32 s60, 0
  s_mov_b32 s10, 0
  s_sub_u32 s62, s9, 42
  s_sub_u32 s92, s9, 18
  s_cmp_lt_u32 s9, 42
  s_cselect_b32 s62, s92, s62
  v_lshrrev_b32 v208, 4, v1
  v_mul_u32_u24 v2, 1056, v208
  v_bfe_u32 v209, v1, 2, 2
  v_lshl_add_u32 v2, v209, 6, v2
  v_and_b32 v209, 3, v1
  v_lshl_add_u32 v2, v209, 3, v2
  s_xor_b32 s92, s90, 1
  s_mul_i32 s93, s92, 67584
  v_add_u32 v5, s93, v2
  s_lshl_b32 s92, s92, 14
  s_mul_i32 s93, s91, 36864
  s_add_u32 s92, s92, s93
  v_lshl_add_u32 v245, v1, 4, s92
  v_add_u32 v3, 50688, v2
  v_add_u32 v4, 101376, v2
  v_add_u32 v6, 50688, v5
  v_add_u32 v7, 101376, v5
  s_mul_i32 s92, s3, 36864
  v_lshl_add_u32 v246, v1, 4, s92
  v_bfe_u32 v209, v1, 4, 1
  v_lshlrev_b32 v209, 9, v209
  v_lshrrev_b32 v208, 5, v1
  v_lshl_add_u32 v209, v208, 8, v209
  v_and_b32 v208, 15, v1
  v_lshl_add_u32 v209, v208, 4, v209
  v_add_u32 v247, s92, v209
  v_and_b32 v208, 12, v1
  v_bfe_u32 v209, v1, 4, 1
  s_lshl_b32 s92, s3, 4
  v_add3_u32 v208, v208, v209, s92
  v_mul_u32_u24 v208, 2304, v208
  v_and_b32 v209, 127, v11
  v_add_u32 v248, v208, v209
  v_add_u32 v249, 4608, v248
  s_cmp_ge_u32 s9, 0
  s_cselect_b32 s8, 8982, s8
  s_cmp_ge_u32 s9, 18
  s_cselect_b32 s8, 17174, s8
  s_cmp_ge_u32 s9, 36
  s_cselect_b32 s8, 362262, s8
  s_cmp_ge_u32 s9, 42
  s_cselect_b32 s8, 5796214, s8
  s_cmp_ge_u32 s9, 51
  s_cselect_b32 s8, 362263, s8
  s_cmp_ge_u32 s9, 54
  s_cselect_b32 s8, 1911, s8
L_cx_next:
  s_and_b32 s92, s8, 15
  s_lshr_b32 s8, s8, 4
  s_cmp_eq_u32 s92, 1
  s_cbranch_scc1 L_cx_T
  s_cmp_eq_u32 s92, 2
  s_cbranch_scc1 L_cx_VT
  s_cmp_eq_u32 s92, 3
  s_cbranch_scc1 L_cx_Y
  s_cmp_eq_u32 s92, 4
  s_cbranch_scc1 L_cx_AT
  s_cmp_eq_u32 s92, 5
  s_cbranch_scc1 L_cx_OT
  s_cmp_eq_u32 s92, 6
  s_cbranch_scc1 L_cx_X
  s_cmp_eq_u32 s92, 7
  s_cbranch_scc1 L_cx_G
  s_cmp_eq_u32 s92, 8
  s_cbranch_scc1 L_cx_OP
  s_branch L_fin
L_cx_T:
  s_mov_b32 s61, s9
  s_lshl_b32 s65, s61, 7
  s_add_u32 s20, s58, 655360
  s_addc_u32 s21, s59, 0
  s_mov_b32 s22, 147456
  s_mov_b32 s23, 0x20000
  s_barrier
  s_call_b64 s[86:87], L_skt
  s_barrier
  s_cmp_ge_u32 s61, 18
  s_cbranch_scc1 L_sk_3_k
  s_mov_b32 s70, 802816
  s_mul_i32 s75, s61, 2048
  s_add_u32 s70, s70, s75
  s_mul_i32 s75, s60, 0
  s_add_u32 s70, s70, s75
  s_call_b64 s[68:69], L_sk_ft
  s_branch L_sk_3_e
L_sk_3_k:
  s_cmp_ge_u32 s61, 36
  s_cbranch_scc1 L_sk_3_v
  s_lshr_b32 s71, s3, 1
  s_mov_b32 s70, 14151680
  s_mul_i32 s75, s61, 2048
  s_add_u32 s70, s70, s75
  s_mul_i32 s75, s71, 2359296
  s_add_u32 s70, s70, s75
  s_call_b64 s[68:69], L_sk_ft
  s_branch L_sk_3_e
L_sk_3_v:
  s_mov_b32 s70, 876544
  s_mul_i32 s75, s61, 2048
  s_add_u32 s70, s70, s75
  s_mul_i32 s75, s60, 0
  s_add_u32 s70, s70, s75
  s_call_b64 s[68:69], L_sk_ft
  s_add_u32 s71, s65, 4451840
  s_call_b64 s[68:69], L_sk_row
L_sk_3_e:
  s_mov_b32 s88, 120576
  s_mul_i32 s75, s61, 128
  s_add_u32 s88, s88, s75
  s_mul_i32 s75, s3, 4
  s_add_u32 s88, s88, s75
  s_waitcnt vmcnt(0)
  v_mov_b32 v254, 163548
  s_mov_b64 exec, 1
  ds_add_rtn_u32 v255, v254, v12
  s_andn2_b32 s88, s88, 15
  s_waitcnt lgkmcnt(0)
  v_and_b32 v255, 3, v255
  v_cmp_eq_u32 vcc, 3, v255
  s_mov_b64 exec, 15
  s_cbranch_vccz L_s1_4
  v_mov_b32 v255, s11
  v_lshlrev_b32 v254, 2, v1
  buffer_store_dword v255, v254, s[12:15], s88 offen sc1
L_s1_4:
  s_mov_b64 exec, -1
  s_branch L_cx_next
L_cx_VT:
  s_mov_b32 s61, s9
  s_lshl_b32 s65, s61, 7
  s_add_u32 s20, s58, 950272
  s_addc_u32 s21, s59, 0
  s_mov_b32 s22, 147456
  s_mov_b32 s23, 0x20000
  s_barrier
  s_call_b64 s[86:87], L_skt
  s_barrier
  s_add_u32 s71, s65, 19054592
  s_call_b64 s[68:69], L_sk_row
L_sk_5_e:
  s_mov_b32 s88, 127488
  s_mul_i32 s75, s61, 128
  s_add_u32 s88, s88, s75
  s_mul_i32 s75, s3, 4
  s_add_u32 s88, s88, s75
  s_waitcnt vmcnt(0)
  v_mov_b32 v254, 163548
  s_mov_b64 exec, 1
  ds_add_rtn_u32 v255, v254, v12
  s_andn2_b32 s88, s88, 15
  s_waitcnt lgkmcnt(0)
  v_and_b32 v255, 3, v255
  v_cmp_eq_u32 vcc, 3, v255
  s_mov_b64 exec, 15
  s_cbranch_vccz L_s1_6
  v_mov_b32 v255, s11
  v_lshlrev_b32 v254, 2, v1
  buffer_store_dword v255, v254, s[12:15], s88 offen sc1
L_s1_6:
  s_mov_b64 exec, -1
  s_branch L_cx_next
L_cx_Y:
  s_mul_hi_u32 s60, s9, 238609295
  s_mul_i32 s61, s60, 18
  s_sub_u32 s61, s9, s61
  s_lshl_b32 s65, s61, 7
  s_mov_b32 s67, 802816
  s_mul_i32 s75, s60, 73728
  s_add_u32 s67, s67, s75
  s_add_u32 s20, s58, s67
  s_addc_u32 s21, s59, 0
  s_mov_b32 s22, 73728
  s_mov_b32 s23, 0x20000
  s_mov_b32 s67, 11829248
  s_mul_i32 s75, s60, 2433024
  s_add_u32 s67, s67, s75
  s_mul_i32 s75, s61, 147456
  s_add_u32 s67, s67, s75
  s_mov_b32 s66, 147456
  s_cmp_eq_u32 s61, 16
  s_cselect_b32 s66, 73728, s66
  s_add_u32 s16, s58, s67
  s_addc_u32 s17, s59, 0
  s_mov_b32 s18, s66
  s_mov_b32 s19, 0x20000
  s_mov_b32 s67, 335872
  s_mul_i32 s75, s60, 143616
  s_add_u32 s67, s67, s75
  s_mul_i32 s75, s61, 8448
  s_add_u32 s67, s67, s75
  s_add_u32 s28, s58, s67
  s_addc_u32 s29, s59, 0
  s_mov_b32 s30, 1048576
  s_mov_b32 s31, 0x20000
  s_mul_i32 s92, s3, 9216
  v_lshl_add_u32 v48, v1, 4, s92
  v_add_u32 v49, 36864, v48
  v_add_u32 v50, 73728, v48
  v_add_u32 v51, 110592, v48
  s_and_b32 s92, s3, 1
  s_mul_i32 s93, s92, 36864
  v_add_u32 v52, s93, v48
  s_sub_u32 s93, 36864, s93
  v_add_u32 v53, s93, v48
  s_lshl_b32 s92, s92, 13
  s_add_u32 s92, s92, 143616
  v_lshl_add_u32 v54, v1, 4, s92
  v_xor_b32 v55, s92, v54
  s_sub_u32 s92, 295424, s92
  v_lshl_add_u32 v55, v1, 4, s92
  v_mov_b32 v56, 163568
  v_mov_b32 v57, 163572
  s_barrier
  s_mov_b32 s92, 0
  buffer_load_dwordx4 v[64:67], v52, s[20:23], s92 offen offset:0 sc1
  buffer_load_dwordx4 v[68:71], v53, s[20:23], s92 offen offset:0 sc1
  buffer_load_dwordx4 v[72:75], v52, s[20:23], s92 offen offset:1024 sc1
  buffer_load_dwordx4 v[76:79], v53, s[20:23], s92 offen offset:1024 sc1
  buffer_load_dwordx4 v[80:83], v52, s[20:23], s92 offen offset:2048 sc1
  buffer_load_dwordx4 v[84:87], v53, s[20:23], s92 offen offset:2048 sc1
  buffer_load_dwordx4 v[88:91], v52, s[20:23], s92 offen offset:3072 sc1
  buffer_load_dwordx4 v[92:95], v53, s[20:23], s92 offen offset:3072 sc1
  s_mov_b32 s92, 4096
  buffer_load_dwordx4 v[96:99], v52, s[20:23], s92 offen offset:0 sc1
  buffer_load_dwordx4 v[100:103], v53, s[20:23], s92 offen offset:0 sc1
  buffer_load_dwordx4 v[104:107], v52, s[20:23], s92 offen offset:1024 sc1
  buffer_load_dwordx4 v[108:111], v53, s[20:23], s92 offen offset:1024 sc1
  buffer_load_dwordx4 v[112:115], v52, s[20:23], s92 offen offset:2048 sc1
  buffer_load_dwordx4 v[116:119], v53, s[20:23], s92 offen offset:2048 sc1
  buffer_load_dwordx4 v[120:123], v52, s[20:23], s92 offen offset:3072 sc1
  buffer_load_dwordx4 v[124:127], v53, s[20:23], s92 offen offset:3072 sc1
  s_mov_b32 s92, 8192
  buffer_load_dwordx4 v[128:131], v52, s[20:23], s92 offen offset:0 sc1
  buffer_load_dwordx4 v[132:135], v53, s[20:23], s92 offen offset:0 sc1
  s_barrier
  s_cmp_eq_u32 s61, 17
  s_cbranch_scc1 L_std_x
  s_mov_b32 s92, 0
  buffer_load_dwordx4 v[136:139], v48, s[16:19], s92 offen offset:0 sc1
  buffer_load_dwordx4 v[140:143], v49, s[16:19], s92 offen offset:0 sc1
  buffer_load_dwordx4 v[144:147], v50, s[16:19], s92 offen offset:0 sc1
  buffer_load_dwordx4 v[148:151], v51, s[16:19], s92 offen offset:0 sc1
  buffer_load_dwordx4 v[152:155], v48, s[16:19], s92 offen offset:1024 sc1
  buffer_load_dwordx4 v[156:159], v49, s[16:19], s92 offen offset:1024 sc1
  buffer_load_dwordx4 v[160:163], v50, s[16:19], s92 offen offset:1024 sc1
  buffer_load_dwordx4 v[164:167], v51, s[16:19], s92 offen offset:1024 sc1
  buffer_load_dwordx4 v[168:171], v48, s[16:19], s92 offen offset:2048 sc1
  buffer_load_dwordx4 v[172:175], v49, s[16:19], s92 offen offset:2048 sc1
  buffer_load_dwordx4 v[176:179], v50, s[16:19], s92 offen offset:2048 sc1
  buffer_load_dwordx4 v[180:183], v51, s[16:19], s92 offen offset:2048 sc1
  buffer_load_dwordx4 v[184:187], v48, s[16:19], s92 offen offset:3072 sc1
  buffer_load_dwordx4 v[188:191], v49, s[16:19], s92 offen offset:3072 sc1
  buffer_load_dwordx4 v[192:195], v50, s[16:19], s92 offen offset:3072 sc1
  buffer_load_dwordx4 v[196:199], v51, s[16:19], s92 offen offset:3072 sc1
  s_mov_b32 s92, 4096
  buffer_load_dwordx4 v[200:203], v48, s[16:19], s92 offen offset:0 sc1
  buffer_load_dwordx4 v[204:207], v49, s[16:19], s92 offen offset:0 sc1
  buffer_load_dwordx4 v[208:211], v50, s[16:19], s92 offen offset:0 sc1
  buffer_load_dwordx4 v[212:215], v51, s[16:19], s92 offen offset:0 sc1
  buffer_load_dwordx4 v[216:219], v48, s[16:19], s92 offen offset:1024 sc1
  buffer_load_dwordx4 v[220:223], v49, s[16:19], s92 offen offset:1024 sc1
  buffer_load_dwordx4 v[224:227], v50, s[16:19], s92 offen offset:1024 sc1
  buffer_load_dwordx4 v[228:231], v51, s[16:19], s92 offen offset:1024 sc1
  s_waitcnt vmcnt(20)
  v_mfma_f32_16x16x32_bf16 v[16:19], v[136:139], v[64:67], 0
  v_mfma_f32_16x16x32_bf16 v[20:23], v[140:143], v[64:67], 0
  v_mfma_f32_16x16x32_bf16 v[24:27], v[144:147], v[64:67], 0
  v_mfma_f32_16x16x32_bf16 v[28:31], v[148:151], v[64:67], 0
  v_mfma_f32_16x16x32_bf16 v[32:35], v[136:139], v[68:71], 0
  v_mfma_f32_16x16x32_bf16 v[36:39], v[140:143], v[68:71], 0
  v_mfma_f32_16x16x32_bf16 v[40:43], v[144:147], v[68:71], 0
  v_mfma_f32_16x16x32_bf16 v[44:47], v[148:151], v[68:71], 0
  buffer_load_dwordx4 v[136:139], v48, s[16:19], s92 offen offset:2048 sc1
  buffer_load_dwordx4 v[140:143], v49, s[16:19], s92 offen offset:2048 sc1
  buffer_load_dwordx4 v[144:147], v50, s[16:19], s92 offen offset:2048 sc1
  buffer_load_dwordx4 v[148:151], v51, s[16:19], s92 offen offset:2048 sc1
  s_waitcnt vmcnt(20)
  v_mfma_f32_16x16x32_bf16 v[16:19], v[152:155], v[72:75], v[16:19]
  v_mfma_f32_16x16x32_bf16 v[20:23], v[156:159], v[72:75], v[20:23]
  v_mfma_f32_16x16x32_bf16 v[24:27], v[160:163], v[72:75], v[24:27]
  v_mfma_f32_16x16x32_bf16 v[28:31], v[164:167], v[72:75], v[28:31]
  v_mfma_f32_16x16x32_bf16 v[32:35], v[152:155], v[76:79], v[32:35]
  v_mfma_f32_16x16x32_bf16 v[36:39], v[156:159], v[76:79], v[36:39]
  v_mfma_f32_16x16x32_bf16 v[40:43], v[160:163], v[76:79], v[40:43]
  v_mfma_f32_16x16x32_bf16 v[44:47], v[164:167], v[76:79], v[44:47]
  buffer_load_dwordx4 v[152:155], v48, s[16:19], s92 offen offset:3072 sc1
  buffer_load_dwordx4 v[156:159], v49, s[16:19], s92 offen offset:3072 sc1
  buffer_load_dwordx4 v[160:163], v50, s[16:19], s92 offen offset:3072 sc1
  buffer_load_dwordx4 v[164:167], v51, s[16:19], s92 offen offset:3072 sc1
  s_waitcnt vmcnt(20)
  v_mfma_f32_16x16x32_bf16 v[16:19], v[168:171], v[80:83], v[16:19]
  v_mfma_f32_16x16x32_bf16 v[20:23], v[172:175], v[80:83], v[20:23]
  v_mfma_f32_16x16x32_bf16 v[24:27], v[176:179], v[80:83], v[24:27]
  v_mfma_f32_16x16x32_bf16 v[28:31], v[180:183], v[80:83], v[28:31]
  v_mfma_f32_16x16x32_bf16 v[32:35], v[168:171], v[84:87], v[32:35]
  v_mfma_f32_16x16x32_bf16 v[36:39], v[172:175], v[84:87], v[36:39]
  v_mfma_f32_16x16x32_bf16 v[40:43], v[176:179], v[84:87], v[40:43]
  v_mfma_f32_16x16x32_bf16 v[44:47], v[180:183], v[84:87], v[44:47]
  s_mov_b32 s92, 8192
  buffer_load_dwordx4 v[168:171], v48, s[16:19], s92 offen offset:0 sc1
  buffer_load_dwordx4 v[172:175], v49, s[16:19], s92 offen offset:0 sc1
  buffer_load_dwordx4 v[176:179], v50, s[16:19], s92 offen offset:0 sc1
  buffer_load_dwordx4 v[180:183], v51, s[16:19], s92 offen offset:0 sc1
  s_waitcnt vmcnt(20)
  v_mfma_f32_16x16x32_bf16 v[16:19], v[184:187], v[88:91], v[16:19]
  v_mfma_f32_16x16x32_bf16 v[20:23], v[188:191], v[88:91], v[20:23]
  v_mfma_f32_16x16x32_bf16 v[24:27], v[192:195], v[88:91], v[24:27]
  v_mfma_f32_16x16x32_bf16 v[28:31], v[196:199], v[88:91], v[28:31]
  v_mfma_f32_16x16x32_bf16 v[32:35], v[184:187], v[92:95], v[32:35]
  v_mfma_f32_16x16x32_bf16 v[36:39], v[188:191], v[92:95], v[36:39]
  v_mfma_f32_16x16x32_bf16 v[40:43], v[192:195], v[92:95], v[40:43]
  v_mfma_f32_16x16x32_bf16 v[44:47], v[196:199], v[92:95], v[44:47]
  s_waitcnt vmcnt(16)
  v_mfma_f32_16x16x32_bf16 v[16:19], v[200:203], v[96:99], v[16:19]
  v_mfma_f32_16x16x32_bf16 v[20:23], v[204:207], v[96:99], v[20:23]
  v_mfma_f32_16x16x32_bf16 v[24:27], v[208:211], v[96:99], v[24:27]
  v_mfma_f32_16x16x32_bf16 v[28:31], v[212:215], v[96:99], v[28:31]
  v_mfma_f32_16x16x32_bf16 v[32:35], v[200:203], v[100:103], v[32:35]
  v_mfma_f32_16x16x32_bf16 v[36:39], v[204:207], v[100:103], v[36:39]
  v_mfma_f32_16x16x32_bf16 v[40:43], v[208:211], v[100:103], v[40:43]
  v_mfma_f32_16x16x32_bf16 v[44:47], v[212:215], v[100:103], v[44:47]
  s_waitcnt vmcnt(12)
  v_mfma_f32_16x16x32_bf16 v[16:19], v[216:219], v[104:107], v[16:19]
  v_mfma_f32_16x16x32_bf16 v[20:23], v[220:223], v[104:107], v[20:23]
  v_mfma_f32_16x16x32_bf16 v[24:27], v[224:227], v[104:107], v[24:27]
  v_mfma_f32_16x16x32_bf16 v[28:31], v[228:231], v[104:107], v[28:31]
  v_mfma_f32_16x16x32_bf16 v[32:35], v[216:219], v[108:111], v[32:35]
  v_mfma_f32_16x16x32_bf16 v[36:39], v[220:223], v[108:111], v[36:39]
  v_mfma_f32_16x16x32_bf16 v[40:43], v[224:227], v[108:111], v[40:43]
  v_mfma_f32_16x16x32_bf16 v[44:47], v[228:231], v[108:111], v[44:47]
  s_waitcnt vmcnt(8)
  v_mfma_f32_16x16x32_bf16 v[16:19], v[136:139], v[112:115], v[16:19]
  v_mfma_f32_16x16x32_bf16 v[20:23], v[140:143], v[112:115], v[20:23]
  v_mfma_f32_16x16x32_bf16 v[24:27], v[144:147], v[112:115], v[24:27]
  v_mfma_f32_16x16x32_bf16 v[28:31], v[148:151], v[112:115], v[28:31]
  v_mfma_f32_16x16x32_bf16 v[32:35], v[136:139], v[116:119], v[32:35]
  v_mfma_f32_16x16x32_bf16 v[36:39], v[140:143], v[116:119], v[36:39]
  v_mfma_f32_16x16x32_bf16 v[40:43], v[144:147], v[116:119], v[40:43]
  v_mfma_f32_16x16x32_bf16 v[44:47], v[148:151], v[116:119], v[44:47]
  s_waitcnt vmcnt(4)
  v_mfma_f32_16x16x32_bf16 v[16:19], v[152:155], v[120:123], v[16:19]
  v_mfma_f32_16x16x32_bf16 v[20:23], v[156:159], v[120:123], v[20:23]
  v_mfma_f32_16x16x32_bf16 v[24:27], v[160:163], v[120:123], v[24:27]
  v_mfma_f32_16x16x32_bf16 v[28:31], v[164:167], v[120:123], v[28:31]
  v_mfma_f32_16x16x32_bf16 v[32:35], v[152:155], v[124:127], v[32:35]
  v_mfma_f32_16x16x32_bf16 v[36:39], v[156:159], v[124:127], v[36:39]
  v_mfma_f32_16x16x32_bf16 v[40:43], v[160:163], v[124:127], v[40:43]
  v_mfma_f32_16x16x32_bf16 v[44:47], v[164:167], v[124:127], v[44:47]
  s_waitcnt vmcnt(0)
  v_mfma_f32_16x16x32_bf16 v[16:19], v[168:171], v[128:131], v[16:19]
  v_mfma_f32_16x16x32_bf16 v[20:23], v[172:175], v[128:131], v[20:23]
  v_mfma_f32_16x16x32_bf16 v[24:27], v[176:179], v[128:131], v[24:27]
  v_mfma_f32_16x16x32_bf16 v[28:31], v[180:183], v[128:131], v[28:31]
  v_mfma_f32_16x16x32_bf16 v[32:35], v[168:171], v[132:135], v[32:35]
  v_mfma_f32_16x16x32_bf16 v[36:39], v[172:175], v[132:135], v[36:39]
  v_mfma_f32_16x16x32_bf16 v[40:43], v[176:179], v[132:135], v[40:43]
  v_mfma_f32_16x16x32_bf16 v[44:47], v[180:183], v[132:135], v[44:47]
  s_nop 7
  s_cmp_lt_u32 s3, 2
  s_cbranch_scc1 L_std_o
  ds_write_b128 v54, v[16:19] offset:0
  ds_write_b128 v54, v[20:23] offset:1024
  ds_write_b128 v54, v[24:27] offset:2048
  ds_write_b128 v54, v[28:31] offset:3072
  ds_write_b128 v54, v[32:35] offset:4096
  ds_write_b128 v54, v[36:39] offset:5120
  ds_write_b128 v54, v[40:43] offset:6144
  ds_write_b128 v54, v[44:47] offset:7168
  s_mov_b64 exec, 1
  ds_add_u32 v56, v12
  s_mov_b64 exec, -1
  s_branch L_std_e
L_std_o:
  s_mov_b32 s74, 16777216
L_lw_7:
  ds_read_b32 v60, v56
  s_waitcnt lgkmcnt(0)
  v_cmp_le_u32 vcc, 2, v60
  s_cbranch_vccnz L_lw_7_d
  s_sleep 1
  s_sub_u32 s74, s74, 1
  s_cmp_lg_u32 s74, 0
  s_cbranch_scc1 L_lw_7
L_lw_7_d:
  ds_read_b128 v[64:67], v54 offset:0
  ds_read_b128 v[68:71], v54 offset:1024
  ds_read_b128 v[72:75], v54 offset:2048
  ds_read_b128 v[76:79], v54 offset:3072
  ds_read_b128 v[80:83], v54 offset:4096
  ds_read_b128 v[84:87], v54 offset:5120
  ds_read_b128 v[88:91], v54 offset:6144
  ds_read_b128 v[92:95], v54 offset:7168
  s_waitcnt lgkmcnt(0)
  v_add_f32 v16, v16, v64
  v_add_f32 v17, v17, v65
  v_add_f32 v18, v18, v66
  v_add_f32 v19, v19, v67
  v_add_f32 v20, v20, v68
  v_add_f32 v21, v21, v69
  v_add_f32 v22, v22, v70
  v_add_f32 v23, v23, v71
  v_add_f32 v24, v24, v72
  v_add_f32 v25, v25, v73
  v_add_f32 v26, v26, v74
  v_add_f32 v27, v27, v75
  v_add_f32 v28, v28, v76
  v_add_f32 v29, v29, v77
  v_add_f32 v30, v30, v78
  v_add_f32 v31, v31, v79
  v_add_f32 v32, v32, v80
  v_add_f32 v33, v33, v81
  v_add_f32 v34, v34, v82
  v_add_f32 v35, v35, v83
  v_add_f32 v36, v36, v84
  v_add_f32 v37, v37, v85
  v_add_f32 v38, v38, v86
  v_add_f32 v39, v39, v87
  v_add_f32 v40, v40, v88
  v_add_f32 v41, v41, v89
  v_add_f32 v42, v42, v90
  v_add_f32 v43, v43, v91
  v_add_f32 v44, v44, v92
  v_add_f32 v45, v45, v93
  v_add_f32 v46, v46, v94
  v_add_f32 v47, v47, v95
  ds_write_b128 v54, v[32:35] offset:0
  ds_write_b128 v54, v[36:39] offset:1024
  ds_write_b128 v54, v[40:43] offset:2048
  ds_write_b128 v54, v[44:47] offset:3072
  s_mov_b64 exec, 1
  ds_add_u32 v57, v12
  s_mov_b64 exec, -1
  s_mov_b32 s74, 16777216
L_lw_8:
  ds_read_b32 v60, v57
  s_waitcnt lgkmcnt(0)
  v_cmp_le_u32 vcc, 2, v60
  s_cbranch_vccnz L_lw_8_d
  s_sleep 1
  s_sub_u32 s74, s74, 1
  s_cmp_lg_u32 s74, 0
  s_cbranch_scc1 L_lw_8
L_lw_8_d:
  ds_read_b128 v[64:67], v55 offset:0
  ds_read_b128 v[68:71], v55 offset:1024
  ds_read_b128 v[72:75], v55 offset:2048
  ds_read_b128 v[76:79], v55 offset:3072
  s_waitcnt lgkmcnt(0)
  v_add_f32 v16, v16, v64
  v_add_f32 v17, v17, v65
  v_add_f32 v18, v18, v66
  v_add_f32 v19, v19, v67
  v_add_f32 v20, v20, v68
  v_add_f32 v21, v21, v69
  v_add_f32 v22, v22, v70
  v_add_f32 v23, v23, v71
  v_add_f32 v24, v24, v72
  v_add_f32 v25, v25, v73
  v_add_f32 v26, v26, v74
  v_add_f32 v27, v27, v75
  v_add_f32 v28, v28, v76
  v_add_f32 v29, v29, v77
  v_add_f32 v30, v30, v78
  v_add_f32 v31, v31, v79
  s_cmp_lg_u32 s61, 16
  s_cbranch_scc1 L_std_m
  v_mov_b32 v24, 0xff800000
  v_mov_b32 v25, 0xff800000
  v_mov_b32 v26, 0xff800000
  v_mov_b32 v27, 0xff800000
  v_mov_b32 v28, 0xff800000
  v_mov_b32 v29, 0xff800000
  v_mov_b32 v30, 0xff800000
  v_mov_b32 v31, 0xff800000
L_std_m:
  v_max_f32 v32, v16, v17
  v_max3_f32 v32, v32, v18, v19
  v_max3_f32 v32, v32, v20, v21
  v_max3_f32 v32, v32, v22, v23
  v_max3_f32 v32, v32, v24, v25
  v_max3_f32 v32, v32, v26, v27
  v_max3_f32 v32, v32, v28, v29
  v_max3_f32 v32, v32, v30, v31
  v_mov_b32 v34, v32
  s_nop 1
  v_permlane16_swap_b32 v32, v34
  v_max_f32 v32, v32, v34
  v_mov_b32 v34, v32
  s_nop 1
  v_permlane32_swap_b32 v32, v34
  v_max_f32 v32, v32, v34
  s_mov_b32 s92, 0x3d2e1a93
  v_mul_f32 v32, s92, v32
  v_fma_f32 v16, v16, s92, -v32
  v_fma_f32 v17, v17, s92, -v32
  v_fma_f32 v18, v18, s92, -v32
  v_fma_f32 v19, v19, s92, -v32
  v_fma_f32 v20, v20, s92, -v32
  v_fma_f32 v21, v21, s92, -v32
  v_fma_f32 v22, v22, s92, -v32
  v_fma_f32 v23, v23, s92, -v32
  v_fma_f32 v24, v24, s92, -v32
  v_fma_f32 v25, v25, s92, -v32
  v_fma_f32 v26, v26, s92, -v32
  v_fma_f32 v27, v27, s92, -v32
  v_fma_f32 v28, v28, s92, -v32
  v_fma_f32 v29, v29, s92, -v32
  v_fma_f32 v30, v30, s92, -v32
  v_fma_f32 v31, v31, s92, -v32
  v_exp_f32 v16, v16
  v_exp_f32 v17, v17
  v_exp_f32 v18, v18
  v_exp_f32 v19, v19
  v_exp_f32 v20, v20
  v_exp_f32 v21, v21
  v_exp_f32 v22, v22
  v_exp_f32 v23, v23
  v_exp_f32 v24, v24
  v_exp_f32 v25, v25
  v_exp_f32 v26, v26
  v_exp_f32 v27, v27
  v_exp_f32 v28, v28
  v_exp_f32 v29, v29
  v_exp_f32 v30, v30
  v_exp_f32 v31, v31
  s_mov_b32 s70, 1245184
  s_mul_i32 s75, s61, 2048
  s_add_u32 s70, s70, s75
  s_mul_i32 s75, s60, 73728
  s_add_u32 s70, s70, s75
  s_call_b64 s[68:69], L_sk_ft
  v_add_f32 v33, v16, v17
  v_add_f32 v33, v33, v18
  v_add_f32 v33, v33, v19
  v_add_f32 v33, v33, v20
  v_add_f32 v33, v33, v21
  v_add_f32 v33, v33, v22
  v_add_f32 v33, v33, v23
  v_add_f32 v33, v33, v24
  v_add_f32 v33, v33, v25
  v_add_f32 v33, v33, v26
  v_add_f32 v33, v33, v27
  v_add_f32 v33, v33, v28
  v_add_f32 v33, v33, v29
  v_add_f32 v33, v33, v30
  v_add_f32 v33, v33, v31
  v_mov_b32 v34, v33
  s_nop 1
  v_permlane16_swap_b32 v33, v34
  v_add_f32 v33, v33, v34
  v_mov_b32 v34, v33
  s_nop 1
  v_permlane32_swap_b32 v33, v34
  v_add_f32 v33, v33, v34
  s_lshl_b32 s92, s3, 7
  v_lshlrev_b32 v34, 3, v1
  s_mov_b64 exec, 0xffff
  buffer_store_dwordx2 v[32:33], v34, s[28:31], s92 offen sc1
  s_mov_b64 exec, -1
L_std_e:
  s_mov_b32 s88, 129792
  s_mul_i32 s75, s60, 2176
  s_add_u32 s88, s88, s75
  s_mul_i32 s75, s61, 128
  s_add_u32 s88, s88, s75
  s_mul_i32 s75, s3, 4
  s_add_u32 s88, s88, s75
  s_waitcnt vmcnt(0)
  v_mov_b32 v254, 163548
  s_mov_b64 exec, 1
  ds_add_rtn_u32 v255, v254, v12
  s_andn2_b32 s88, s88, 15
  s_waitcnt lgkmcnt(0)
  v_and_b32 v255, 3, v255
  v_cmp_eq_u32 vcc, 3, v255
  s_mov_b64 exec, 15
  s_cbranch_vccz L_s1_9
  v_mov_b32 v255, s11
  v_lshlrev_b32 v254, 2, v1
  buffer_store_dword v255, v254, s[12:15], s88 offen sc1
L_s1_9:
  s_mov_b64 exec, -1
L_std_x:
  s_mov_b32 s67, 1245184
  s_mul_i32 s75, s60, 73728
  s_add_u32 s67, s67, s75
  s_add_u32 s20, s58, s67
  s_addc_u32 s21, s59, 0
  s_mov_b32 s22, 73728
  s_mov_b32 s23, 0x20000
  s_mov_b32 s67, 335872
  s_mul_i32 s75, s60, 143616
  s_add_u32 s67, s67, s75
  s_add_u32 s28, s58, s67
  s_addc_u32 s29, s59, 0
  s_mov_b32 s30, 1048576
  s_mov_b32 s31, 0x20000
  s_barrier
  s_call_b64 s[86:87], L_sky
  s_lshl_b32 s92, s91, 12
  s_add_u32 s92, s92, 153792
  v_lshl_add_u32 v64, v1, 4, s92
  s_cmp_lt_u32 s3, 2
  s_cbranch_scc1 L_sk_10_o
  ds_write_b128 v64, v[16:19] offset:0
  ds_write_b128 v64, v[20:23] offset:1024
  ds_write_b128 v64, v[24:27] offset:2048
  ds_write_b128 v64, v[28:31] offset:3072
  s_waitcnt lgkmcnt(0)
  s_branch L_sk_10_s
L_sk_10_o:
  s_barrier
  ds_read_b128 v[68:71], v64 offset:0
  ds_read_b128 v[72:75], v64 offset:1024
  ds_read_b128 v[76:79], v64 offset:2048
  ds_read_b128 v[80:83], v64 offset:3072
  s_waitcnt lgkmcnt(0)
  v_add_f32 v16, v16, v68
  v_add_f32 v17, v17, v69
  v_add_f32 v18, v18, v70
  v_add_f32 v19, v19, v71
  v_add_f32 v20, v20, v72
  v_add_f32 v21, v21, v73
  v_add_f32 v22, v22, v74
  v_add_f32 v23, v23, v75
  v_add_f32 v24, v24, v76
  v_add_f32 v25, v25, v77
  v_add_f32 v26, v26, v78
  v_add_f32 v27, v27, v79
  v_add_f32 v28, v28, v80
  v_add_f32 v29, v29, v81
  v_add_f32 v30, v30, v82
  v_add_f32 v31, v31, v83
  s_mov_b32 s70, 1392640
  s_mul_i32 s75, s61, 2048
  s_add_u32 s70, s70, s75
  s_mul_i32 s75, s60, 73728
  s_add_u32 s70, s70, s75
  s_call_b64 s[68:69], L_sk_ft
  v_mul_f32 v48, v48, v250
  v_mul_f32 v49, v49, v250
  v_mul_f32 v50, v50, v250
  v_mul_f32 v51, v51, v250
  v_mul_f32 v52, v52, v250
  v_mul_f32 v53, v53, v250
  v_mul_f32 v54, v54, v250
  v_mul_f32 v55, v55, v250
  v_mul_f32 v56, v56, v250
  v_mul_f32 v57, v57, v250
  v_mul_f32 v58, v58, v250
  v_mul_f32 v59, v59, v250
  v_mul_f32 v60, v60, v250
  v_mul_f32 v61, v61, v250
  v_mul_f32 v62, v62, v250
  v_mul_f32 v63, v63, v250
  s_mov_b32 s70, 1687552
  s_mul_i32 s75, s60, 147456
  s_add_u32 s70, s70, s75
  s_mul_i32 s75, s3, 73728
  s_add_u32 s70, s70, s75
  s_mul_i32 s75, s61, 4096
  s_add_u32 s70, s70, s75
  v_lshlrev_b32 v250, 4, v1
  buffer_store_dwordx4 v[48:51], v250, s[12:15], s70 offen offset:0 sc1
  buffer_store_dwordx4 v[52:55], v250, s[12:15], s70 offen offset:1024 sc1
  buffer_store_dwordx4 v[56:59], v250, s[12:15], s70 offen offset:2048 sc1
  buffer_store_dwordx4 v[60:63], v250, s[12:15], s70 offen offset:3072 sc1
  s_branch L_sk_10_e
L_sk_10_s:
  s_barrier
L_sk_10_e:
  s_mov_b32 s88, 134144
  s_mul_i32 s75, s60, 2304
  s_add_u32 s88, s88, s75
  s_mul_i32 s75, s61, 128
  s_add_u32 s88, s88, s75
  s_mul_i32 s75, s3, 4
  s_add_u32 s88, s88, s75
  s_waitcnt vmcnt(0)
  v_mov_b32 v254, 163548
  s_mov_b64 exec, 1
  ds_add_rtn_u32 v255, v254, v12
  s_andn2_b32 s88, s88, 15
  s_waitcnt lgkmcnt(0)
  v_and_b32 v255, 3, v255
  v_cmp_eq_u32 vcc, 3, v255
  s_mov_b64 exec, 15
  s_cbranch_vccz L_s1_11
  v_mov_b32 v255, s11
  v_lshlrev_b32 v254, 2, v1
  buffer_store_dword v255, v254, s[12:15], s88 offen sc1
L_s1_11:
  s_mov_b64 exec, -1
  s_branch L_cx_next
L_cx_AT:
  s_sub_u32 s61, s9, 18
  s_lshl_b32 s65, s61, 7
  s_add_u32 s20, s58, 1392640
  s_addc_u32 s21, s59, 0
  s_mov_b32 s22, 147456
  s_mov_b32 s23, 0x20000
  s_barrier
  s_mov_b32 s70, 1687552
  s_mul_i32 s75, s3, 73728
  s_add_u32 s70, s70, s75
  s_mul_i32 s75, s61, 4096
  s_add_u32 s70, s70, s75
  v_lshlrev_b32 v250, 4, v1
  buffer_load_dwordx4 v[32:35], v250, s[12:15], s70 offen offset:0 sc1
  buffer_load_dwordx4 v[36:39], v250, s[12:15], s70 offen offset:1024 sc1
  buffer_load_dwordx4 v[40:43], v250, s[12:15], s70 offen offset:2048 sc1
  buffer_load_dwordx4 v[44:47], v250, s[12:15], s70 offen offset:3072 sc1
  s_call_b64 s[86:87], L_skt
  s_barrier
  v_add_f32 v16, v16, v32
  v_add_f32 v17, v17, v33
  v_add_f32 v18, v18, v34
  v_add_f32 v19, v19, v35
  v_add_f32 v20, v20, v36
  v_add_f32 v21, v21, v37
  v_add_f32 v22, v22, v38
  v_add_f32 v23, v23, v39
  v_add_f32 v24, v24, v40
  v_add_f32 v25, v25, v41
  v_add_f32 v26, v26, v42
  v_add_f32 v27, v27, v43
  v_add_f32 v28, v28, v44
  v_add_f32 v29, v29, v45
  v_add_f32 v30, v30, v46
  v_add_f32 v31, v31, v47
  s_mov_b32 s70, 1540096
  s_mul_i32 s75, s61, 2048
  s_add_u32 s70, s70, s75
  s_mul_i32 s75, s60, 0
  s_add_u32 s70, s70, s75
  s_call_b64 s[68:69], L_sk_ft
L_sk_12_e:
  s_mov_b32 s88, 138752
  s_mul_i32 s75, s61, 128
  s_add_u32 s88, s88, s75
  s_mul_i32 s75, s3, 4
  s_add_u32 s88, s88, s75
  s_waitcnt vmcnt(0)
  v_mov_b32 v254, 163548
  s_mov_b64 exec, 1
  ds_add_rtn_u32 v255, v254, v12
  s_andn2_b32 s88, s88, 15
  s_waitcnt lgkmcnt(0)
  v_and_b32 v255, 3, v255
  v_cmp_eq_u32 vcc, 3, v255
  s_mov_b64 exec, 15
  s_cbranch_vccz L_s1_13
  v_mov_b32 v255, s11
  v_lshlrev_b32 v254, 2, v1
  buffer_store_dword v255, v254, s[12:15], s88 offen sc1
L_s1_13:
  s_mov_b64 exec, -1
  s_branch L_cx_next
L_cx_OT:
  s_sub_u32 s61, s9, 36
  s_lshl_b32 s65, s61, 7
  s_add_u32 s20, s58, 1540096
  s_addc_u32 s21, s59, 0
  s_mov_b32 s22, 147456
  s_mov_b32 s23, 0x20000
  s_add_u32 s70, s65, 4718592
  s_sub_u32 s71, 147456, s65
  s_add_u32 s24, s54, s70
  s_addc_u32 s25, s55, 0
  s_mov_b32 s26, s71
  s_mov_b32 s27, 0x20000
  s_add_u32 s32, s38, s65
  s_addc_u32 s33, s39, 0
  s_mov_b32 s34, s71
  s_mov_b32 s35, 0x20000
  s_barrier
  buffer_load_dwordx4 v[48:51], v248, s[32:35], 0 offen
  buffer_load_dwordx4 v[52:55], v249, s[32:35], 0 offen
  s_lshr_b32 s71, s3, 1
  s_mov_b32 s70, 271360
  s_mul_i32 s75, s71, 4608
  s_add_u32 s70, s70, s75
  s_mul_i32 s75, s61, 256
  s_add_u32 s70, s70, s75
  v_and_b32 v250, 48, v1
  buffer_load_dwordx4 v[32:35], v250, s[12:15], s70 offen offset:0 sc1
  buffer_load_dwordx4 v[36:39], v250, s[12:15], s70 offen offset:64 sc1
  buffer_load_dwordx4 v[40:43], v250, s[12:15], s70 offen offset:128 sc1
  buffer_load_dwordx4 v[44:47], v250, s[12:15], s70 offen offset:192 sc1
  s_add_u32 s70, s70, 18432
  buffer_load_dwordx4 v[160:163], v250, s[12:15], s70 offen offset:0 sc1
  buffer_load_dwordx4 v[164:167], v250, s[12:15], s70 offen offset:64 sc1
  buffer_load_dwordx4 v[168:171], v250, s[12:15], s70 offen offset:128 sc1
  buffer_load_dwordx4 v[172:175], v250, s[12:15], s70 offen offset:192 sc1
  s_add_u32 s70, s70, 18432
  s_waitcnt vmcnt(0)
  v_add_f32 v32, v32, v160
  v_add_f32 v33, v33, v161
  v_add_f32 v34, v34, v162
  v_add_f32 v35, v35, v163
  v_add_f32 v36, v36, v164
  v_add_f32 v37, v37, v165
  v_add_f32 v38, v38, v166
  v_add_f32 v39, v39, v167
  v_add_f32 v40, v40, v168
  v_add_f32 v41, v41, v169
  v_add_f32 v42, v42, v170
  v_add_f32 v43, v43, v171
  v_add_f32 v44, v44, v172
  v_add_f32 v45, v45, v173
  v_add_f32 v46, v46, v174
  v_add_f32 v47, v47, v175
  s_nop 1
  v_permlane16_swap_b32 v48, v50
  v_permlane16_swap_b32 v49, v51
  v_permlane16_swap_b32 v52, v54
  v_permlane16_swap_b32 v53, v55
  v_bfi_b32 v64, v8, v48, v50
  v_bfi_b32 v65, v8, v49, v51
  v_bfi_b32 v66, v8, v52, v54
  v_bfi_b32 v67, v8, v53, v55
  v_mov_b32_dpp v76, v64 quad_perm:[1,0,3,2] row_mask:0xf bank_mask:0xf
  v_mov_b32_dpp v77, v65 quad_perm:[1,0,3,2] row_mask:0xf bank_mask:0xf
  v_mov_b32_dpp v78, v66 quad_perm:[1,0,3,2] row_mask:0xf bank_mask:0xf
  v_mov_b32_dpp v79, v67 quad_perm:[1,0,3,2] row_mask:0xf bank_mask:0xf
  v_bfi_b32 v48, v8, v76, v48
  v_bfi_b32 v50, v8, v50, v76
  v_bfi_b32 v49, v8, v77, v49
  v_bfi_b32 v51, v8, v51, v77
  v_bfi_b32 v52, v8, v78, v52
  v_bfi_b32 v54, v8, v54, v78
  v_bfi_b32 v53, v8, v79, v53
  v_bfi_b32 v55, v8, v55, v79
  v_bfi_b32 v64, v9, v48, v52
  v_bfi_b32 v65, v9, v49, v53
  v_bfi_b32 v66, v9, v50, v54
  v_bfi_b32 v67, v9, v51, v55
  v_mov_b32_dpp v76, v64 quad_perm:[2,3,0,1] row_mask:0xf bank_mask:0xf
  v_mov_b32_dpp v77, v65 quad_perm:[2,3,0,1] row_mask:0xf bank_mask:0xf
  v_mov_b32_dpp v78, v66 quad_perm:[2,3,0,1] row_mask:0xf bank_mask:0xf
  v_mov_b32_dpp v79, v67 quad_perm:[2,3,0,1] row_mask:0xf bank_mask:0xf
  v_bfi_b32 v48, v9, v76, v48
  v_bfi_b32 v52, v9, v52, v76
  v_bfi_b32 v49, v9, v77, v49
  v_bfi_b32 v53, v9, v53, v77
  v_bfi_b32 v50, v9, v78, v50
  v_bfi_b32 v54, v9, v54, v78
  v_bfi_b32 v51, v9, v79, v51
  v_bfi_b32 v55, v9, v55, v79
  s_barrier
  s_call_b64 s[86:87], L_skt
  s_barrier
  v_lshlrev_b32 v64, 16, v48
  v_and_b32 v65, 0xffff0000, v48
  v_lshlrev_b32 v66, 16, v49
  v_and_b32 v67, 0xffff0000, v49
  v_fmac_f32 v64, v16, v32
  v_fmac_f32 v65, v17, v33
  v_fmac_f32 v66, v18, v34
  v_fmac_f32 v67, v19, v35
  v_cvt_pk_bf16_f32 v48, v64, v65
  v_cvt_pk_bf16_f32 v49, v66, v67
  v_lshlrev_b32 v64, 16, v50
  v_and_b32 v65, 0xffff0000, v50
  v_lshlrev_b32 v66, 16, v51
  v_and_b32 v67, 0xffff0000, v51
  v_fmac_f32 v64, v20, v36
  v_fmac_f32 v65, v21, v37
  v_fmac_f32 v66, v22, v38
  v_fmac_f32 v67, v23, v39
  v_cvt_pk_bf16_f32 v50, v64, v65
  v_cvt_pk_bf16_f32 v51, v66, v67
  v_lshlrev_b32 v64, 16, v52
  v_and_b32 v65, 0xffff0000, v52
  v_lshlrev_b32 v66, 16, v53
  v_and_b32 v67, 0xffff0000, v53
  v_fmac_f32 v64, v24, v40
  v_fmac_f32 v65, v25, v41
  v_fmac_f32 v66, v26, v42
  v_fmac_f32 v67, v27, v43
  v_cvt_pk_bf16_f32 v52, v64, v65
  v_cvt_pk_bf16_f32 v53, v66, v67
  v_lshlrev_b32 v64, 16, v54
  v_and_b32 v65, 0xffff0000, v54
  v_lshlrev_b32 v66, 16, v55
  v_and_b32 v67, 0xffff0000, v55
  v_fmac_f32 v64, v28, v44
  v_fmac_f32 v65, v29, v45
  v_fmac_f32 v66, v30, v46
  v_fmac_f32 v67, v31, v47
  v_cvt_pk_bf16_f32 v54, v64, v65
  v_cvt_pk_bf16_f32 v55, v66, v67
  s_nop 1
  v_bfi_b32 v64, v8, v48, v50
  v_bfi_b32 v65, v8, v49, v51
  v_bfi_b32 v66, v8, v52, v54
  v_bfi_b32 v67, v8, v53, v55
  v_mov_b32_dpp v76, v64 quad_perm:[1,0,3,2] row_mask:0xf bank_mask:0xf
  v_mov_b32_dpp v77, v65 quad_perm:[1,0,3,2] row_mask:0xf bank_mask:0xf
  v_mov_b32_dpp v78, v66 quad_perm:[1,0,3,2] row_mask:0xf bank_mask:0xf
  v_mov_b32_dpp v79, v67 quad_perm:[1,0,3,2] row_mask:0xf bank_mask:0xf
  v_bfi_b32 v48, v8, v76, v48
  v_bfi_b32 v50, v8, v50, v76
  v_bfi_b32 v49, v8, v77, v49
  v_bfi_b32 v51, v8, v51, v77
  v_bfi_b32 v52, v8, v78, v52
  v_bfi_b32 v54, v8, v54, v78
  v_bfi_b32 v53, v8, v79, v53
  v_bfi_b32 v55, v8, v55, v79
  v_bfi_b32 v64, v9, v48, v52
  v_bfi_b32 v65, v9, v49, v53
  v_bfi_b32 v66, v9, v50, v54
  v_bfi_b32 v67, v9, v51, v55
  v_mov_b32_dpp v76, v64 quad_perm:[2,3,0,1] row_mask:0xf bank_mask:0xf
  v_mov_b32_dpp v77, v65 quad_perm:[2,3,0,1] row_mask:0xf bank_mask:0xf
  v_mov_b32_dpp v78, v66 quad_perm:[2,3,0,1] row_mask:0xf bank_mask:0xf
  v_mov_b32_dpp v79, v67 quad_perm:[2,3,0,1] row_mask:0xf bank_mask:0xf
  v_bfi_b32 v48, v9, v76, v48
  v_bfi_b32 v52, v9, v52, v76
  v_bfi_b32 v49, v9, v77, v49
  v_bfi_b32 v53, v9, v53, v77
  v_bfi_b32 v50, v9, v78, v50
  v_bfi_b32 v54, v9, v54, v78
  v_bfi_b32 v51, v9, v79, v51
  v_bfi_b32 v55, v9, v55, v79
  s_nop 1
  v_permlane16_swap_b32 v48, v50
  v_permlane16_swap_b32 v49, v51
  v_permlane16_swap_b32 v52, v54
  v_permlane16_swap_b32 v53, v55
  buffer_store_dwordx4 v[48:51], v248, s[24:27], 0 offen sc1
  buffer_store_dwordx4 v[52:55], v249, s[24:27], 0 offen sc1
L_sk_14_e:
  s_add_u32 s92, s61, s3
  s_cmp_lg_u32 s92, 0
  s_cbranch_scc1 L_sk_14_t
  v_mov_b32 v255, s11
  s_mov_b32 s92, 151424
  s_mov_b64 exec, 1
  buffer_store_dword v255, v13, s[12:15], s92 offen sc1
  s_mov_b64 exec, -1
L_sk_14_t:
  s_branch L_cx_next
L_cx_X:
  s_lshl_b32 s92, s9, 1
  s_add_u32 s92, s92, 6
  s_add_u32 s93, s9, 48
  s_cmp_lt_u32 s9, 42
  s_cselect_b32 s92, s93, s92
  s_mov_b32 s81, 1
  s_mov_b32 s66, 1
  s_lshr_b32 s71, s3, 2
  s_mov_b32 s79, 153792
  s_mul_i32 s75, s71, 2048
  s_add_u32 s79, s79, s75
  s_mov_b32 s80, 163528
  s_mul_i32 s75, s71, 4
  s_add_u32 s80, s80, s75
  s_mov_b32 s71, s81
  s_mov_b32 s81, s92
  s_mul_hi_u32 s92, s81, 1431655766
  s_mul_i32 s93, s92, 3
  s_sub_u32 s93, s81, s93
  s_lshl_b32 s67, s92, 7
  s_mul_i32 s70, s93, 384
  s_movk_i32 s78, 9216
  s_mov_b32 s76, 151552
  s_mul_i32 s75, s93, 36864
  s_add_u32 s76, s76, s75
  s_mul_i32 s75, s71, 18432
  s_add_u32 s76, s76, s75
  s_mul_i32 s75, s92, 256
  s_add_u32 s76, s76, s75
  s_mov_b32 s77, 4
  s_mov_b32 s6, -1
  s_call_b64 s[86:87], L_gemv
  s_barrier
  s_branch L_cx_next
L_cx_G:
  s_barrier
  s_lshl_b32 s92, s62, 1
  s_add_u32 s92, s92, 0
  s_add_u32 s10, s10, 1
  s_cmp_lt_u32 s62, 12
  s_cselect_b32 s93, 24, 2
  s_add_u32 s62, s62, s93
  s_cmp_ge_u32 s92, 36
  s_cselect_b32 s93, 1, 0
  s_mul_i32 s75, s93, 36
  s_sub_u32 s92, s92, s75
  s_lshr_b32 s71, s3, 2
  s_mov_b32 s79, 153792
  s_mul_i32 s75, s71, 2048
  s_add_u32 s79, s79, s75
  s_mov_b32 s80, 163560
  s_mul_i32 s75, s71, 4
  s_add_u32 s80, s80, s75
  s_mov_b32 s81, s92
  s_mul_hi_u32 s71, s81, 238609295
  s_mul_i32 s92, s71, 18
  s_sub_u32 s92, s81, s92
  s_lshl_b32 s66, s93, 1
  s_add_u32 s66, s66, 1
  s_lshl_b32 s67, s92, 7
  s_add_u32 s67, s67, 4608
  s_movk_i32 s78, 4608
  s_mul_i32 s70, s93, 384
  s_mov_b32 s6, 0
  s_mul_i32 s75, s81, 256
  s_add_u32 s6, s6, s75
  s_mul_i32 s75, s93, 128
  s_add_u32 s6, s6, s75
  s_mov_b32 s76, 262144
  s_mul_i32 s75, s93, 18432
  s_add_u32 s76, s76, s75
  s_mul_i32 s75, s71, 9216
  s_add_u32 s76, s76, s75
  s_mul_i32 s75, s92, 256
  s_add_u32 s76, s76, s75
  s_lshl_b32 s77, s10, 2
  s_call_b64 s[86:87], L_gemv
  s_branch L_cx_next
L_cx_OP:
  s_sub_u32 s61, s9, 36
  s_lshl_b32 s65, s61, 7
  s_branch L_cx_next
L_skt:
  s_mov_b32 s92, 0
  buffer_load_dwordx4 v[64:67], v246, s[20:23], s92 offen offset:0 sc1
  buffer_load_dwordx4 v[68:71], v246, s[20:23], s92 offen offset:1024 sc1
  buffer_load_dwordx4 v[72:75], v246, s[20:23], s92 offen offset:2048 sc1
  buffer_load_dwordx4 v[76:79], v246, s[20:23], s92 offen offset:3072 sc1
  s_mov_b32 s92, 4096
  buffer_load_dwordx4 v[80:83], v246, s[20:23], s92 offen offset:0 sc1
  buffer_load_dwordx4 v[84:87], v246, s[20:23], s92 offen offset:1024 sc1
  buffer_load_dwordx4 v[88:91], v246, s[20:23], s92 offen offset:2048 sc1
  buffer_load_dwordx4 v[92:95], v246, s[20:23], s92 offen offset:3072 sc1
  s_mov_b32 s92, 8192
  buffer_load_dwordx4 v[96:99], v246, s[20:23], s92 offen offset:0 sc1
  buffer_load_dwordx4 v[100:103], v246, s[20:23], s92 offen offset:1024 sc1
  buffer_load_dwordx4 v[104:107], v246, s[20:23], s92 offen offset:2048 sc1
  buffer_load_dwordx4 v[108:111], v246, s[20:23], s92 offen offset:3072 sc1
  ds_read_b64_tr_b16 v[132:133], v2 offset:0
  ds_read_b64_tr_b16 v[134:135], v2 offset:512
  ds_read_b64_tr_b16 v[136:137], v2 offset:32
  ds_read_b64_tr_b16 v[138:139], v2 offset:544
  ds_read_b64_tr_b16 v[140:141], v2 offset:256
  ds_read_b64_tr_b16 v[142:143], v2 offset:768
  ds_read_b64_tr_b16 v[144:145], v2 offset:288
  ds_read_b64_tr_b16 v[146:147], v2 offset:800
  ds_read_b64_tr_b16 v[148:149], v2 offset:4224
  ds_read_b64_tr_b16 v[150:151], v2 offset:4736
  ds_read_b64_tr_b16 v[152:153], v2 offset:4256
  ds_read_b64_tr_b16 v[154:155], v2 offset:4768
  ds_read_b64_tr_b16 v[156:157], v2 offset:4480
  ds_read_b64_tr_b16 v[158:159], v2 offset:4992
  ds_read_b64_tr_b16 v[160:161], v2 offset:4512
  ds_read_b64_tr_b16 v[162:163], v2 offset:5024
  s_waitcnt vmcnt(11)
  s_waitcnt lgkmcnt(14)
  v_mfma_f32_16x16x32_bf16 v[16:19], v[132:135], v[64:67], 0
  ds_read_b64_tr_b16 v[164:165], v2 offset:8448
  ds_read_b64_tr_b16 v[166:167], v2 offset:8960
  s_waitcnt lgkmcnt(14)
  v_mfma_f32_16x16x32_bf16 v[20:23], v[136:139], v[64:67], 0
  ds_read_b64_tr_b16 v[168:169], v2 offset:8480
  ds_read_b64_tr_b16 v[170:171], v2 offset:8992
  s_waitcnt lgkmcnt(14)
  v_mfma_f32_16x16x32_bf16 v[24:27], v[140:143], v[64:67], 0
  ds_read_b64_tr_b16 v[172:173], v2 offset:8704
  ds_read_b64_tr_b16 v[174:175], v2 offset:9216
  s_waitcnt lgkmcnt(14)
  v_mfma_f32_16x16x32_bf16 v[28:31], v[144:147], v[64:67], 0
  ds_read_b64_tr_b16 v[176:177], v2 offset:8736
  ds_read_b64_tr_b16 v[178:179], v2 offset:9248
  s_mov_b32 s92, 12288
  buffer_load_dwordx4 v[112:115], v246, s[20:23], s92 offen offset:0 sc1
  s_waitcnt vmcnt(11)
  s_waitcnt lgkmcnt(14)
  v_mfma_f32_16x16x32_bf16 v[16:19], v[148:151], v[68:71], v[16:19]
  ds_read_b64_tr_b16 v[132:133], v2 offset:12672
  ds_read_b64_tr_b16 v[134:135], v2 offset:13184
  s_waitcnt lgkmcnt(14)
  v_mfma_f32_16x16x32_bf16 v[20:23], v[152:155], v[68:71], v[20:23]
  ds_read_b64_tr_b16 v[136:137], v2 offset:12704
  ds_read_b64_tr_b16 v[138:139], v2 offset:13216
  s_waitcnt lgkmcnt(14)
  v_mfma_f32_16x16x32_bf16 v[24:27], v[156:159], v[68:71], v[24:27]
  ds_read_b64_tr_b16 v[140:141], v2 offset:12928
  ds_read_b64_tr_b16 v[142:143], v2 offset:13440
  s_waitcnt lgkmcnt(14)
  v_mfma_f32_16x16x32_bf16 v[28:31], v[160:163], v[68:71], v[28:31]
  ds_read_b64_tr_b16 v[144:145], v2 offset:12960
  ds_read_b64_tr_b16 v[146:147], v2 offset:13472
  buffer_load_dwordx4 v[116:119], v246, s[20:23], s92 offen offset:1024 sc1
  s_waitcnt vmcnt(11)
  s_waitcnt lgkmcnt(14)
  v_mfma_f32_16x16x32_bf16 v[16:19], v[164:167], v[72:75], v[16:19]
  ds_read_b64_tr_b16 v[148:149], v2 offset:16896
  ds_read_b64_tr_b16 v[150:151], v2 offset:17408
  s_waitcnt lgkmcnt(14)
  v_mfma_f32_16x16x32_bf16 v[20:23], v[168:171], v[72:75], v[20:23]
  ds_read_b64_tr_b16 v[152:153], v2 offset:16928
  ds_read_b64_tr_b16 v[154:155], v2 offset:17440
  s_waitcnt lgkmcnt(14)
  v_mfma_f32_16x16x32_bf16 v[24:27], v[172:175], v[72:75], v[24:27]
  ds_read_b64_tr_b16 v[156:157], v2 offset:17152
  ds_read_b64_tr_b16 v[158:159], v2 offset:17664
  s_waitcnt lgkmcnt(14)
  v_mfma_f32_16x16x32_bf16 v[28:31], v[176:179], v[72:75], v[28:31]
  ds_read_b64_tr_b16 v[160:161], v2 offset:17184
  ds_read_b64_tr_b16 v[162:163], v2 offset:17696
  buffer_load_dwordx4 v[120:123], v246, s[20:23], s92 offen offset:2048 sc1
  s_waitcnt vmcnt(11)
  s_waitcnt lgkmcnt(14)
  v_mfma_f32_16x16x32_bf16 v[16:19], v[132:135], v[76:79], v[16:19]
  ds_read_b64_tr_b16 v[164:165], v2 offset:21120
  ds_read_b64_tr_b16 v[166:167], v2 offset:21632
  s_waitcnt lgkmcnt(14)
  v_mfma_f32_16x16x32_bf16 v[20:23], v[136:139], v[76:79], v[20:23]
  ds_read_b64_tr_b16 v[168:169], v2 offset:21152
  ds_read_b64_tr_b16 v[170:171], v2 offset:21664
  s_waitcnt lgkmcnt(14)
  v_mfma_f32_16x16x32_bf16 v[24:27], v[140:143], v[76:79], v[24:27]
  ds_read_b64_tr_b16 v[172:173], v2 offset:21376
  ds_read_b64_tr_b16 v[174:175], v2 offset:21888
  s_waitcnt lgkmcnt(14)
  v_mfma_f32_16x16x32_bf16 v[28:31], v[144:147], v[76:79], v[28:31]
  ds_read_b64_tr_b16 v[176:177], v2 offset:21408
  ds_read_b64_tr_b16 v[178:179], v2 offset:21920
  buffer_load_dwordx4 v[124:127], v246, s[20:23], s92 offen offset:3072 sc1
  s_waitcnt vmcnt(11)
  s_waitcnt lgkmcnt(14)
  v_mfma_f32_16x16x32_bf16 v[16:19], v[148:151], v[80:83], v[16:19]
  ds_read_b64_tr_b16 v[132:133], v2 offset:25344
  ds_read_b64_tr_b16 v[134:135], v2 offset:25856
  s_waitcnt lgkmcnt(14)
  v_mfma_f32_16x16x32_bf16 v[20:23], v[152:155], v[80:83], v[20:23]
  ds_read_b64_tr_b16 v[136:137], v2 offset:25376
  ds_read_b64_tr_b16 v[138:139], v2 offset:25888
  s_waitcnt lgkmcnt(14)
  v_mfma_f32_16x16x32_bf16 v[24:27], v[156:159], v[80:83], v[24:27]
  ds_read_b64_tr_b16 v[140:141], v2 offset:25600
  ds_read_b64_tr_b16 v[142:143], v2 offset:26112
  s_waitcnt lgkmcnt(14)
  v_mfma_f32_16x16x32_bf16 v[28:31], v[160:163], v[80:83], v[28:31]
  ds_read_b64_tr_b16 v[144:145], v2 offset:25632
  ds_read_b64_tr_b16 v[146:147], v2 offset:26144
  s_mov_b32 s92, 16384
  buffer_load_dwordx4 v[128:131], v246, s[20:23], s92 offen offset:0 sc1
  s_waitcnt vmcnt(11)
  s_waitcnt lgkmcnt(14)
  v_mfma_f32_16x16x32_bf16 v[16:19], v[164:167], v[84:87], v[16:19]
  ds_read_b64_tr_b16 v[148:149], v2 offset:29568
  ds_read_b64_tr_b16 v[150:151], v2 offset:30080
  s_waitcnt lgkmcnt(14)
  v_mfma_f32_16x16x32_bf16 v[20:23], v[168:171], v[84:87], v[20:23]
  ds_read_b64_tr_b16 v[152:153], v2 offset:29600
  ds_read_b64_tr_b16 v[154:155], v2 offset:30112
  s_waitcnt lgkmcnt(14)
  v_mfma_f32_16x16x32_bf16 v[24:27], v[172:175], v[84:87], v[24:27]
  ds_read_b64_tr_b16 v[156:157], v2 offset:29824
  ds_read_b64_tr_b16 v[158:159], v2 offset:30336
  s_waitcnt lgkmcnt(14)
  v_mfma_f32_16x16x32_bf16 v[28:31], v[176:179], v[84:87], v[28:31]
  ds_read_b64_tr_b16 v[160:161], v2 offset:29856
  ds_read_b64_tr_b16 v[162:163], v2 offset:30368
  buffer_load_dwordx4 v[64:67], v246, s[20:23], s92 offen offset:1024 sc1
  s_waitcnt vmcnt(11)
  s_waitcnt lgkmcnt(14)
  v_mfma_f32_16x16x32_bf16 v[16:19], v[132:135], v[88:91], v[16:19]
  ds_read_b64_tr_b16 v[164:165], v2 offset:33792
  ds_read_b64_tr_b16 v[166:167], v2 offset:34304
  s_waitcnt lgkmcnt(14)
  v_mfma_f32_16x16x32_bf16 v[20:23], v[136:139], v[88:91], v[20:23]
  ds_read_b64_tr_b16 v[168:169], v2 offset:33824
  ds_read_b64_tr_b16 v[170:171], v2 offset:34336
  s_waitcnt lgkmcnt(14)
  v_mfma_f32_16x16x32_bf16 v[24:27], v[140:143], v[88:91], v[24:27]
  ds_read_b64_tr_b16 v[172:173], v2 offset:34048
  ds_read_b64_tr_b16 v[174:175], v2 offset:34560
  s_waitcnt lgkmcnt(14)
  v_mfma_f32_16x16x32_bf16 v[28:31], v[144:147], v[88:91], v[28:31]
  ds_read_b64_tr_b16 v[176:177], v2 offset:34080
  ds_read_b64_tr_b16 v[178:179], v2 offset:34592
  buffer_load_dwordx4 v[68:71], v246, s[20:23], s92 offen offset:2048 sc1
  s_waitcnt vmcnt(11)
  s_waitcnt lgkmcnt(14)
  v_mfma_f32_16x16x32_bf16 v[16:19], v[148:151], v[92:95], v[16:19]
  ds_read_b64_tr_b16 v[132:133], v2 offset:38016
  ds_read_b64_tr_b16 v[134:135], v2 offset:38528
  s_waitcnt lgkmcnt(14)
  v_mfma_f32_16x16x32_bf16 v[20:23], v[152:155], v[92:95], v[20:23]
  ds_read_b64_tr_b16 v[136:137], v2 offset:38048
  ds_read_b64_tr_b16 v[138:139], v2 offset:38560
  s_waitcnt lgkmcnt(14)
  v_mfma_f32_16x16x32_bf16 v[24:27], v[156:159], v[92:95], v[24:27]
  ds_read_b64_tr_b16 v[140:141], v2 offset:38272
  ds_read_b64_tr_b16 v[142:143], v2 offset:38784
  s_waitcnt lgkmcnt(14)
  v_mfma_f32_16x16x32_bf16 v[28:31], v[160:163], v[92:95], v[28:31]
  ds_read_b64_tr_b16 v[144:145], v2 offset:38304
  ds_read_b64_tr_b16 v[146:147], v2 offset:38816
  buffer_load_dwordx4 v[72:75], v246, s[20:23], s92 offen offset:3072 sc1
  s_waitcnt vmcnt(11)
  s_waitcnt lgkmcnt(14)
  v_mfma_f32_16x16x32_bf16 v[16:19], v[164:167], v[96:99], v[16:19]
  ds_read_b64_tr_b16 v[148:149], v2 offset:42240
  ds_read_b64_tr_b16 v[150:151], v2 offset:42752
  s_waitcnt lgkmcnt(14)
  v_mfma_f32_16x16x32_bf16 v[20:23], v[168:171], v[96:99], v[20:23]
  ds_read_b64_tr_b16 v[152:153], v2 offset:42272
  ds_read_b64_tr_b16 v[154:155], v2 offset:42784
  s_waitcnt lgkmcnt(14)
  v_mfma_f32_16x16x32_bf16 v[24:27], v[172:175], v[96:99], v[24:27]
  ds_read_b64_tr_b16 v[156:157], v2 offset:42496
  ds_read_b64_tr_b16 v[158:159], v2 offset:43008
  s_waitcnt lgkmcnt(14)
  v_mfma_f32_16x16x32_bf16 v[28:31], v[176:179], v[96:99], v[28:31]
  ds_read_b64_tr_b16 v[160:161], v2 offset:42528
  ds_read_b64_tr_b16 v[162:163], v2 offset:43040
  s_mov_b32 s92, 20480
  buffer_load_dwordx4 v[76:79], v246, s[20:23], s92 offen offset:0 sc1
  s_waitcnt vmcnt(11)
  s_waitcnt lgkmcnt(14)
  v_mfma_f32_16x16x32_bf16 v[16:19], v[132:135], v[100:103], v[16:19]
  ds_read_b64_tr_b16 v[164:165], v2 offset:46464
  ds_read_b64_tr_b16 v[166:167], v2 offset:46976
  s_waitcnt lgkmcnt(14)
  v_mfma_f32_16x16x32_bf16 v[20:23], v[136:139], v[100:103], v[20:23]
  ds_read_b64_tr_b16 v[168:169], v2 offset:46496
  ds_read_b64_tr_b16 v[170:171], v2 offset:47008
  s_waitcnt lgkmcnt(14)
  v_mfma_f32_16x16x32_bf16 v[24:27], v[140:143], v[100:103], v[24:27]
  ds_read_b64_tr_b16 v[172:173], v2 offset:46720
  ds_read_b64_tr_b16 v[174:175], v2 offset:47232
  s_waitcnt lgkmcnt(14)
  v_mfma_f32_16x16x32_bf16 v[28:31], v[144:147], v[100:103], v[28:31]
  ds_read_b64_tr_b16 v[176:177], v2 offset:46752
  ds_read_b64_tr_b16 v[178:179], v2 offset:47264
  buffer_load_dwordx4 v[80:83], v246, s[20:23], s92 offen offset:1024 sc1
  s_waitcnt vmcnt(11)
  s_waitcnt lgkmcnt(14)
  v_mfma_f32_16x16x32_bf16 v[16:19], v[148:151], v[104:107], v[16:19]
  ds_read_b64_tr_b16 v[132:133], v3 offset:0
  ds_read_b64_tr_b16 v[134:135], v3 offset:512
  s_waitcnt lgkmcnt(14)
  v_mfma_f32_16x16x32_bf16 v[20:23], v[152:155], v[104:107], v[20:23]
  ds_read_b64_tr_b16 v[136:137], v3 offset:32
  ds_read_b64_tr_b16 v[138:139], v3 offset:544
  s_waitcnt lgkmcnt(14)
  v_mfma_f32_16x16x32_bf16 v[24:27], v[156:159], v[104:107], v[24:27]
  ds_read_b64_tr_b16 v[140:141], v3 offset:256
  ds_read_b64_tr_b16 v[142:143], v3 offset:768
  s_waitcnt lgkmcnt(14)
  v_mfma_f32_16x16x32_bf16 v[28:31], v[160:163], v[104:107], v[28:31]
  ds_read_b64_tr_b16 v[144:145], v3 offset:288
  ds_read_b64_tr_b16 v[146:147], v3 offset:800
  buffer_load_dwordx4 v[84:87], v246, s[20:23], s92 offen offset:2048 sc1
  s_waitcnt vmcnt(11)
  s_waitcnt lgkmcnt(14)
  v_mfma_f32_16x16x32_bf16 v[16:19], v[164:167], v[108:111], v[16:19]
  ds_read_b64_tr_b16 v[148:149], v3 offset:4224
  ds_read_b64_tr_b16 v[150:151], v3 offset:4736
  s_waitcnt lgkmcnt(14)
  v_mfma_f32_16x16x32_bf16 v[20:23], v[168:171], v[108:111], v[20:23]
  ds_read_b64_tr_b16 v[152:153], v3 offset:4256
  ds_read_b64_tr_b16 v[154:155], v3 offset:4768
  s_waitcnt lgkmcnt(14)
  v_mfma_f32_16x16x32_bf16 v[24:27], v[172:175], v[108:111], v[24:27]
  ds_read_b64_tr_b16 v[156:157], v3 offset:4480
  ds_read_b64_tr_b16 v[158:159], v3 offset:4992
  s_waitcnt lgkmcnt(14)
  v_mfma_f32_16x16x32_bf16 v[28:31], v[176:179], v[108:111], v[28:31]
  ds_read_b64_tr_b16 v[160:161], v3 offset:4512
  ds_read_b64_tr_b16 v[162:163], v3 offset:5024
  buffer_load_dwordx4 v[88:91], v246, s[20:23], s92 offen offset:3072 sc1
  s_waitcnt vmcnt(11)
  s_waitcnt lgkmcnt(14)
  v_mfma_f32_16x16x32_bf16 v[16:19], v[132:135], v[112:115], v[16:19]
  ds_read_b64_tr_b16 v[164:165], v3 offset:8448
  ds_read_b64_tr_b16 v[166:167], v3 offset:8960
  s_waitcnt lgkmcnt(14)
  v_mfma_f32_16x16x32_bf16 v[20:23], v[136:139], v[112:115], v[20:23]
  ds_read_b64_tr_b16 v[168:169], v3 offset:8480
  ds_read_b64_tr_b16 v[170:171], v3 offset:8992
  s_waitcnt lgkmcnt(14)
  v_mfma_f32_16x16x32_bf16 v[24:27], v[140:143], v[112:115], v[24:27]
  ds_read_b64_tr_b16 v[172:173], v3 offset:8704
  ds_read_b64_tr_b16 v[174:175], v3 offset:9216
  s_waitcnt lgkmcnt(14)
  v_mfma_f32_16x16x32_bf16 v[28:31], v[144:147], v[112:115], v[28:31]
  ds_read_b64_tr_b16 v[176:177], v3 offset:8736
  ds_read_b64_tr_b16 v[178:179], v3 offset:9248
  s_mov_b32 s92, 24576
  buffer_load_dwordx4 v[92:95], v246, s[20:23], s92 offen offset:0 sc1
  s_waitcnt vmcnt(11)
  s_waitcnt lgkmcnt(14)
  v_mfma_f32_16x16x32_bf16 v[16:19], v[148:151], v[116:119], v[16:19]
  ds_read_b64_tr_b16 v[132:133], v3 offset:12672
  ds_read_b64_tr_b16 v[134:135], v3 offset:13184
  s_waitcnt lgkmcnt(14)
  v_mfma_f32_16x16x32_bf16 v[20:23], v[152:155], v[116:119], v[20:23]
  ds_read_b64_tr_b16 v[136:137], v3 offset:12704
  ds_read_b64_tr_b16 v[138:139], v3 offset:13216
  s_waitcnt lgkmcnt(14)
  v_mfma_f32_16x16x32_bf16 v[24:27], v[156:159], v[116:119], v[24:27]
  ds_read_b64_tr_b16 v[140:141], v3 offset:12928
  ds_read_b64_tr_b16 v[142:143], v3 offset:13440
  s_waitcnt lgkmcnt(14)
  v_mfma_f32_16x16x32_bf16 v[28:31], v[160:163], v[116:119], v[28:31]
  ds_read_b64_tr_b16 v[144:145], v3 offset:12960
  ds_read_b64_tr_b16 v[146:147], v3 offset:13472
  buffer_load_dwordx4 v[96:99], v246, s[20:23], s92 offen offset:1024 sc1
  s_waitcnt vmcnt(11)
  s_waitcnt lgkmcnt(14)
  v_mfma_f32_16x16x32_bf16 v[16:19], v[164:167], v[120:123], v[16:19]
  ds_read_b64_tr_b16 v[148:149], v3 offset:16896
  ds_read_b64_tr_b16 v[150:151], v3 offset:17408
  s_waitcnt lgkmcnt(14)
  v_mfma_f32_16x16x32_bf16 v[20:23], v[168:171], v[120:123], v[20:23]
  ds_read_b64_tr_b16 v[152:153], v3 offset:16928
  ds_read_b64_tr_b16 v[154:155], v3 offset:17440
  s_waitcnt lgkmcnt(14)
  v_mfma_f32_16x16x32_bf16 v[24:27], v[172:175], v[120:123], v[24:27]
  ds_read_b64_tr_b16 v[156:157], v3 offset:17152
  ds_read_b64_tr_b16 v[158:159], v3 offset:17664
  s_waitcnt lgkmcnt(14)
  v_mfma_f32_16x16x32_bf16 v[28:31], v[176:179], v[120:123], v[28:31]
  ds_read_b64_tr_b16 v[160:161], v3 offset:17184
  ds_read_b64_tr_b16 v[162:163], v3 offset:17696
  buffer_load_dwordx4 v[100:103], v246, s[20:23], s92 offen offset:2048 sc1
  s_waitcnt vmcnt(11)
  s_waitcnt lgkmcnt(14)
  v_mfma_f32_16x16x32_bf16 v[16:19], v[132:135], v[124:127], v[16:19]
  ds_read_b64_tr_b16 v[164:165], v3 offset:21120
  ds_read_b64_tr_b16 v[166:167], v3 offset:21632
  s_waitcnt lgkmcnt(14)
  v_mfma_f32_16x16x32_bf16 v[20:23], v[136:139], v[124:127], v[20:23]
  ds_read_b64_tr_b16 v[168:169], v3 offset:21152
  ds_read_b64_tr_b16 v[170:171], v3 offset:21664
  s_waitcnt lgkmcnt(14)
  v_mfma_f32_16x16x32_bf16 v[24:27], v[140:143], v[124:127], v[24:27]
  ds_read_b64_tr_b16 v[172:173], v3 offset:21376
  ds_read_b64_tr_b16 v[174:175], v3 offset:21888
  s_waitcnt lgkmcnt(14)
  v_mfma_f32_16x16x32_bf16 v[28:31], v[144:147], v[124:127], v[28:31]
  ds_read_b64_tr_b16 v[176:177], v3 offset:21408
  ds_read_b64_tr_b16 v[178:179], v3 offset:21920
  buffer_load_dwordx4 v[104:107], v246, s[20:23], s92 offen offset:3072 sc1
  s_waitcnt vmcnt(11)
  s_waitcnt lgkmcnt(14)
  v_mfma_f32_16x16x32_bf16 v[16:19], v[148:151], v[128:131], v[16:19]
  ds_read_b64_tr_b16 v[132:133], v3 offset:25344
  ds_read_b64_tr_b16 v[134:135], v3 offset:25856
  s_waitcnt lgkmcnt(14)
  v_mfma_f32_16x16x32_bf16 v[20:23], v[152:155], v[128:131], v[20:23]
  ds_read_b64_tr_b16 v[136:137], v3 offset:25376
  ds_read_b64_tr_b16 v[138:139], v3 offset:25888
  s_waitcnt lgkmcnt(14)
  v_mfma_f32_16x16x32_bf16 v[24:27], v[156:159], v[128:131], v[24:27]
  ds_read_b64_tr_b16 v[140:141], v3 offset:25600
  ds_read_b64_tr_b16 v[142:143], v3 offset:26112
  s_waitcnt lgkmcnt(14)
  v_mfma_f32_16x16x32_bf16 v[28:31], v[160:163], v[128:131], v[28:31]
  ds_read_b64_tr_b16 v[144:145], v3 offset:25632
  ds_read_b64_tr_b16 v[146:147], v3 offset:26144
  s_mov_b32 s92, 28672
  buffer_load_dwordx4 v[108:111], v246, s[20:23], s92 offen offset:0 sc1
  s_waitcnt vmcnt(11)
  s_waitcnt lgkmcnt(14)
  v_mfma_f32_16x16x32_bf16 v[16:19], v[164:167], v[64:67], v[16:19]
  ds_read_b64_tr_b16 v[148:149], v3 offset:29568
  ds_read_b64_tr_b16 v[150:151], v3 offset:30080
  s_waitcnt lgkmcnt(14)
  v_mfma_f32_16x16x32_bf16 v[20:23], v[168:171], v[64:67], v[20:23]
  ds_read_b64_tr_b16 v[152:153], v3 offset:29600
  ds_read_b64_tr_b16 v[154:155], v3 offset:30112
  s_waitcnt lgkmcnt(14)
  v_mfma_f32_16x16x32_bf16 v[24:27], v[172:175], v[64:67], v[24:27]
  ds_read_b64_tr_b16 v[156:157], v3 offset:29824
  ds_read_b64_tr_b16 v[158:159], v3 offset:30336
  s_waitcnt lgkmcnt(14)
  v_mfma_f32_16x16x32_bf16 v[28:31], v[176:179], v[64:67], v[28:31]
  ds_read_b64_tr_b16 v[160:161], v3 offset:29856
  ds_read_b64_tr_b16 v[162:163], v3 offset:30368
  buffer_load_dwordx4 v[112:115], v246, s[20:23], s92 offen offset:1024 sc1
  s_waitcnt vmcnt(11)
  s_waitcnt lgkmcnt(14)
  v_mfma_f32_16x16x32_bf16 v[16:19], v[132:135], v[68:71], v[16:19]
  ds_read_b64_tr_b16 v[164:165], v3 offset:33792
  ds_read_b64_tr_b16 v[166:167], v3 offset:34304
  s_waitcnt lgkmcnt(14)
  v_mfma_f32_16x16x32_bf16 v[20:23], v[136:139], v[68:71], v[20:23]
  ds_read_b64_tr_b16 v[168:169], v3 offset:33824
  ds_read_b64_tr_b16 v[170:171], v3 offset:34336
  s_waitcnt lgkmcnt(14)
  v_mfma_f32_16x16x32_bf16 v[24:27], v[140:143], v[68:71], v[24:27]
  ds_read_b64_tr_b16 v[172:173], v3 offset:34048
  ds_read_b64_tr_b16 v[174:175], v3 offset:34560
  s_waitcnt lgkmcnt(14)
  v_mfma_f32_16x16x32_bf16 v[28:31], v[144:147], v[68:71], v[28:31]
  ds_read_b64_tr_b16 v[176:177], v3 offset:34080
  ds_read_b64_tr_b16 v[178:179], v3 offset:34592
  buffer_load_dwordx4 v[116:119], v246, s[20:23], s92 offen offset:2048 sc1
  s_waitcnt vmcnt(11)
  s_waitcnt lgkmcnt(14)
  v_mfma_f32_16x16x32_bf16 v[16:19], v[148:151], v[72:75], v[16:19]
  ds_read_b64_tr_b16 v[132:133], v3 offset:38016
  ds_read_b64_tr_b16 v[134:135], v3 offset:38528
  s_waitcnt lgkmcnt(14)
  v_mfma_f32_16x16x32_bf16 v[20:23], v[152:155], v[72:75], v[20:23]
  ds_read_b64_tr_b16 v[136:137], v3 offset:38048
  ds_read_b64_tr_b16 v[138:139], v3 offset:38560
  s_waitcnt lgkmcnt(14)
  v_mfma_f32_16x16x32_bf16 v[24:27], v[156:159], v[72:75], v[24:27]
  ds_read_b64_tr_b16 v[140:141], v3 offset:38272
  ds_read_b64_tr_b16 v[142:143], v3 offset:38784
  s_waitcnt lgkmcnt(14)
  v_mfma_f32_16x16x32_bf16 v[28:31], v[160:163], v[72:75], v[28:31]
  ds_read_b64_tr_b16 v[144:145], v3 offset:38304
  ds_read_b64_tr_b16 v[146:147], v3 offset:38816
  buffer_load_dwordx4 v[120:123], v246, s[20:23], s92 offen offset:3072 sc1
  s_waitcnt vmcnt(11)
  s_waitcnt lgkmcnt(14)
  v_mfma_f32_16x16x32_bf16 v[16:19], v[164:167], v[76:79], v[16:19]
  ds_read_b64_tr_b16 v[148:149], v3 offset:42240
  ds_read_b64_tr_b16 v[150:151], v3 offset:42752
  s_waitcnt lgkmcnt(14)
  v_mfma_f32_16x16x32_bf16 v[20:23], v[168:171], v[76:79], v[20:23]
  ds_read_b64_tr_b16 v[152:153], v3 offset:42272
  ds_read_b64_tr_b16 v[154:155], v3 offset:42784
  s_waitcnt lgkmcnt(14)
  v_mfma_f32_16x16x32_bf16 v[24:27], v[172:175], v[76:79], v[24:27]
  ds_read_b64_tr_b16 v[156:157], v3 offset:42496
  ds_read_b64_tr_b16 v[158:159], v3 offset:43008
  s_waitcnt lgkmcnt(14)
  v_mfma_f32_16x16x32_bf16 v[28:31], v[176:179], v[76:79], v[28:31]
  ds_read_b64_tr_b16 v[160:161], v3 offset:42528
  ds_read_b64_tr_b16 v[162:163], v3 offset:43040
  s_mov_b32 s92, 32768
  buffer_load_dwordx4 v[124:127], v246, s[20:23], s92 offen offset:0 sc1
  s_waitcnt vmcnt(11)
  s_waitcnt lgkmcnt(14)
  v_mfma_f32_16x16x32_bf16 v[16:19], v[132:135], v[80:83], v[16:19]
  ds_read_b64_tr_b16 v[164:165], v3 offset:46464
  ds_read_b64_tr_b16 v[166:167], v3 offset:46976
  s_waitcnt lgkmcnt(14)
  v_mfma_f32_16x16x32_bf16 v[20:23], v[136:139], v[80:83], v[20:23]
  ds_read_b64_tr_b16 v[168:169], v3 offset:46496
  ds_read_b64_tr_b16 v[170:171], v3 offset:47008
  s_waitcnt lgkmcnt(14)
  v_mfma_f32_16x16x32_bf16 v[24:27], v[140:143], v[80:83], v[24:27]
  ds_read_b64_tr_b16 v[172:173], v3 offset:46720
  ds_read_b64_tr_b16 v[174:175], v3 offset:47232
  s_waitcnt lgkmcnt(14)
  v_mfma_f32_16x16x32_bf16 v[28:31], v[144:147], v[80:83], v[28:31]
  ds_read_b64_tr_b16 v[176:177], v3 offset:46752
  ds_read_b64_tr_b16 v[178:179], v3 offset:47264
  buffer_load_dwordx4 v[128:131], v246, s[20:23], s92 offen offset:1024 sc1
  s_waitcnt vmcnt(11)
  s_waitcnt lgkmcnt(14)
  v_mfma_f32_16x16x32_bf16 v[16:19], v[148:151], v[84:87], v[16:19]
  ds_read_b64_tr_b16 v[132:133], v4 offset:0
  ds_read_b64_tr_b16 v[134:135], v4 offset:512
  s_waitcnt lgkmcnt(14)
  v_mfma_f32_16x16x32_bf16 v[20:23], v[152:155], v[84:87], v[20:23]
  ds_read_b64_tr_b16 v[136:137], v4 offset:32
  ds_read_b64_tr_b16 v[138:139], v4 offset:544
  s_waitcnt lgkmcnt(14)
  v_mfma_f32_16x16x32_bf16 v[24:27], v[156:159], v[84:87], v[24:27]
  ds_read_b64_tr_b16 v[140:141], v4 offset:256
  ds_read_b64_tr_b16 v[142:143], v4 offset:768
  s_waitcnt lgkmcnt(14)
  v_mfma_f32_16x16x32_bf16 v[28:31], v[160:163], v[84:87], v[28:31]
  ds_read_b64_tr_b16 v[144:145], v4 offset:288
  ds_read_b64_tr_b16 v[146:147], v4 offset:800
  buffer_load_dwordx4 v[64:67], v246, s[20:23], s92 offen offset:2048 sc1
  s_waitcnt vmcnt(11)
  s_waitcnt lgkmcnt(14)
  v_mfma_f32_16x16x32_bf16 v[16:19], v[164:167], v[88:91], v[16:19]
  ds_read_b64_tr_b16 v[148:149], v4 offset:4224
  ds_read_b64_tr_b16 v[150:151], v4 offset:4736
  s_waitcnt lgkmcnt(14)
  v_mfma_f32_16x16x32_bf16 v[20:23], v[168:171], v[88:91], v[20:23]
  ds_read_b64_tr_b16 v[152:153], v4 offset:4256
  ds_read_b64_tr_b16 v[154:155], v4 offset:4768
  s_waitcnt lgkmcnt(14)
  v_mfma_f32_16x16x32_bf16 v[24:27], v[172:175], v[88:91], v[24:27]
  ds_read_b64_tr_b16 v[156:157], v4 offset:4480
  ds_read_b64_tr_b16 v[158:159], v4 offset:4992
  s_waitcnt lgkmcnt(14)
  v_mfma_f32_16x16x32_bf16 v[28:31], v[176:179], v[88:91], v[28:31]
  ds_read_b64_tr_b16 v[160:161], v4 offset:4512
  ds_read_b64_tr_b16 v[162:163], v4 offset:5024
  buffer_load_dwordx4 v[68:71], v246, s[20:23], s92 offen offset:3072 sc1
  s_waitcnt vmcnt(11)
  s_waitcnt lgkmcnt(14)
  v_mfma_f32_16x16x32_bf16 v[16:19], v[132:135], v[92:95], v[16:19]
  ds_read_b64_tr_b16 v[164:165], v4 offset:8448
  ds_read_b64_tr_b16 v[166:167], v4 offset:8960
  s_waitcnt lgkmcnt(14)
  v_mfma_f32_16x16x32_bf16 v[20:23], v[136:139], v[92:95], v[20:23]
  ds_read_b64_tr_b16 v[168:169], v4 offset:8480
  ds_read_b64_tr_b16 v[170:171], v4 offset:8992
  s_waitcnt lgkmcnt(14)
  v_mfma_f32_16x16x32_bf16 v[24:27], v[140:143], v[92:95], v[24:27]
  ds_read_b64_tr_b16 v[172:173], v4 offset:8704
  ds_read_b64_tr_b16 v[174:175], v4 offset:9216
  s_waitcnt lgkmcnt(14)
  v_mfma_f32_16x16x32_bf16 v[28:31], v[144:147], v[92:95], v[28:31]
  ds_read_b64_tr_b16 v[176:177], v4 offset:8736
  ds_read_b64_tr_b16 v[178:179], v4 offset:9248
  s_waitcnt vmcnt(10)
  s_waitcnt lgkmcnt(14)
  v_mfma_f32_16x16x32_bf16 v[16:19], v[148:151], v[96:99], v[16:19]
  ds_read_b64_tr_b16 v[132:133], v4 offset:12672
  ds_read_b64_tr_b16 v[134:135], v4 offset:13184
  s_waitcnt lgkmcnt(14)
  v_mfma_f32_16x16x32_bf16 v[20:23], v[152:155], v[96:99], v[20:23]
  ds_read_b64_tr_b16 v[136:137], v4 offset:12704
  ds_read_b64_tr_b16 v[138:139], v4 offset:13216
  s_waitcnt lgkmcnt(14)
  v_mfma_f32_16x16x32_bf16 v[24:27], v[156:159], v[96:99], v[24:27]
  ds_read_b64_tr_b16 v[140:141], v4 offset:12928
  ds_read_b64_tr_b16 v[142:143], v4 offset:13440
  s_waitcnt lgkmcnt(14)
  v_mfma_f32_16x16x32_bf16 v[28:31], v[160:163], v[96:99], v[28:31]
  ds_read_b64_tr_b16 v[144:145], v4 offset:12960
  ds_read_b64_tr_b16 v[146:147], v4 offset:13472
  s_waitcnt vmcnt(9)
  s_waitcnt lgkmcnt(14)
  v_mfma_f32_16x16x32_bf16 v[16:19], v[164:167], v[100:103], v[16:19]
  ds_read_b64_tr_b16 v[148:149], v4 offset:16896
  ds_read_b64_tr_b16 v[150:151], v4 offset:17408
  s_waitcnt lgkmcnt(14)
  v_mfma_f32_16x16x32_bf16 v[20:23], v[168:171], v[100:103], v[20:23]
  ds_read_b64_tr_b16 v[152:153], v4 offset:16928
  ds_read_b64_tr_b16 v[154:155], v4 offset:17440
  s_waitcnt lgkmcnt(14)
  v_mfma_f32_16x16x32_bf16 v[24:27], v[172:175], v[100:103], v[24:27]
  ds_read_b64_tr_b16 v[156:157], v4 offset:17152
  ds_read_b64_tr_b16 v[158:159], v4 offset:17664
  s_waitcnt lgkmcnt(14)
  v_mfma_f32_16x16x32_bf16 v[28:31], v[176:179], v[100:103], v[28:31]
  ds_read_b64_tr_b16 v[160:161], v4 offset:17184
  ds_read_b64_tr_b16 v[162:163], v4 offset:17696
  s_waitcnt vmcnt(8)
  s_waitcnt lgkmcnt(14)
  v_mfma_f32_16x16x32_bf16 v[16:19], v[132:135], v[104:107], v[16:19]
  ds_read_b64_tr_b16 v[164:165], v4 offset:21120
  ds_read_b64_tr_b16 v[166:167], v4 offset:21632
  s_waitcnt lgkmcnt(14)
  v_mfma_f32_16x16x32_bf16 v[20:23], v[136:139], v[104:107], v[20:23]
  ds_read_b64_tr_b16 v[168:169], v4 offset:21152
  ds_read_b64_tr_b16 v[170:171], v4 offset:21664
  s_waitcnt lgkmcnt(14)
  v_mfma_f32_16x16x32_bf16 v[24:27], v[140:143], v[104:107], v[24:27]
  ds_read_b64_tr_b16 v[172:173], v4 offset:21376
  ds_read_b64_tr_b16 v[174:175], v4 offset:21888
  s_waitcnt lgkmcnt(14)
  v_mfma_f32_16x16x32_bf16 v[28:31], v[144:147], v[104:107], v[28:31]
  ds_read_b64_tr_b16 v[176:177], v4 offset:21408
  ds_read_b64_tr_b16 v[178:179], v4 offset:21920
  s_waitcnt vmcnt(7)
  s_waitcnt lgkmcnt(14)
  v_mfma_f32_16x16x32_bf16 v[16:19], v[148:151], v[108:111], v[16:19]
  ds_read_b64_tr_b16 v[132:133], v4 offset:25344
  ds_read_b64_tr_b16 v[134:135], v4 offset:25856
  s_waitcnt lgkmcnt(14)
  v_mfma_f32_16x16x32_bf16 v[20:23], v[152:155], v[108:111], v[20:23]
  ds_read_b64_tr_b16 v[136:137], v4 offset:25376
  ds_read_b64_tr_b16 v[138:139], v4 offset:25888
  s_waitcnt lgkmcnt(14)
  v_mfma_f32_16x16x32_bf16 v[24:27], v[156:159], v[108:111], v[24:27]
  ds_read_b64_tr_b16 v[140:141], v4 offset:25600
  ds_read_b64_tr_b16 v[142:143], v4 offset:26112
  s_waitcnt lgkmcnt(14)
  v_mfma_f32_16x16x32_bf16 v[28:31], v[160:163], v[108:111], v[28:31]
  ds_read_b64_tr_b16 v[144:145], v4 offset:25632
  ds_read_b64_tr_b16 v[146:147], v4 offset:26144
  s_waitcnt vmcnt(6)
  s_waitcnt lgkmcnt(14)
  v_mfma_f32_16x16x32_bf16 v[16:19], v[164:167], v[112:115], v[16:19]
  ds_read_b64_tr_b16 v[148:149], v4 offset:29568
  ds_read_b64_tr_b16 v[150:151], v4 offset:30080
  s_waitcnt lgkmcnt(14)
  v_mfma_f32_16x16x32_bf16 v[20:23], v[168:171], v[112:115], v[20:23]
  ds_read_b64_tr_b16 v[152:153], v4 offset:29600
  ds_read_b64_tr_b16 v[154:155], v4 offset:30112
  s_waitcnt lgkmcnt(14)
  v_mfma_f32_16x16x32_bf16 v[24:27], v[172:175], v[112:115], v[24:27]
  ds_read_b64_tr_b16 v[156:157], v4 offset:29824
  ds_read_b64_tr_b16 v[158:159], v4 offset:30336
  s_waitcnt lgkmcnt(14)
  v_mfma_f32_16x16x32_bf16 v[28:31], v[176:179], v[112:115], v[28:31]
  ds_read_b64_tr_b16 v[160:161], v4 offset:29856
  ds_read_b64_tr_b16 v[162:163], v4 offset:30368
  s_waitcnt vmcnt(5)
  s_waitcnt lgkmcnt(14)
  v_mfma_f32_16x16x32_bf16 v[16:19], v[132:135], v[116:119], v[16:19]
  ds_read_b64_tr_b16 v[164:165], v4 offset:33792
  ds_read_b64_tr_b16 v[166:167], v4 offset:34304
  s_waitcnt lgkmcnt(14)
  v_mfma_f32_16x16x32_bf16 v[20:23], v[136:139], v[116:119], v[20:23]
  ds_read_b64_tr_b16 v[168:169], v4 offset:33824
  ds_read_b64_tr_b16 v[170:171], v4 offset:34336
  s_waitcnt lgkmcnt(14)
  v_mfma_f32_16x16x32_bf16 v[24:27], v[140:143], v[116:119], v[24:27]
  ds_read_b64_tr_b16 v[172:173], v4 offset:34048
  ds_read_b64_tr_b16 v[174:175], v4 offset:34560
  s_waitcnt lgkmcnt(14)
  v_mfma_f32_16x16x32_bf16 v[28:31], v[144:147], v[116:119], v[28:31]
  ds_read_b64_tr_b16 v[176:177], v4 offset:34080
  ds_read_b64_tr_b16 v[178:179], v4 offset:34592
  s_waitcnt vmcnt(4)
  s_waitcnt lgkmcnt(14)
  v_mfma_f32_16x16x32_bf16 v[16:19], v[148:151], v[120:123], v[16:19]
  ds_read_b64_tr_b16 v[132:133], v4 offset:38016
  ds_read_b64_tr_b16 v[134:135], v4 offset:38528
  s_waitcnt lgkmcnt(14)
  v_mfma_f32_16x16x32_bf16 v[20:23], v[152:155], v[120:123], v[20:23]
  ds_read_b64_tr_b16 v[136:137], v4 offset:38048
  ds_read_b64_tr_b16 v[138:139], v4 offset:38560
  s_waitcnt lgkmcnt(14)
  v_mfma_f32_16x16x32_bf16 v[24:27], v[156:159], v[120:123], v[24:27]
  ds_read_b64_tr_b16 v[140:141], v4 offset:38272
  ds_read_b64_tr_b16 v[142:143], v4 offset:38784
  s_waitcnt lgkmcnt(14)
  v_mfma_f32_16x16x32_bf16 v[28:31], v[160:163], v[120:123], v[28:31]
  ds_read_b64_tr_b16 v[144:145], v4 offset:38304
  ds_read_b64_tr_b16 v[146:147], v4 offset:38816
  s_waitcnt vmcnt(3)
  s_waitcnt lgkmcnt(14)
  v_mfma_f32_16x16x32_bf16 v[16:19], v[164:167], v[124:127], v[16:19]
  ds_read_b64_tr_b16 v[148:149], v4 offset:42240
  ds_read_b64_tr_b16 v[150:151], v4 offset:42752
  s_waitcnt lgkmcnt(14)
  v_mfma_f32_16x16x32_bf16 v[20:23], v[168:171], v[124:127], v[20:23]
  ds_read_b64_tr_b16 v[152:153], v4 offset:42272
  ds_read_b64_tr_b16 v[154:155], v4 offset:42784
  s_waitcnt lgkmcnt(14)
  v_mfma_f32_16x16x32_bf16 v[24:27], v[172:175], v[124:127], v[24:27]
  ds_read_b64_tr_b16 v[156:157], v4 offset:42496
  ds_read_b64_tr_b16 v[158:159], v4 offset:43008
  s_waitcnt lgkmcnt(14)
  v_mfma_f32_16x16x32_bf16 v[28:31], v[176:179], v[124:127], v[28:31]
  ds_read_b64_tr_b16 v[160:161], v4 offset:42528
  ds_read_b64_tr_b16 v[162:163], v4 offset:43040
  s_waitcnt vmcnt(2)
  s_waitcnt lgkmcnt(14)
  v_mfma_f32_16x16x32_bf16 v[16:19], v[132:135], v[128:131], v[16:19]
  ds_read_b64_tr_b16 v[164:165], v4 offset:46464
  ds_read_b64_tr_b16 v[166:167], v4 offset:46976
  s_waitcnt lgkmcnt(14)
  v_mfma_f32_16x16x32_bf16 v[20:23], v[136:139], v[128:131], v[20:23]
  ds_read_b64_tr_b16 v[168:169], v4 offset:46496
  ds_read_b64_tr_b16 v[170:171], v4 offset:47008
  s_waitcnt lgkmcnt(14)
  v_mfma_f32_16x16x32_bf16 v[24:27], v[140:143], v[128:131], v[24:27]
  ds_read_b64_tr_b16 v[172:173], v4 offset:46720
  ds_read_b64_tr_b16 v[174:175], v4 offset:47232
  s_waitcnt lgkmcnt(14)
  v_mfma_f32_16x16x32_bf16 v[28:31], v[144:147], v[128:131], v[28:31]
  ds_read_b64_tr_b16 v[176:177], v4 offset:46752
  ds_read_b64_tr_b16 v[178:179], v4 offset:47264
  s_waitcnt vmcnt(1)
  s_waitcnt lgkmcnt(14)
  v_mfma_f32_16x16x32_bf16 v[16:19], v[148:151], v[64:67], v[16:19]
  s_waitcnt lgkmcnt(12)
  v_mfma_f32_16x16x32_bf16 v[20:23], v[152:155], v[64:67], v[20:23]
  s_waitcnt lgkmcnt(10)
  v_mfma_f32_16x16x32_bf16 v[24:27], v[156:159], v[64:67], v[24:27]
  s_waitcnt lgkmcnt(8)
  v_mfma_f32_16x16x32_bf16 v[28:31], v[160:163], v[64:67], v[28:31]
  s_waitcnt vmcnt(0)
  s_waitcnt lgkmcnt(6)
  v_mfma_f32_16x16x32_bf16 v[16:19], v[164:167], v[68:71], v[16:19]
  s_waitcnt lgkmcnt(4)
  v_mfma_f32_16x16x32_bf16 v[20:23], v[168:171], v[68:71], v[20:23]
  s_waitcnt lgkmcnt(2)
  v_mfma_f32_16x16x32_bf16 v[24:27], v[172:175], v[68:71], v[24:27]
  s_waitcnt lgkmcnt(0)
  v_mfma_f32_16x16x32_bf16 v[28:31], v[176:179], v[68:71], v[28:31]
  s_nop 7
  s_setpc_b64 s[86:87]
L_sky:
  v_and_b32 v250, 15, v1
  s_lshl_b32 s92, s91, 4
  v_add_lshl_u32 v250, v250, s92, 3
  s_mul_i32 s93, s90, 67584
  v_add_u32 v251, s93, v250
  s_sub_u32 s93, 67584, s93
  v_add_u32 v254, s93, v250
  s_mov_b32 s92, 0
  buffer_load_dwordx2 v[208:209], v254, s[28:31], s92 offen sc1
  s_mov_b32 s92, 8448
  buffer_load_dwordx2 v[210:211], v254, s[28:31], s92 offen sc1
  s_mov_b32 s92, 16896
  buffer_load_dwordx2 v[212:213], v254, s[28:31], s92 offen sc1
  s_mov_b32 s92, 25344
  buffer_load_dwordx2 v[214:215], v254, s[28:31], s92 offen sc1
  s_mov_b32 s92, 33792
  buffer_load_dwordx2 v[216:217], v254, s[28:31], s92 offen sc1
  s_mov_b32 s92, 42240
  buffer_load_dwordx2 v[218:219], v254, s[28:31], s92 offen sc1
  s_mov_b32 s92, 50688
  buffer_load_dwordx2 v[220:221], v254, s[28:31], s92 offen sc1
  s_mov_b32 s92, 59136
  buffer_load_dwordx2 v[222:223], v254, s[28:31], s92 offen sc1
  s_mov_b32 s92, 0
  buffer_load_dwordx2 v[224:225], v251, s[28:31], s92 offen sc1
  s_mov_b32 s92, 8448
  buffer_load_dwordx2 v[226:227], v251, s[28:31], s92 offen sc1
  s_mov_b32 s92, 16896
  buffer_load_dwordx2 v[228:229], v251, s[28:31], s92 offen sc1
  s_mov_b32 s92, 25344
  buffer_load_dwordx2 v[230:231], v251, s[28:31], s92 offen sc1
  s_mov_b32 s92, 33792
  buffer_load_dwordx2 v[232:233], v251, s[28:31], s92 offen sc1
  s_mov_b32 s92, 42240
  buffer_load_dwordx2 v[234:235], v251, s[28:31], s92 offen sc1
  s_mov_b32 s92, 50688
  buffer_load_dwordx2 v[236:237], v251, s[28:31], s92 offen sc1
  s_mov_b32 s92, 59136
  buffer_load_dwordx2 v[238:239], v251, s[28:31], s92 offen sc1
  s_mov_b32 s92, 135168
  buffer_load_dwordx2 v[252:253], v250, s[28:31], s92 offen sc1
  s_mov_b32 s92, 0
  buffer_load_dwordx4 v[64:67], v245, s[20:23], s92 offen offset:0 sc1
  buffer_load_dwordx4 v[68:71], v245, s[20:23], s92 offen offset:1024 sc1
  buffer_load_dwordx4 v[72:75], v245, s[20:23], s92 offen offset:2048 sc1
  buffer_load_dwordx4 v[76:79], v245, s[20:23], s92 offen offset:3072 sc1
  s_mov_b32 s92, 4096
  buffer_load_dwordx4 v[80:83], v245, s[20:23], s92 offen offset:0 sc1
  buffer_load_dwordx4 v[84:87], v245, s[20:23], s92 offen offset:1024 sc1
  buffer_load_dwordx4 v[88:91], v245, s[20:23], s92 offen offset:2048 sc1
  buffer_load_dwordx4 v[92:95], v245, s[20:23], s92 offen offset:3072 sc1
  s_mov_b32 s92, 8192
  buffer_load_dwordx4 v[96:99], v245, s[20:23], s92 offen offset:0 sc1
  buffer_load_dwordx4 v[100:103], v245, s[20:23], s92 offen offset:1024 sc1
  buffer_load_dwordx4 v[104:107], v245, s[20:23], s92 offen offset:2048 sc1
  buffer_load_dwordx4 v[108:111], v245, s[20:23], s92 offen offset:3072 sc1
  s_mov_b32 s92, 12288
  buffer_load_dwordx4 v[112:115], v245, s[20:23], s92 offen offset:0 sc1
  buffer_load_dwordx4 v[116:119], v245, s[20:23], s92 offen offset:1024 sc1
  buffer_load_dwordx4 v[120:123], v245, s[20:23], s92 offen offset:2048 sc1
  buffer_load_dwordx4 v[124:127], v245, s[20:23], s92 offen offset:3072 sc1
  s_mov_b32 s92, 16384
  buffer_load_dwordx4 v[128:131], v245, s[20:23], s92 offen offset:0 sc1
  s_waitcnt vmcnt(17)
  v_max3_f32 v250, v208, v210, v212
  v_max3_f32 v250, v250, v214, v216
  v_max3_f32 v250, v250, v218, v220
  v_max3_f32 v250, v250, v222, v224
  v_max3_f32 v250, v250, v226, v228
  v_max3_f32 v250, v250, v230, v232
  v_max3_f32 v250, v250, v234, v236
  v_max3_f32 v250, v250, v238, v252
  v_sub_f32 v208, v208, v250
  v_sub_f32 v210, v210, v250
  v_sub_f32 v212, v212, v250
  v_sub_f32 v214, v214, v250
  v_sub_f32 v216, v216, v250
  v_sub_f32 v218, v218, v250
  v_sub_f32 v220, v220, v250
  v_sub_f32 v222, v222, v250
  v_sub_f32 v224, v224, v250
  v_sub_f32 v226, v226, v250
  v_sub_f32 v228, v228, v250
  v_sub_f32 v230, v230, v250
  v_sub_f32 v232, v232, v250
  v_sub_f32 v234, v234, v250
  v_sub_f32 v236, v236, v250
  v_sub_f32 v238, v238, v250
  v_sub_f32 v252, v252, v250
  v_exp_f32 v208, v208
  v_exp_f32 v210, v210
  v_exp_f32 v212, v212
  v_exp_f32 v214, v214
  v_exp_f32 v216, v216
  v_exp_f32 v218, v218
  v_exp_f32 v220, v220
  v_exp_f32 v222, v222
  v_exp_f32 v224, v224
  v_exp_f32 v226, v226
  v_exp_f32 v228, v228
  v_exp_f32 v230, v230
  v_exp_f32 v232, v232
  v_exp_f32 v234, v234
  v_exp_f32 v236, v236
  v_exp_f32 v238, v238
  v_exp_f32 v252, v252
  v_mul_f32 v251, v208, v209
  v_fmac_f32 v251, v210, v211
  v_fmac_f32 v251, v212, v213
  v_fmac_f32 v251, v214, v215
  v_fmac_f32 v251, v216, v217
  v_fmac_f32 v251, v218, v219
  v_fmac_f32 v251, v220, v221
  v_fmac_f32 v251, v222, v223
  v_fmac_f32 v251, v224, v225
  v_fmac_f32 v251, v226, v227
  v_fmac_f32 v251, v228, v229
  v_fmac_f32 v251, v230, v231
  v_fmac_f32 v251, v232, v233
  v_fmac_f32 v251, v234, v235
  v_fmac_f32 v251, v236, v237
  v_fmac_f32 v251, v238, v239
  v_fmac_f32 v251, v252, v253
  v_rcp_f32 v251, v251
  s_nop 0
  v_mul_f32 v32, v208, v251
  v_mul_f32 v33, v210, v251
  v_mul_f32 v34, v212, v251
  v_mul_f32 v35, v214, v251
  v_mul_f32 v36, v216, v251
  v_mul_f32 v37, v218, v251
  v_mul_f32 v38, v220, v251
  v_mul_f32 v39, v222, v251
  v_mul_f32 v250, v252, v251
  ds_read_b64_tr_b16 v[132:133], v5 offset:0
  ds_read_b64_tr_b16 v[134:135], v5 offset:512
  ds_read_b64_tr_b16 v[136:137], v5 offset:32
  ds_read_b64_tr_b16 v[138:139], v5 offset:544
  ds_read_b64_tr_b16 v[140:141], v5 offset:256
  ds_read_b64_tr_b16 v[142:143], v5 offset:768
  ds_read_b64_tr_b16 v[144:145], v5 offset:288
  ds_read_b64_tr_b16 v[146:147], v5 offset:800
  ds_read_b64_tr_b16 v[148:149], v5 offset:4224
  ds_read_b64_tr_b16 v[150:151], v5 offset:4736
  ds_read_b64_tr_b16 v[152:153], v5 offset:4256
  ds_read_b64_tr_b16 v[154:155], v5 offset:4768
  ds_read_b64_tr_b16 v[156:157], v5 offset:4480
  ds_read_b64_tr_b16 v[158:159], v5 offset:4992
  ds_read_b64_tr_b16 v[160:161], v5 offset:4512
  ds_read_b64_tr_b16 v[162:163], v5 offset:5024
  s_waitcnt vmcnt(16)
  s_waitcnt lgkmcnt(14)
  v_mfma_f32_16x16x32_bf16 v[48:51], v[132:135], v[64:67], 0
  ds_read_b64_tr_b16 v[164:165], v5 offset:8448
  ds_read_b64_tr_b16 v[166:167], v5 offset:8960
  s_waitcnt lgkmcnt(14)
  v_mfma_f32_16x16x32_bf16 v[52:55], v[136:139], v[64:67], 0
  ds_read_b64_tr_b16 v[168:169], v5 offset:8480
  ds_read_b64_tr_b16 v[170:171], v5 offset:8992
  s_waitcnt lgkmcnt(14)
  v_mfma_f32_16x16x32_bf16 v[56:59], v[140:143], v[64:67], 0
  ds_read_b64_tr_b16 v[172:173], v5 offset:8704
  ds_read_b64_tr_b16 v[174:175], v5 offset:9216
  s_waitcnt lgkmcnt(14)
  v_mfma_f32_16x16x32_bf16 v[60:63], v[144:147], v[64:67], 0
  ds_read_b64_tr_b16 v[176:177], v5 offset:8736
  ds_read_b64_tr_b16 v[178:179], v5 offset:9248
  s_waitcnt vmcnt(15)
  s_waitcnt lgkmcnt(14)
  v_mfma_f32_16x16x32_bf16 v[48:51], v[148:151], v[68:71], v[48:51]
  ds_read_b64_tr_b16 v[132:133], v5 offset:12672
  ds_read_b64_tr_b16 v[134:135], v5 offset:13184
  s_waitcnt lgkmcnt(14)
  v_mfma_f32_16x16x32_bf16 v[52:55], v[152:155], v[68:71], v[52:55]
  ds_read_b64_tr_b16 v[136:137], v5 offset:12704
  ds_read_b64_tr_b16 v[138:139], v5 offset:13216
  s_waitcnt lgkmcnt(14)
  v_mfma_f32_16x16x32_bf16 v[56:59], v[156:159], v[68:71], v[56:59]
  ds_read_b64_tr_b16 v[140:141], v5 offset:12928
  ds_read_b64_tr_b16 v[142:143], v5 offset:13440
  s_waitcnt lgkmcnt(14)
  v_mfma_f32_16x16x32_bf16 v[60:63], v[160:163], v[68:71], v[60:63]
  ds_read_b64_tr_b16 v[144:145], v5 offset:12960
  ds_read_b64_tr_b16 v[146:147], v5 offset:13472
  s_waitcnt vmcnt(14)
  s_waitcnt lgkmcnt(14)
  v_mfma_f32_16x16x32_bf16 v[196:199], v[164:167], v[72:75], 0
  ds_read_b64_tr_b16 v[148:149], v5 offset:16896
  ds_read_b64_tr_b16 v[150:151], v5 offset:17408
  s_waitcnt lgkmcnt(14)
  v_mfma_f32_16x16x32_bf16 v[200:203], v[168:171], v[72:75], 0
  ds_read_b64_tr_b16 v[152:153], v5 offset:16928
  ds_read_b64_tr_b16 v[154:155], v5 offset:17440
  s_waitcnt lgkmcnt(14)
  v_mfma_f32_16x16x32_bf16 v[204:207], v[172:175], v[72:75], 0
  ds_read_b64_tr_b16 v[156:157], v5 offset:17152
  ds_read_b64_tr_b16 v[158:159], v5 offset:17664
  s_waitcnt lgkmcnt(14)
  v_mfma_f32_16x16x32_bf16 v[208:211], v[176:179], v[72:75], 0
  ds_read_b64_tr_b16 v[160:161], v5 offset:17184
  ds_read_b64_tr_b16 v[162:163], v5 offset:17696
  s_waitcnt vmcnt(13)
  s_waitcnt lgkmcnt(14)
  v_mfma_f32_16x16x32_bf16 v[196:199], v[132:135], v[76:79], v[196:199]
  ds_read_b64_tr_b16 v[164:165], v5 offset:21120
  ds_read_b64_tr_b16 v[166:167], v5 offset:21632
  s_waitcnt lgkmcnt(14)
  v_mfma_f32_16x16x32_bf16 v[200:203], v[136:139], v[76:79], v[200:203]
  ds_read_b64_tr_b16 v[168:169], v5 offset:21152
  ds_read_b64_tr_b16 v[170:171], v5 offset:21664
  s_waitcnt lgkmcnt(14)
  v_mfma_f32_16x16x32_bf16 v[204:207], v[140:143], v[76:79], v[204:207]
  ds_read_b64_tr_b16 v[172:173], v5 offset:21376
  ds_read_b64_tr_b16 v[174:175], v5 offset:21888
  s_waitcnt lgkmcnt(14)
  v_mfma_f32_16x16x32_bf16 v[208:211], v[144:147], v[76:79], v[208:211]
  ds_read_b64_tr_b16 v[176:177], v5 offset:21408
  ds_read_b64_tr_b16 v[178:179], v5 offset:21920
  v_mul_f32 v16, v48, v32
  v_mul_f32 v17, v49, v32
  v_mul_f32 v18, v50, v32
  v_mul_f32 v19, v51, v32
  v_mul_f32 v20, v52, v32
  v_mul_f32 v21, v53, v32
  v_mul_f32 v22, v54, v32
  v_mul_f32 v23, v55, v32
  v_mul_f32 v24, v56, v32
  v_mul_f32 v25, v57, v32
  v_mul_f32 v26, v58, v32
  v_mul_f32 v27, v59, v32
  v_mul_f32 v28, v60, v32
  v_mul_f32 v29, v61, v32
  v_mul_f32 v30, v62, v32
  v_mul_f32 v31, v63, v32
  s_waitcnt vmcnt(12)
  s_waitcnt lgkmcnt(14)
  v_mfma_f32_16x16x32_bf16 v[48:51], v[148:151], v[80:83], 0
  ds_read_b64_tr_b16 v[132:133], v5 offset:25344
  ds_read_b64_tr_b16 v[134:135], v5 offset:25856
  s_waitcnt lgkmcnt(14)
  v_mfma_f32_16x16x32_bf16 v[52:55], v[152:155], v[80:83], 0
  ds_read_b64_tr_b16 v[136:137], v5 offset:25376
  ds_read_b64_tr_b16 v[138:139], v5 offset:25888
  s_waitcnt lgkmcnt(14)
  v_mfma_f32_16x16x32_bf16 v[56:59], v[156:159], v[80:83], 0
  ds_read_b64_tr_b16 v[140:141], v5 offset:25600
  ds_read_b64_tr_b16 v[142:143], v5 offset:26112
  s_waitcnt lgkmcnt(14)
  v_mfma_f32_16x16x32_bf16 v[60:63], v[160:163], v[80:83], 0
  ds_read_b64_tr_b16 v[144:145], v5 offset:25632
  ds_read_b64_tr_b16 v[146:147], v5 offset:26144
  s_waitcnt vmcnt(11)
  s_waitcnt lgkmcnt(14)
  v_mfma_f32_16x16x32_bf16 v[48:51], v[164:167], v[84:87], v[48:51]
  ds_read_b64_tr_b16 v[148:149], v5 offset:29568
  ds_read_b64_tr_b16 v[150:151], v5 offset:30080
  s_waitcnt lgkmcnt(14)
  v_mfma_f32_16x16x32_bf16 v[52:55], v[168:171], v[84:87], v[52:55]
  ds_read_b64_tr_b16 v[152:153], v5 offset:29600
  ds_read_b64_tr_b16 v[154:155], v5 offset:30112
  s_waitcnt lgkmcnt(14)
  v_mfma_f32_16x16x32_bf16 v[56:59], v[172:175], v[84:87], v[56:59]
  ds_read_b64_tr_b16 v[156:157], v5 offset:29824
  ds_read_b64_tr_b16 v[158:159], v5 offset:30336
  s_waitcnt lgkmcnt(14)
  v_mfma_f32_16x16x32_bf16 v[60:63], v[176:179], v[84:87], v[60:63]
  ds_read_b64_tr_b16 v[160:161], v5 offset:29856
  ds_read_b64_tr_b16 v[162:163], v5 offset:30368
  v_fmac_f32 v16, v196, v33
  v_fmac_f32 v17, v197, v33
  v_fmac_f32 v18, v198, v33
  v_fmac_f32 v19, v199, v33
  v_fmac_f32 v20, v200, v33
  v_fmac_f32 v21, v201, v33
  v_fmac_f32 v22, v202, v33
  v_fmac_f32 v23, v203, v33
  v_fmac_f32 v24, v204, v33
  v_fmac_f32 v25, v205, v33
  v_fmac_f32 v26, v206, v33
  v_fmac_f32 v27, v207, v33
  v_fmac_f32 v28, v208, v33
  v_fmac_f32 v29, v209, v33
  v_fmac_f32 v30, v210, v33
  v_fmac_f32 v31, v211, v33
  s_waitcnt vmcnt(10)
  s_waitcnt lgkmcnt(14)
  v_mfma_f32_16x16x32_bf16 v[196:199], v[132:135], v[88:91], 0
  ds_read_b64_tr_b16 v[164:165], v5 offset:33792
  ds_read_b64_tr_b16 v[166:167], v5 offset:34304
  s_waitcnt lgkmcnt(14)
  v_mfma_f32_16x16x32_bf16 v[200:203], v[136:139], v[88:91], 0
  ds_read_b64_tr_b16 v[168:169], v5 offset:33824
  ds_read_b64_tr_b16 v[170:171], v5 offset:34336
  s_waitcnt lgkmcnt(14)
  v_mfma_f32_16x16x32_bf16 v[204:207], v[140:143], v[88:91], 0
  ds_read_b64_tr_b16 v[172:173], v5 offset:34048
  ds_read_b64_tr_b16 v[174:175], v5 offset:34560
  s_waitcnt lgkmcnt(14)
  v_mfma_f32_16x16x32_bf16 v[208:211], v[144:147], v[88:91], 0
  ds_read_b64_tr_b16 v[176:177], v5 offset:34080
  ds_read_b64_tr_b16 v[178:179], v5 offset:34592
  s_waitcnt vmcnt(9)
  s_waitcnt lgkmcnt(14)
  v_mfma_f32_16x16x32_bf16 v[196:199], v[148:151], v[92:95], v[196:199]
  ds_read_b64_tr_b16 v[132:133], v5 offset:38016
  ds_read_b64_tr_b16 v[134:135], v5 offset:38528
  s_waitcnt lgkmcnt(14)
  v_mfma_f32_16x16x32_bf16 v[200:203], v[152:155], v[92:95], v[200:203]
  ds_read_b64_tr_b16 v[136:137], v5 offset:38048
  ds_read_b64_tr_b16 v[138:139], v5 offset:38560
  s_waitcnt lgkmcnt(14)
  v_mfma_f32_16x16x32_bf16 v[204:207], v[156:159], v[92:95], v[204:207]
  ds_read_b64_tr_b16 v[140:141], v5 offset:38272
  ds_read_b64_tr_b16 v[142:143], v5 offset:38784
  s_waitcnt lgkmcnt(14)
  v_mfma_f32_16x16x32_bf16 v[208:211], v[160:163], v[92:95], v[208:211]
  ds_read_b64_tr_b16 v[144:145], v5 offset:38304
  ds_read_b64_tr_b16 v[146:147], v5 offset:38816
  v_fmac_f32 v16, v48, v34
  v_fmac_f32 v17, v49, v34
  v_fmac_f32 v18, v50, v34
  v_fmac_f32 v19, v51, v34
  v_fmac_f32 v20, v52, v34
  v_fmac_f32 v21, v53, v34
  v_fmac_f32 v22, v54, v34
  v_fmac_f32 v23, v55, v34
  v_fmac_f32 v24, v56, v34
  v_fmac_f32 v25, v57, v34
  v_fmac_f32 v26, v58, v34
  v_fmac_f32 v27, v59, v34
  v_fmac_f32 v28, v60, v34
  v_fmac_f32 v29, v61, v34
  v_fmac_f32 v30, v62, v34
  v_fmac_f32 v31, v63, v34
  s_waitcnt vmcnt(8)
  s_waitcnt lgkmcnt(14)
  v_mfma_f32_16x16x32_bf16 v[48:51], v[164:167], v[96:99], 0
  ds_read_b64_tr_b16 v[148:149], v5 offset:42240
  ds_read_b64_tr_b16 v[150:151], v5 offset:42752
  s_waitcnt lgkmcnt(14)
  v_mfma_f32_16x16x32_bf16 v[52:55], v[168:171], v[96:99], 0
  ds_read_b64_tr_b16 v[152:153], v5 offset:42272
  ds_read_b64_tr_b16 v[154:155], v5 offset:42784
  s_waitcnt lgkmcnt(14)
  v_mfma_f32_16x16x32_bf16 v[56:59], v[172:175], v[96:99], 0
  ds_read_b64_tr_b16 v[156:157], v5 offset:42496
  ds_read_b64_tr_b16 v[158:159], v5 offset:43008
  s_waitcnt lgkmcnt(14)
  v_mfma_f32_16x16x32_bf16 v[60:63], v[176:179], v[96:99], 0
  ds_read_b64_tr_b16 v[160:161], v5 offset:42528
  ds_read_b64_tr_b16 v[162:163], v5 offset:43040
  s_waitcnt vmcnt(7)
  s_waitcnt lgkmcnt(14)
  v_mfma_f32_16x16x32_bf16 v[48:51], v[132:135], v[100:103], v[48:51]
  ds_read_b64_tr_b16 v[164:165], v5 offset:46464
  ds_read_b64_tr_b16 v[166:167], v5 offset:46976
  s_waitcnt lgkmcnt(14)
  v_mfma_f32_16x16x32_bf16 v[52:55], v[136:139], v[100:103], v[52:55]
  ds_read_b64_tr_b16 v[168:169], v5 offset:46496
  ds_read_b64_tr_b16 v[170:171], v5 offset:47008
  s_waitcnt lgkmcnt(14)
  v_mfma_f32_16x16x32_bf16 v[56:59], v[140:143], v[100:103], v[56:59]
  ds_read_b64_tr_b16 v[172:173], v5 offset:46720
  ds_read_b64_tr_b16 v[174:175], v5 offset:47232
  s_waitcnt lgkmcnt(14)
  v_mfma_f32_16x16x32_bf16 v[60:63], v[144:147], v[100:103], v[60:63]
  ds_read_b64_tr_b16 v[176:177], v5 offset:46752
  ds_read_b64_tr_b16 v[178:179], v5 offset:47264
  v_fmac_f32 v16, v196, v35
  v_fmac_f32 v17, v197, v35
  v_fmac_f32 v18, v198, v35
  v_fmac_f32 v19, v199, v35
  v_fmac_f32 v20, v200, v35
  v_fmac_f32 v21, v201, v35
  v_fmac_f32 v22, v202, v35
  v_fmac_f32 v23, v203, v35
  v_fmac_f32 v24, v204, v35
  v_fmac_f32 v25, v205, v35
  v_fmac_f32 v26, v206, v35
  v_fmac_f32 v27, v207, v35
  v_fmac_f32 v28, v208, v35
  v_fmac_f32 v29, v209, v35
  v_fmac_f32 v30, v210, v35
  v_fmac_f32 v31, v211, v35
  s_waitcnt vmcnt(6)
  s_waitcnt lgkmcnt(14)
  v_mfma_f32_16x16x32_bf16 v[196:199], v[148:151], v[104:107], 0
  ds_read_b64_tr_b16 v[132:133], v6 offset:0
  ds_read_b64_tr_b16 v[134:135], v6 offset:512
  s_waitcnt lgkmcnt(14)
  v_mfma_f32_16x16x32_bf16 v[200:203], v[152:155], v[104:107], 0
  ds_read_b64_tr_b16 v[136:137], v6 offset:32
  ds_read_b64_tr_b16 v[138:139], v6 offset:544
  s_waitcnt lgkmcnt(14)
  v_mfma_f32_16x16x32_bf16 v[204:207], v[156:159], v[104:107], 0
  ds_read_b64_tr_b16 v[140:141], v6 offset:256
  ds_read_b64_tr_b16 v[142:143], v6 offset:768
  s_waitcnt lgkmcnt(14)
  v_mfma_f32_16x16x32_bf16 v[208:211], v[160:163], v[104:107], 0
  ds_read_b64_tr_b16 v[144:145], v6 offset:288
  ds_read_b64_tr_b16 v[146:147], v6 offset:800
  s_waitcnt vmcnt(5)
  s_waitcnt lgkmcnt(14)
  v_mfma_f32_16x16x32_bf16 v[196:199], v[164:167], v[108:111], v[196:199]
  ds_read_b64_tr_b16 v[148:149], v6 offset:4224
  ds_read_b64_tr_b16 v[150:151], v6 offset:4736
  s_waitcnt lgkmcnt(14)
  v_mfma_f32_16x16x32_bf16 v[200:203], v[168:171], v[108:111], v[200:203]
  ds_read_b64_tr_b16 v[152:153], v6 offset:4256
  ds_read_b64_tr_b16 v[154:155], v6 offset:4768
  s_waitcnt lgkmcnt(14)
  v_mfma_f32_16x16x32_bf16 v[204:207], v[172:175], v[108:111], v[204:207]
  ds_read_b64_tr_b16 v[156:157], v6 offset:4480
  ds_read_b64_tr_b16 v[158:159], v6 offset:4992
  s_waitcnt lgkmcnt(14)
  v_mfma_f32_16x16x32_bf16 v[208:211], v[176:179], v[108:111], v[208:211]
  ds_read_b64_tr_b16 v[160:161], v6 offset:4512
  ds_read_b64_tr_b16 v[162:163], v6 offset:5024
  v_fmac_f32 v16, v48, v36
  v_fmac_f32 v17, v49, v36
  v_fmac_f32 v18, v50, v36
  v_fmac_f32 v19, v51, v36
  v_fmac_f32 v20, v52, v36
  v_fmac_f32 v21, v53, v36
  v_fmac_f32 v22, v54, v36
  v_fmac_f32 v23, v55, v36
  v_fmac_f32 v24, v56, v36
  v_fmac_f32 v25, v57, v36
  v_fmac_f32 v26, v58, v36
  v_fmac_f32 v27, v59, v36
  v_fmac_f32 v28, v60, v36
  v_fmac_f32 v29, v61, v36
  v_fmac_f32 v30, v62, v36
  v_fmac_f32 v31, v63, v36
  s_waitcnt vmcnt(4)
  s_waitcnt lgkmcnt(14)
  v_mfma_f32_16x16x32_bf16 v[48:51], v[132:135], v[112:115], 0
  ds_read_b64_tr_b16 v[164:165], v6 offset:8448
  ds_read_b64_tr_b16 v[166:167], v6 offset:8960
  s_waitcnt lgkmcnt(14)
  v_mfma_f32_16x16x32_bf16 v[52:55], v[136:139], v[112:115], 0
  ds_read_b64_tr_b16 v[168:169], v6 offset:8480
  ds_read_b64_tr_b16 v[170:171], v6 offset:8992
  s_waitcnt lgkmcnt(14)
  v_mfma_f32_16x16x32_bf16 v[56:59], v[140:143], v[112:115], 0
  ds_read_b64_tr_b16 v[172:173], v6 offset:8704
  ds_read_b64_tr_b16 v[174:175], v6 offset:9216
  s_waitcnt lgkmcnt(14)
  v_mfma_f32_16x16x32_bf16 v[60:63], v[144:147], v[112:115], 0
  ds_read_b64_tr_b16 v[176:177], v6 offset:8736
  ds_read_b64_tr_b16 v[178:179], v6 offset:9248
  s_waitcnt vmcnt(3)
  s_waitcnt lgkmcnt(14)
  v_mfma_f32_16x16x32_bf16 v[48:51], v[148:151], v[116:119], v[48:51]
  ds_read_b64_tr_b16 v[132:133], v6 offset:12672
  ds_read_b64_tr_b16 v[134:135], v6 offset:13184
  s_waitcnt lgkmcnt(14)
  v_mfma_f32_16x16x32_bf16 v[52:55], v[152:155], v[116:119], v[52:55]
  ds_read_b64_tr_b16 v[136:137], v6 offset:12704
  ds_read_b64_tr_b16 v[138:139], v6 offset:13216
  s_waitcnt lgkmcnt(14)
  v_mfma_f32_16x16x32_bf16 v[56:59], v[156:159], v[116:119], v[56:59]
  ds_read_b64_tr_b16 v[140:141], v6 offset:12928
  ds_read_b64_tr_b16 v[142:143], v6 offset:13440
  s_waitcnt lgkmcnt(14)
  v_mfma_f32_16x16x32_bf16 v[60:63], v[160:163], v[116:119], v[60:63]
  ds_read_b64_tr_b16 v[144:145], v6 offset:12960
  ds_read_b64_tr_b16 v[146:147], v6 offset:13472
  v_fmac_f32 v16, v196, v37
  v_fmac_f32 v17, v197, v37
  v_fmac_f32 v18, v198, v37
  v_fmac_f32 v19, v199, v37
  v_fmac_f32 v20, v200, v37
  v_fmac_f32 v21, v201, v37
  v_fmac_f32 v22, v202, v37
  v_fmac_f32 v23, v203, v37
  v_fmac_f32 v24, v204, v37
  v_fmac_f32 v25, v205, v37
  v_fmac_f32 v26, v206, v37
  v_fmac_f32 v27, v207, v37
  v_fmac_f32 v28, v208, v37
  v_fmac_f32 v29, v209, v37
  v_fmac_f32 v30, v210, v37
  v_fmac_f32 v31, v211, v37
  s_waitcnt vmcnt(2)
  s_waitcnt lgkmcnt(14)
  v_mfma_f32_16x16x32_bf16 v[196:199], v[164:167], v[120:123], 0
  ds_read_b64_tr_b16 v[148:149], v6 offset:16896
  ds_read_b64_tr_b16 v[150:151], v6 offset:17408
  s_waitcnt lgkmcnt(14)
  v_mfma_f32_16x16x32_bf16 v[200:203], v[168:171], v[120:123], 0
  ds_read_b64_tr_b16 v[152:153], v6 offset:16928
  ds_read_b64_tr_b16 v[154:155], v6 offset:17440
  s_waitcnt lgkmcnt(14)
  v_mfma_f32_16x16x32_bf16 v[204:207], v[172:175], v[120:123], 0
  ds_read_b64_tr_b16 v[156:157], v6 offset:17152
  ds_read_b64_tr_b16 v[158:159], v6 offset:17664
  s_waitcnt lgkmcnt(14)
  v_mfma_f32_16x16x32_bf16 v[208:211], v[176:179], v[120:123], 0
  ds_read_b64_tr_b16 v[160:161], v6 offset:17184
  ds_read_b64_tr_b16 v[162:163], v6 offset:17696
  s_waitcnt vmcnt(1)
  s_waitcnt lgkmcnt(14)
  v_mfma_f32_16x16x32_bf16 v[196:199], v[132:135], v[124:127], v[196:199]
  s_waitcnt lgkmcnt(12)
  v_mfma_f32_16x16x32_bf16 v[200:203], v[136:139], v[124:127], v[200:203]
  s_waitcnt lgkmcnt(10)
  v_mfma_f32_16x16x32_bf16 v[204:207], v[140:143], v[124:127], v[204:207]
  s_waitcnt lgkmcnt(8)
  v_mfma_f32_16x16x32_bf16 v[208:211], v[144:147], v[124:127], v[208:211]
  v_fmac_f32 v16, v48, v38
  v_fmac_f32 v17, v49, v38
  v_fmac_f32 v18, v50, v38
  v_fmac_f32 v19, v51, v38
  v_fmac_f32 v20, v52, v38
  v_fmac_f32 v21, v53, v38
  v_fmac_f32 v22, v54, v38
  v_fmac_f32 v23, v55, v38
  v_fmac_f32 v24, v56, v38
  v_fmac_f32 v25, v57, v38
  v_fmac_f32 v26, v58, v38
  v_fmac_f32 v27, v59, v38
  v_fmac_f32 v28, v60, v38
  v_fmac_f32 v29, v61, v38
  v_fmac_f32 v30, v62, v38
  v_fmac_f32 v31, v63, v38
  s_waitcnt vmcnt(0)
  s_waitcnt lgkmcnt(6)
  v_mfma_f32_16x16x32_bf16 v[48:51], v[148:151], v[128:131], 0
  s_waitcnt lgkmcnt(4)
  v_mfma_f32_16x16x32_bf16 v[52:55], v[152:155], v[128:131], 0
  s_waitcnt lgkmcnt(2)
  v_mfma_f32_16x16x32_bf16 v[56:59], v[156:159], v[128:131], 0
  s_waitcnt lgkmcnt(0)
  v_mfma_f32_16x16x32_bf16 v[60:63], v[160:163], v[128:131], 0
  s_nop 7
  v_fmac_f32 v16, v196, v39
  v_fmac_f32 v17, v197, v39
  v_fmac_f32 v18, v198, v39
  v_fmac_f32 v19, v199, v39
  v_fmac_f32 v20, v200, v39
  v_fmac_f32 v21, v201, v39
  v_fmac_f32 v22, v202, v39
  v_fmac_f32 v23, v203, v39
  v_fmac_f32 v24, v204, v39
  v_fmac_f32 v25, v205, v39
  v_fmac_f32 v26, v206, v39
  v_fmac_f32 v27, v207, v39
  v_fmac_f32 v28, v208, v39
  v_fmac_f32 v29, v209, v39
  v_fmac_f32 v30, v210, v39
  v_fmac_f32 v31, v211, v39
  s_nop 7
  s_setpc_b64 s[86:87]
L_sk_ft:
  v_cvt_pk_bf16_f32 v64, v16, v17
  v_cvt_pk_bf16_f32 v65, v18, v19
  v_cvt_pk_bf16_f32 v66, v20, v21
  v_cvt_pk_bf16_f32 v67, v22, v23
  v_cvt_pk_bf16_f32 v68, v24, v25
  v_cvt_pk_bf16_f32 v69, v26, v27
  v_cvt_pk_bf16_f32 v70, v28, v29
  v_cvt_pk_bf16_f32 v71, v30, v31
  s_nop 1
  v_permlane16_swap_b32 v64, v66
  v_permlane16_swap_b32 v65, v67
  v_permlane16_swap_b32 v68, v70
  v_permlane16_swap_b32 v69, v71
  buffer_store_dwordx4 v[64:67], v247, s[12:15], s70 offen offset:0 sc1
  buffer_store_dwordx4 v[68:71], v247, s[12:15], s70 offen offset:1024 sc1
  s_setpc_b64 s[68:69]
L_sk_row:
  v_cvt_pk_bf16_f32 v72, v16, v17
  v_cvt_pk_bf16_f32 v73, v18, v19
  v_cvt_pk_bf16_f32 v74, v20, v21
  v_cvt_pk_bf16_f32 v75, v22, v23
  v_cvt_pk_bf16_f32 v76, v24, v25
  v_cvt_pk_bf16_f32 v77, v26, v27
  v_cvt_pk_bf16_f32 v78, v28, v29
  v_cvt_pk_bf16_f32 v79, v30, v31
  s_nop 1
  v_bfi_b32 v80, v8, v72, v74
  v_bfi_b32 v81, v8, v73, v75
  v_bfi_b32 v82, v8, v76, v78
  v_bfi_b32 v83, v8, v77, v79
  v_mov_b32_dpp v92, v80 quad_perm:[1,0,3,2] row_mask:0xf bank_mask:0xf
  v_mov_b32_dpp v93, v81 quad_perm:[1,0,3,2] row_mask:0xf bank_mask:0xf
  v_mov_b32_dpp v94, v82 quad_perm:[1,0,3,2] row_mask:0xf bank_mask:0xf
  v_mov_b32_dpp v95, v83 quad_perm:[1,0,3,2] row_mask:0xf bank_mask:0xf
  v_bfi_b32 v72, v8, v92, v72
  v_bfi_b32 v74, v8, v74, v92
  v_bfi_b32 v73, v8, v93, v73
  v_bfi_b32 v75, v8, v75, v93
  v_bfi_b32 v76, v8, v94, v76
  v_bfi_b32 v78, v8, v78, v94
  v_bfi_b32 v77, v8, v95, v77
  v_bfi_b32 v79, v8, v79, v95
  v_bfi_b32 v80, v9, v72, v76
  v_bfi_b32 v81, v9, v73, v77
  v_bfi_b32 v82, v9, v74, v78
  v_bfi_b32 v83, v9, v75, v79
  v_mov_b32_dpp v92, v80 quad_perm:[2,3,0,1] row_mask:0xf bank_mask:0xf
  v_mov_b32_dpp v93, v81 quad_perm:[2,3,0,1] row_mask:0xf bank_mask:0xf
  v_mov_b32_dpp v94, v82 quad_perm:[2,3,0,1] row_mask:0xf bank_mask:0xf
  v_mov_b32_dpp v95, v83 quad_perm:[2,3,0,1] row_mask:0xf bank_mask:0xf
  v_bfi_b32 v72, v9, v92, v72
  v_bfi_b32 v76, v9, v76, v92
  v_bfi_b32 v73, v9, v93, v73
  v_bfi_b32 v77, v9, v77, v93
  v_bfi_b32 v74, v9, v94, v74
  v_bfi_b32 v78, v9, v78, v94
  v_bfi_b32 v75, v9, v95, v75
  v_bfi_b32 v79, v9, v79, v95
  s_nop 1
  v_permlane16_swap_b32 v72, v74
  v_permlane16_swap_b32 v73, v75
  v_permlane16_swap_b32 v76, v78
  v_permlane16_swap_b32 v77, v79
  s_lshr_b32 s92, s3, 1
  s_mul_i32 s92, s92, 2359296
  s_add_u32 s92, s92, s71
  buffer_store_dwordx4 v[72:75], v248, s[12:15], s92 offen sc1
  buffer_store_dwordx4 v[76:79], v249, s[12:15], s92 offen sc1
  s_setpc_b64 s[68:69]
L_loader:
  s_cmp_lt_u32 s2, 112
  s_cbranch_scc1 L_l_nogv
  s_cmp_ge_u32 s10, 132
  s_cbranch_scc1 L_l_noln
  v_subrev_u32 v0, 256, v0
  v_mov_b32 v12, 1
  v_mov_b32 v13, 0
  s_sub_u32 s3, s3, 4
  v_lshrrev_b32 v176, 4, v0
  v_and_b32 v177, 15, v0
  v_mul_u32_u24 v176, 2304, v176
  v_lshl_add_u32 v176, v177, 4, v176
  s_and_b32 s83, s10, 127
  s_mul_i32 s83, s83, 36864
  s_cmp_ge_u32 s10, 128
  s_cselect_b32 s24, s38, s36
  s_cselect_b32 s25, s39, s37
  s_mov_b32 s26, 4718592
  s_cselect_b32 s26, 147456, s26
  s_mov_b32 s27, 0x20000
  buffer_load_dwordx4 v[140:143], v176, s[24:27], s83 offen offset:0 nt
  buffer_load_dwordx4 v[144:147], v176, s[24:27], s83 offen offset:256 nt
  buffer_load_dwordx4 v[148:151], v176, s[24:27], s83 offen offset:512 nt
  buffer_load_dwordx4 v[152:155], v176, s[24:27], s83 offen offset:768 nt
  buffer_load_dwordx4 v[156:159], v176, s[24:27], s83 offen offset:1024 nt
  buffer_load_dwordx4 v[160:163], v176, s[24:27], s83 offen offset:1280 nt
  buffer_load_dwordx4 v[164:167], v176, s[24:27], s83 offen offset:1536 nt
  buffer_load_dwordx4 v[168:171], v176, s[24:27], s83 offen offset:1792 nt
  buffer_load_dwordx4 v[172:175], v176, s[24:27], s83 offen offset:2048 nt
  s_waitcnt vmcnt(0)
  v_lshlrev_b32 v32, 16, v140
  v_and_b32 v33, 0xffff0000, v140
  v_lshlrev_b32 v34, 16, v141
  v_and_b32 v35, 0xffff0000, v141
  v_lshlrev_b32 v36, 16, v142
  v_and_b32 v37, 0xffff0000, v142
  v_lshlrev_b32 v38, 16, v143
  v_and_b32 v39, 0xffff0000, v143
  v_lshlrev_b32 v40, 16, v144
  v_and_b32 v41, 0xffff0000, v144
  v_lshlrev_b32 v42, 16, v145
  v_and_b32 v43, 0xffff0000, v145
  v_lshlrev_b32 v44, 16, v146
  v_and_b32 v45, 0xffff0000, v146
  v_lshlrev_b32 v46, 16, v147
  v_and_b32 v47, 0xffff0000, v147
  v_lshlrev_b32 v48, 16, v148
  v_and_b32 v49, 0xffff0000, v148
  v_lshlrev_b32 v50, 16, v149
  v_and_b32 v51, 0xffff0000, v149
  v_lshlrev_b32 v52, 16, v150
  v_and_b32 v53, 0xffff0000, v150
  v_lshlrev_b32 v54, 16, v151
  v_and_b32 v55, 0xffff0000, v151
  v_lshlrev_b32 v56, 16, v152
  v_and_b32 v57, 0xffff0000, v152
  v_lshlrev_b32 v58, 16, v153
  v_and_b32 v59, 0xffff0000, v153
  v_lshlrev_b32 v60, 16, v154
  v_and_b32 v61, 0xffff0000, v154
  v_lshlrev_b32 v62, 16, v155
  v_and_b32 v63, 0xffff0000, v155
  v_lshlrev_b32 v64, 16, v156
  v_and_b32 v65, 0xffff0000, v156
  v_lshlrev_b32 v66, 16, v157
  v_and_b32 v67, 0xffff0000, v157
  v_lshlrev_b32 v68, 16, v158
  v_and_b32 v69, 0xffff0000, v158
  v_lshlrev_b32 v70, 16, v159
  v_and_b32 v71, 0xffff0000, v159
  v_lshlrev_b32 v72, 16, v160
  v_and_b32 v73, 0xffff0000, v160
  v_lshlrev_b32 v74, 16, v161
  v_and_b32 v75, 0xffff0000, v161
  v_lshlrev_b32 v76, 16, v162
  v_and_b32 v77, 0xffff0000, v162
  v_lshlrev_b32 v78, 16, v163
  v_and_b32 v79, 0xffff0000, v163
  v_lshlrev_b32 v80, 16, v164
  v_and_b32 v81, 0xffff0000, v164
  v_lshlrev_b32 v82, 16, v165
  v_and_b32 v83, 0xffff0000, v165
  v_lshlrev_b32 v84, 16, v166
  v_and_b32 v85, 0xffff0000, v166
  v_lshlrev_b32 v86, 16, v167
  v_and_b32 v87, 0xffff0000, v167
  v_lshlrev_b32 v88, 16, v168
  v_and_b32 v89, 0xffff0000, v168
  v_lshlrev_b32 v90, 16, v169
  v_and_b32 v91, 0xffff0000, v169
  v_lshlrev_b32 v92, 16, v170
  v_and_b32 v93, 0xffff0000, v170
  v_lshlrev_b32 v94, 16, v171
  v_and_b32 v95, 0xffff0000, v171
  v_lshlrev_b32 v96, 16, v172
  v_and_b32 v97, 0xffff0000, v172
  v_lshlrev_b32 v98, 16, v173
  v_and_b32 v99, 0xffff0000, v173
  v_lshlrev_b32 v100, 16, v174
  v_and_b32 v101, 0xffff0000, v174
  v_lshlrev_b32 v102, 16, v175
  v_and_b32 v103, 0xffff0000, v175
  v_pk_add_f32 v[180:181], v[32:33], v[34:35]
  v_pk_add_f32 v[180:181], v[180:181], v[36:37]
  v_pk_add_f32 v[180:181], v[180:181], v[38:39]
  v_pk_add_f32 v[180:181], v[180:181], v[40:41]
  v_pk_add_f32 v[180:181], v[180:181], v[42:43]
  v_pk_add_f32 v[180:181], v[180:181], v[44:45]
  v_pk_add_f32 v[180:181], v[180:181], v[46:47]
  v_pk_add_f32 v[180:181], v[180:181], v[48:49]
  v_pk_add_f32 v[180:181], v[180:181], v[50:51]
  v_pk_add_f32 v[180:181], v[180:181], v[52:53]
  v_pk_add_f32 v[180:181], v[180:181], v[54:55]
  v_pk_add_f32 v[180:181], v[180:181], v[56:57]
  v_pk_add_f32 v[180:181], v[180:181], v[58:59]
  v_pk_add_f32 v[180:181], v[180:181], v[60:61]
  v_pk_add_f32 v[180:181], v[180:181], v[62:63]
  v_pk_add_f32 v[180:181], v[180:181], v[64:65]
  v_pk_add_f32 v[180:181], v[180:181], v[66:67]
  v_pk_add_f32 v[180:181], v[180:181], v[68:69]
  v_pk_add_f32 v[180:181], v[180:181], v[70:71]
  v_pk_add_f32 v[180:181], v[180:181], v[72:73]
  v_pk_add_f32 v[180:181], v[180:181], v[74:75]
  v_pk_add_f32 v[180:181], v[180:181], v[76:77]
  v_pk_add_f32 v[180:181], v[180:181], v[78:79]
  v_pk_add_f32 v[180:181], v[180:181], v[80:81]
  v_pk_add_f32 v[180:181], v[180:181], v[82:83]
  v_pk_add_f32 v[180:181], v[180:181], v[84:85]
  v_pk_add_f32 v[180:181], v[180:181], v[86:87]
  v_pk_add_f32 v[180:181], v[180:181], v[88:89]
  v_pk_add_f32 v[180:181], v[180:181], v[90:91]
  v_pk_add_f32 v[180:181], v[180:181], v[92:93]
  v_pk_add_f32 v[180:181], v[180:181], v[94:95]
  v_pk_add_f32 v[180:181], v[180:181], v[96:97]
  v_pk_add_f32 v[180:181], v[180:181], v[98:99]
  v_pk_add_f32 v[180:181], v[180:181], v[100:101]
  v_pk_add_f32 v[180:181], v[180:181], v[102:103]
  v_add_f32 v180, v180, v181
  s_nop 1
  v_add_f32_dpp v181, v180, v180 row_ror:8 row_mask:0xf bank_mask:0xf
  s_nop 1
  v_add_f32_dpp v180, v181, v181 row_ror:4 row_mask:0xf bank_mask:0xf
  s_nop 1
  v_add_f32_dpp v181, v180, v180 row_ror:2 row_mask:0xf bank_mask:0xf
  s_nop 1
  v_add_f32_dpp v180, v181, v181 row_ror:1 row_mask:0xf bank_mask:0xf
  v_mul_f32 v180, 0xba638e39, v180
  v_pk_add_f32 v[32:33], v[32:33], v[180:181] op_sel_hi:[1,0]
  v_pk_add_f32 v[34:35], v[34:35], v[180:181] op_sel_hi:[1,0]
  v_pk_add_f32 v[36:37], v[36:37], v[180:181] op_sel_hi:[1,0]
  v_pk_add_f32 v[38:39], v[38:39], v[180:181] op_sel_hi:[1,0]
  v_pk_add_f32 v[40:41], v[40:41], v[180:181] op_sel_hi:[1,0]
  v_pk_add_f32 v[42:43], v[42:43], v[180:181] op_sel_hi:[1,0]
  v_pk_add_f32 v[44:45], v[44:45], v[180:181] op_sel_hi:[1,0]
  v_pk_add_f32 v[46:47], v[46:47], v[180:181] op_sel_hi:[1,0]
  v_pk_add_f32 v[48:49], v[48:49], v[180:181] op_sel_hi:[1,0]
  v_pk_add_f32 v[50:51], v[50:51], v[180:181] op_sel_hi:[1,0]
  v_pk_add_f32 v[52:53], v[52:53], v[180:181] op_sel_hi:[1,0]
  v_pk_add_f32 v[54:55], v[54:55], v[180:181] op_sel_hi:[1,0]
  v_pk_add_f32 v[56:57], v[56:57], v[180:181] op_sel_hi:[1,0]
  v_pk_add_f32 v[58:59], v[58:59], v[180:181] op_sel_hi:[1,0]
  v_pk_add_f32 v[60:61], v[60:61], v[180:181] op_sel_hi:[1,0]
  v_pk_add_f32 v[62:63], v[62:63], v[180:181] op_sel_hi:[1,0]
  v_pk_add_f32 v[64:65], v[64:65], v[180:181] op_sel_hi:[1,0]
  v_pk_add_f32 v[66:67], v[66:67], v[180:181] op_sel_hi:[1,0]
  v_pk_add_f32 v[68:69], v[68:69], v[180:181] op_sel_hi:[1,0]
  v_pk_add_f32 v[70:71], v[70:71], v[180:181] op_sel_hi:[1,0]
  v_pk_add_f32 v[72:73], v[72:73], v[180:181] op_sel_hi:[1,0]
  v_pk_add_f32 v[74:75], v[74:75], v[180:181] op_sel_hi:[1,0]
  v_pk_add_f32 v[76:77], v[76:77], v[180:181] op_sel_hi:[1,0]
  v_pk_add_f32 v[78:79], v[78:79], v[180:181] op_sel_hi:[1,0]
  v_pk_add_f32 v[80:81], v[80:81], v[180:181] op_sel_hi:[1,0]
  v_pk_add_f32 v[82:83], v[82:83], v[180:181] op_sel_hi:[1,0]
  v_pk_add_f32 v[84:85], v[84:85], v[180:181] op_sel_hi:[1,0]
  v_pk_add_f32 v[86:87], v[86:87], v[180:181] op_sel_hi:[1,0]
  v_pk_add_f32 v[88:89], v[88:89], v[180:181] op_sel_hi:[1,0]
  v_pk_add_f32 v[90:91], v[90:91], v[180:181] op_sel_hi:[1,0]
  v_pk_add_f32 v[92:93], v[92:93], v[180:181] op_sel_hi:[1,0]
  v_pk_add_f32 v[94:95], v[94:95], v[180:181] op_sel_hi:[1,0]
  v_pk_add_f32 v[96:97], v[96:97], v[180:181] op_sel_hi:[1,0]
  v_pk_add_f32 v[98:99], v[98:99], v[180:181] op_sel_hi:[1,0]
  v_pk_add_f32 v[100:101], v[100:101], v[180:181] op_sel_hi:[1,0]
  v_pk_add_f32 v[102:103], v[102:103], v[180:181] op_sel_hi:[1,0]
  v_mov_b32 v14, 163540
  s_mov_b64 exec, 1
  ds_add_u32 v14, v12
  s_mov_b64 exec, -1
  v_pk_mul_f32 v[182:183], v[32:33], v[32:33]
  v_pk_fma_f32 v[182:183], v[34:35], v[34:35], v[182:183]
  v_pk_fma_f32 v[182:183], v[36:37], v[36:37], v[182:183]
  v_pk_fma_f32 v[182:183], v[38:39], v[38:39], v[182:183]
  v_pk_fma_f32 v[182:183], v[40:41], v[40:41], v[182:183]
  v_pk_fma_f32 v[182:183], v[42:43], v[42:43], v[182:183]
  v_pk_fma_f32 v[182:183], v[44:45], v[44:45], v[182:183]
  v_pk_fma_f32 v[182:183], v[46:47], v[46:47], v[182:183]
  v_pk_fma_f32 v[182:183], v[48:49], v[48:49], v[182:183]
  v_pk_fma_f32 v[182:183], v[50:51], v[50:51], v[182:183]
  v_pk_fma_f32 v[182:183], v[52:53], v[52:53], v[182:183]
  v_pk_fma_f32 v[182:183], v[54:55], v[54:55], v[182:183]
  v_pk_fma_f32 v[182:183], v[56:57], v[56:57], v[182:183]
  v_pk_fma_f32 v[182:183], v[58:59], v[58:59], v[182:183]
  v_pk_fma_f32 v[182:183], v[60:61], v[60:61], v[182:183]
  v_pk_fma_f32 v[182:183], v[62:63], v[62:63], v[182:183]
  v_pk_fma_f32 v[182:183], v[64:65], v[64:65], v[182:183]
  v_pk_fma_f32 v[182:183], v[66:67], v[66:67], v[182:183]
  v_pk_fma_f32 v[182:183], v[68:69], v[68:69], v[182:183]
  v_pk_fma_f32 v[182:183], v[70:71], v[70:71], v[182:183]
  v_pk_fma_f32 v[182:183], v[72:73], v[72:73], v[182:183]
  v_pk_fma_f32 v[182:183], v[74:75], v[74:75], v[182:183]
  v_pk_fma_f32 v[182:183], v[76:77], v[76:77], v[182:183]
  v_pk_fma_f32 v[182:183], v[78:79], v[78:79], v[182:183]
  v_pk_fma_f32 v[182:183], v[80:81], v[80:81], v[182:183]
  v_pk_fma_f32 v[182:183], v[82:83], v[82:83], v[182:183]
  v_pk_fma_f32 v[182:183], v[84:85], v[84:85], v[182:183]
  v_pk_fma_f32 v[182:183], v[86:87], v[86:87], v[182:183]
  v_pk_fma_f32 v[182:183], v[88:89], v[88:89], v[182:183]
  v_pk_fma_f32 v[182:183], v[90:91], v[90:91], v[182:183]
  v_pk_fma_f32 v[182:183], v[92:93], v[92:93], v[182:183]
  v_pk_fma_f32 v[182:183], v[94:95], v[94:95], v[182:183]
  v_pk_fma_f32 v[182:183], v[96:97], v[96:97], v[182:183]
  v_pk_fma_f32 v[182:183], v[98:99], v[98:99], v[182:183]
  v_pk_fma_f32 v[182:183], v[100:101], v[100:101], v[182:183]
  v_pk_fma_f32 v[182:183], v[102:103], v[102:103], v[182:183]
  v_add_f32 v181, v182, v183
  s_nop 1
  v_add_f32_dpp v182, v181, v181 row_ror:8 row_mask:0xf bank_mask:0xf
  s_nop 1
  v_add_f32_dpp v181, v182, v182 row_ror:4 row_mask:0xf bank_mask:0xf
  s_nop 1
  v_add_f32_dpp v182, v181, v181 row_ror:2 row_mask:0xf bank_mask:0xf
  s_nop 1
  v_add_f32_dpp v181, v182, v182 row_ror:1 row_mask:0xf bank_mask:0xf
  v_mov_b32 v180, 0x3727c5ac
  v_fmac_f32 v180, 0x3a638e39, v181
  v_rsq_f32 v180, v180
  s_nop 0
  v_pk_mul_f32 v[32:33], v[32:33], v[180:181] op_sel_hi:[1,0]
  v_pk_mul_f32 v[34:35], v[34:35], v[180:181] op_sel_hi:[1,0]
  v_pk_mul_f32 v[36:37], v[36:37], v[180:181] op_sel_hi:[1,0]
  v_pk_mul_f32 v[38:39], v[38:39], v[180:181] op_sel_hi:[1,0]
  v_pk_mul_f32 v[40:41], v[40:41], v[180:181] op_sel_hi:[1,0]
  v_pk_mul_f32 v[42:43], v[42:43], v[180:181] op_sel_hi:[1,0]
  v_pk_mul_f32 v[44:45], v[44:45], v[180:181] op_sel_hi:[1,0]
  v_pk_mul_f32 v[46:47], v[46:47], v[180:181] op_sel_hi:[1,0]
  v_pk_mul_f32 v[48:49], v[48:49], v[180:181] op_sel_hi:[1,0]
  v_pk_mul_f32 v[50:51], v[50:51], v[180:181] op_sel_hi:[1,0]
  v_pk_mul_f32 v[52:53], v[52:53], v[180:181] op_sel_hi:[1,0]
  v_pk_mul_f32 v[54:55], v[54:55], v[180:181] op_sel_hi:[1,0]
  v_pk_mul_f32 v[56:57], v[56:57], v[180:181] op_sel_hi:[1,0]
  v_pk_mul_f32 v[58:59], v[58:59], v[180:181] op_sel_hi:[1,0]
  v_pk_mul_f32 v[60:61], v[60:61], v[180:181] op_sel_hi:[1,0]
  v_pk_mul_f32 v[62:63], v[62:63], v[180:181] op_sel_hi:[1,0]
  v_pk_mul_f32 v[64:65], v[64:65], v[180:181] op_sel_hi:[1,0]
  v_pk_mul_f32 v[66:67], v[66:67], v[180:181] op_sel_hi:[1,0]
  v_pk_mul_f32 v[68:69], v[68:69], v[180:181] op_sel_hi:[1,0]
  v_pk_mul_f32 v[70:71], v[70:71], v[180:181] op_sel_hi:[1,0]
  v_pk_mul_f32 v[72:73], v[72:73], v[180:181] op_sel_hi:[1,0]
  v_pk_mul_f32 v[74:75], v[74:75], v[180:181] op_sel_hi:[1,0]
  v_pk_mul_f32 v[76:77], v[76:77], v[180:181] op_sel_hi:[1,0]
  v_pk_mul_f32 v[78:79], v[78:79], v[180:181] op_sel_hi:[1,0]
  v_pk_mul_f32 v[80:81], v[80:81], v[180:181] op_sel_hi:[1,0]
  v_pk_mul_f32 v[82:83], v[82:83], v[180:181] op_sel_hi:[1,0]
  v_pk_mul_f32 v[84:85], v[84:85], v[180:181] op_sel_hi:[1,0]
  v_pk_mul_f32 v[86:87], v[86:87], v[180:181] op_sel_hi:[1,0]
  v_pk_mul_f32 v[88:89], v[88:89], v[180:181] op_sel_hi:[1,0]
  v_pk_mul_f32 v[90:91], v[90:91], v[180:181] op_sel_hi:[1,0]
  v_pk_mul_f32 v[92:93], v[92:93], v[180:181] op_sel_hi:[1,0]
  v_pk_mul_f32 v[94:95], v[94:95], v[180:181] op_sel_hi:[1,0]
  v_pk_mul_f32 v[96:97], v[96:97], v[180:181] op_sel_hi:[1,0]
  v_pk_mul_f32 v[98:99], v[98:99], v[180:181] op_sel_hi:[1,0]
  v_pk_mul_f32 v[100:101], v[100:101], v[180:181] op_sel_hi:[1,0]
  v_pk_mul_f32 v[102:103], v[102:103], v[180:181] op_sel_hi:[1,0]
  s_lshr_b32 s80, s10, 7
  s_lshr_b32 s81, s10, 6
  s_bfe_u32 s75, s10, 0x10001
  s_cmp_eq_u32 s80, 1
  s_cselect_b32 s81, s75, s81
  v_lshlrev_b32 v180, 4, v0
  v_mov_b32 v14, 163536
  s_and_b32 s75, s10, 63
  s_mul_i32 s76, s75, 36864
  s_mul_i32 s75, s81, 2433024
  s_add_u32 s75, s75, 2097152
  s_cmp_eq_u32 s80, 1
  s_cselect_b32 s75, 655360, s75
  s_add_u32 s76, s76, s75
  s_lshl_b32 s75, s80, 30
  v_or_b32 v176, s75, v176
  s_mov_b32 s88, 13824
  s_mul_i32 s75, s10, 128
  s_add_u32 s88, s88, s75
  s_mul_i32 s75, s3, 4
  s_add_u32 s88, s88, s75
  v_lshlrev_b32 v182, 5, v177
  v_add_u32 v182, 153792, v182
  s_mov_b32 s74, 16777216
L_lw_15:
  ds_read_b32 v183, v14
  s_waitcnt lgkmcnt(0)
  v_cmp_le_u32 vcc, 4, v183
  s_cbranch_vccnz L_lw_15_d
  s_sleep 1
  s_sub_u32 s74, s74, 1
  s_cmp_lg_u32 s74, 0
  s_cbranch_scc1 L_lw_15
L_lw_15_d:
  ds_read_b128 v[104:107], v182 offset:0
  ds_read_b128 v[112:115], v182 offset:4608
  ds_read_b128 v[108:111], v182 offset:16
  ds_read_b128 v[116:119], v182 offset:4624
  ds_read_b128 v[120:123], v182 offset:512
  ds_read_b128 v[128:131], v182 offset:5120
  ds_read_b128 v[124:127], v182 offset:528
  ds_read_b128 v[132:135], v182 offset:5136
  ds_read_b128 v[184:187], v182 offset:1024
  ds_read_b128 v[192:195], v182 offset:5632
  ds_read_b128 v[188:191], v182 offset:1040
  ds_read_b128 v[196:199], v182 offset:5648
  ds_read_b128 v[200:203], v182 offset:1536
  ds_read_b128 v[208:211], v182 offset:6144
  ds_read_b128 v[204:207], v182 offset:1552
  ds_read_b128 v[212:215], v182 offset:6160
  s_waitcnt lgkmcnt(8)
  v_pk_fma_f32 v[104:105], v[32:33], v[112:113], v[104:105]
  v_pk_fma_f32 v[106:107], v[34:35], v[114:115], v[106:107]
  v_pk_fma_f32 v[108:109], v[36:37], v[116:117], v[108:109]
  v_pk_fma_f32 v[110:111], v[38:39], v[118:119], v[110:111]
  v_cvt_pk_bf16_f32 v140, v104, v105
  v_cvt_pk_bf16_f32 v141, v106, v107
  v_cvt_pk_bf16_f32 v142, v108, v109
  v_cvt_pk_bf16_f32 v143, v110, v111
  buffer_store_dwordx4 v[140:143], v176, s[12:15], s76 offen offset:0 sc1
  v_pk_fma_f32 v[120:121], v[40:41], v[128:129], v[120:121]
  v_pk_fma_f32 v[122:123], v[42:43], v[130:131], v[122:123]
  v_pk_fma_f32 v[124:125], v[44:45], v[132:133], v[124:125]
  v_pk_fma_f32 v[126:127], v[46:47], v[134:135], v[126:127]
  v_cvt_pk_bf16_f32 v144, v120, v121
  v_cvt_pk_bf16_f32 v145, v122, v123
  v_cvt_pk_bf16_f32 v146, v124, v125
  v_cvt_pk_bf16_f32 v147, v126, v127
  buffer_store_dwordx4 v[144:147], v176, s[12:15], s76 offen offset:256 sc1
  ds_read_b128 v[104:107], v182 offset:2048
  ds_read_b128 v[112:115], v182 offset:6656
  ds_read_b128 v[108:111], v182 offset:2064
  ds_read_b128 v[116:119], v182 offset:6672
  ds_read_b128 v[120:123], v182 offset:2560
  ds_read_b128 v[128:131], v182 offset:7168
  ds_read_b128 v[124:127], v182 offset:2576
  ds_read_b128 v[132:135], v182 offset:7184
  s_waitcnt lgkmcnt(8)
  v_pk_fma_f32 v[184:185], v[48:49], v[192:193], v[184:185]
  v_pk_fma_f32 v[186:187], v[50:51], v[194:195], v[186:187]
  v_pk_fma_f32 v[188:189], v[52:53], v[196:197], v[188:189]
  v_pk_fma_f32 v[190:191], v[54:55], v[198:199], v[190:191]
  v_cvt_pk_bf16_f32 v148, v184, v185
  v_cvt_pk_bf16_f32 v149, v186, v187
  v_cvt_pk_bf16_f32 v150, v188, v189
  v_cvt_pk_bf16_f32 v151, v190, v191
  buffer_store_dwordx4 v[148:151], v176, s[12:15], s76 offen offset:512 sc1
  v_pk_fma_f32 v[200:201], v[56:57], v[208:209], v[200:201]
  v_pk_fma_f32 v[202:203], v[58:59], v[210:211], v[202:203]
  v_pk_fma_f32 v[204:205], v[60:61], v[212:213], v[204:205]
  v_pk_fma_f32 v[206:207], v[62:63], v[214:215], v[206:207]
  v_cvt_pk_bf16_f32 v152, v200, v201
  v_cvt_pk_bf16_f32 v153, v202, v203
  v_cvt_pk_bf16_f32 v154, v204, v205
  v_cvt_pk_bf16_f32 v155, v206, v207
  buffer_store_dwordx4 v[152:155], v176, s[12:15], s76 offen offset:768 sc1
  ds_read_b128 v[184:187], v182 offset:3072
  ds_read_b128 v[192:195], v182 offset:7680
  ds_read_b128 v[188:191], v182 offset:3088
  ds_read_b128 v[196:199], v182 offset:7696
  ds_read_b128 v[200:203], v182 offset:3584
  ds_read_b128 v[208:211], v182 offset:8192
  ds_read_b128 v[204:207], v182 offset:3600
  ds_read_b128 v[212:215], v182 offset:8208
  s_waitcnt lgkmcnt(8)
  v_pk_fma_f32 v[104:105], v[64:65], v[112:113], v[104:105]
  v_pk_fma_f32 v[106:107], v[66:67], v[114:115], v[106:107]
  v_pk_fma_f32 v[108:109], v[68:69], v[116:117], v[108:109]
  v_pk_fma_f32 v[110:111], v[70:71], v[118:119], v[110:111]
  v_cvt_pk_bf16_f32 v156, v104, v105
  v_cvt_pk_bf16_f32 v157, v106, v107
  v_cvt_pk_bf16_f32 v158, v108, v109
  v_cvt_pk_bf16_f32 v159, v110, v111
  buffer_store_dwordx4 v[156:159], v176, s[12:15], s76 offen offset:1024 sc1
  v_pk_fma_f32 v[120:121], v[72:73], v[128:129], v[120:121]
  v_pk_fma_f32 v[122:123], v[74:75], v[130:131], v[122:123]
  v_pk_fma_f32 v[124:125], v[76:77], v[132:133], v[124:125]
  v_pk_fma_f32 v[126:127], v[78:79], v[134:135], v[126:127]
  v_cvt_pk_bf16_f32 v160, v120, v121
  v_cvt_pk_bf16_f32 v161, v122, v123
  v_cvt_pk_bf16_f32 v162, v124, v125
  v_cvt_pk_bf16_f32 v163, v126, v127
  buffer_store_dwordx4 v[160:163], v176, s[12:15], s76 offen offset:1280 sc1
  ds_read_b128 v[104:107], v182 offset:4096
  ds_read_b128 v[112:115], v182 offset:8704
  ds_read_b128 v[108:111], v182 offset:4112
  ds_read_b128 v[116:119], v182 offset:8720
  s_waitcnt lgkmcnt(4)
  v_pk_fma_f32 v[184:185], v[80:81], v[192:193], v[184:185]
  v_pk_fma_f32 v[186:187], v[82:83], v[194:195], v[186:187]
  v_pk_fma_f32 v[188:189], v[84:85], v[196:197], v[188:189]
  v_pk_fma_f32 v[190:191], v[86:87], v[198:199], v[190:191]
  v_cvt_pk_bf16_f32 v164, v184, v185
  v_cvt_pk_bf16_f32 v165, v186, v187
  v_cvt_pk_bf16_f32 v166, v188, v189
  v_cvt_pk_bf16_f32 v167, v190, v191
  buffer_store_dwordx4 v[164:167], v176, s[12:15], s76 offen offset:1536 sc1
  v_pk_fma_f32 v[200:201], v[88:89], v[208:209], v[200:201]
  v_pk_fma_f32 v[202:203], v[90:91], v[210:211], v[202:203]
  v_pk_fma_f32 v[204:205], v[92:93], v[212:213], v[204:205]
  v_pk_fma_f32 v[206:207], v[94:95], v[214:215], v[206:207]
  v_cvt_pk_bf16_f32 v168, v200, v201
  v_cvt_pk_bf16_f32 v169, v202, v203
  v_cvt_pk_bf16_f32 v170, v204, v205
  v_cvt_pk_bf16_f32 v171, v206, v207
  buffer_store_dwordx4 v[168:171], v176, s[12:15], s76 offen offset:1792 sc1
  s_waitcnt lgkmcnt(0)
  v_pk_fma_f32 v[104:105], v[96:97], v[112:113], v[104:105]
  v_pk_fma_f32 v[106:107], v[98:99], v[114:115], v[106:107]
  v_pk_fma_f32 v[108:109], v[100:101], v[116:117], v[108:109]
  v_pk_fma_f32 v[110:111], v[102:103], v[118:119], v[110:111]
  v_cvt_pk_bf16_f32 v172, v104, v105
  v_cvt_pk_bf16_f32 v173, v106, v107
  v_cvt_pk_bf16_f32 v174, v108, v109
  v_cvt_pk_bf16_f32 v175, v110, v111
  buffer_store_dwordx4 v[172:175], v176, s[12:15], s76 offen offset:2048 sc1
  s_cmp_eq_u32 s80, 0
  s_cbranch_scc1 L_ln_rm
  v_and_b32 v176, 0xf0, v0
  v_add_u32 v181, v180, v176
  v_mul_u32_u24 v177, 272, v177
  v_add_u32 v176, v177, v176
  v_mov_b32 v14, 163544
  ds_write_b128 v176, v[140:143] offset:0
  ds_write_b128 v176, v[144:147] offset:4352
  ds_write_b128 v176, v[148:151] offset:8704
  ds_write_b128 v176, v[152:155] offset:13056
  ds_write_b128 v176, v[156:159] offset:17408
  ds_write_b128 v176, v[160:163] offset:21760
  ds_write_b128 v176, v[164:167] offset:26112
  ds_write_b128 v176, v[168:171] offset:30464
  ds_write_b128 v176, v[172:175] offset:34816
  s_mov_b64 exec, 1
  ds_add_u32 v14, v12
  s_mov_b64 exec, -1
  s_mov_b32 s74, 16777216
L_lw_16:
  ds_read_b32 v183, v14
  s_waitcnt lgkmcnt(0)
  v_cmp_le_u32 vcc, 4, v183
  s_cbranch_vccnz L_lw_16_d
  s_sleep 1
  s_sub_u32 s74, s74, 1
  s_cmp_lg_u32 s74, 0
  s_cbranch_scc1 L_lw_16
L_lw_16_d:
  ds_read_b128 v[140:143], v181 offset:0
  ds_read_b128 v[144:147], v181 offset:4352
  ds_read_b128 v[148:151], v181 offset:8704
  ds_read_b128 v[152:155], v181 offset:13056
  ds_read_b128 v[156:159], v181 offset:17408
  ds_read_b128 v[160:163], v181 offset:21760
  ds_read_b128 v[164:167], v181 offset:26112
  ds_read_b128 v[168:171], v181 offset:30464
  ds_read_b128 v[172:175], v181 offset:34816
  s_waitcnt lgkmcnt(8)
  buffer_store_dwordx4 v[140:143], v180, s[12:15], s76 offen sc1
  s_add_u32 s76, s76, 4096
  s_waitcnt lgkmcnt(7)
  buffer_store_dwordx4 v[144:147], v180, s[12:15], s76 offen sc1
  s_add_u32 s76, s76, 4096
  s_waitcnt lgkmcnt(6)
  buffer_store_dwordx4 v[148:151], v180, s[12:15], s76 offen sc1
  s_add_u32 s76, s76, 4096
  s_waitcnt lgkmcnt(5)
  buffer_store_dwordx4 v[152:155], v180, s[12:15], s76 offen sc1
  s_add_u32 s76, s76, 4096
  s_waitcnt lgkmcnt(4)
  buffer_store_dwordx4 v[156:159], v180, s[12:15], s76 offen sc1
  s_add_u32 s76, s76, 4096
  s_waitcnt lgkmcnt(3)
  buffer_store_dwordx4 v[160:163], v180, s[12:15], s76 offen sc1
  s_add_u32 s76, s76, 4096
  s_waitcnt lgkmcnt(2)
  buffer_store_dwordx4 v[164:167], v180, s[12:15], s76 offen sc1
  s_add_u32 s76, s76, 4096
  s_waitcnt lgkmcnt(1)
  buffer_store_dwordx4 v[168:171], v180, s[12:15], s76 offen sc1
  s_add_u32 s76, s76, 4096
  s_waitcnt lgkmcnt(0)
  buffer_store_dwordx4 v[172:175], v180, s[12:15], s76 offen sc1
  s_add_u32 s76, s76, 4096
L_ln_rm:
  s_waitcnt vmcnt(0)
  v_mov_b32 v254, 163548
  s_mov_b64 exec, 1
  ds_add_rtn_u32 v255, v254, v12
  s_andn2_b32 s88, s88, 15
  s_waitcnt lgkmcnt(0)
  v_and_b32 v255, 3, v255
  v_cmp_eq_u32 vcc, 3, v255
  s_mov_b64 exec, 15
  s_cbranch_vccz L_s1_17
  v_mov_b32 v255, s11
  v_lshlrev_b32 v254, 2, v1
  buffer_store_dword v255, v254, s[12:15], s88 offen sc1
L_s1_17:
  s_mov_b64 exec, -1
  s_add_u32 s3, s3, 4
  s_branch L_l_nogv
L_l_noln:
  s_call_b64 s[86:87], L_gemv1
L_l_nogv:
  s_sub_u32 s84, s3, 4
  s_mul_i32 s85, s84, 4160
  s_mov_b32 s82, s85
  s_mul_i32 s5, s84, 1040
  s_sub_u32 s5, 16640, s5
  s_mov_b32 m0, s82
  v_bfe_u32 v2, v1, 2, 2
  v_lshl_add_u32 v2, s84, 4, v2
  v_lshrrev_b32 v20, 4, v1
  v_and_b32 v21, 3, v1
  v_lshlrev_b32 v21, 4, v21
  v_lshl_add_u32 v3, v20, 6, v21
  v_bfe_u32 v20, v1, 2, 3
  v_lshl_add_u32 v4, s84, 5, v20
  s_mul_i32 s75, s84, 24
  v_add_u32 v5, s75, v20
  v_bfe_u32 v20, v1, 4, 1
  v_mul_u32_u24 v20, 48, v20
  v_xor_b32 v21, v21, v20
  v_lshrrev_b32 v20, 5, v1
  v_lshl_add_u32 v6, v20, 6, v21
  s_and_b32 s75, s84, 1
  s_mul_i32 s75, s75, 48
  v_xor_b32 v7, s75, v6
  v_mov_b32 v8, 0
  s_cmp_ge_u32 s2, 200
  s_cbranch_scc1 L_laux
  s_branch L_l_nou
L_l_u:
  s_barrier
  s_mov_b32 s83, 1
  s_call_b64 s[86:87], L_issue
  s_waitcnt vmcnt(7)
  s_barrier
  s_mov_b32 s83, 2
  s_call_b64 s[86:87], L_issue
  s_waitcnt lgkmcnt(0)
  s_mul_i32 s11, s8, 1664525
  s_add_u32 s11, s11, 1013904223
  s_mov_b32 s88, 30720
  s_mul_i32 s75, s61, 1536
  s_add_u32 s88, s88, s75
  s_mul_i32 s75, s62, 128
  s_add_u32 s88, s88, s75
  s_mul_i32 s75, s3, 4
  s_add_u32 s88, s88, s75
  s_and_b32 s92, s2, 3
  s_lshr_b32 s93, s2, 3
  s_bfe_u32 s60, s2, 0x10002
  s_mul_hi_u32 s62, s93, 858993460
  s_mul_i32 s61, s62, 5
  s_sub_u32 s61, s93, s61
  s_lshr_b32 s70, s93, 2
  s_and_b32 s71, s93, 3
  s_bitcmp1_b32 s92, 0
  s_cselect_b32 s62, s70, s62
  s_cselect_b32 s61, s71, s61
  s_lshl_b32 s70, s92, 2
  s_lshr_b32 s71, 0x0650, s70
  s_and_b32 s71, s71, 15
  s_add_u32 s62, s62, s71
  s_lshr_b32 s71, 0x5400, s70
  s_and_b32 s71, s71, 15
  s_add_u32 s61, s61, s71
  s_mul_i32 s92, s92, 25
  s_add_u32 s92, s92, s93
  s_cmp_eq_u32 s92, 20
  s_cselect_b32 s61, 4, s61
  s_cselect_b32 s62, 5, s62
  s_cmp_eq_u32 s92, 49
  s_cselect_b32 s62, 4, s62
  s_mov_b32 s63, 0
  s_mul_i32 s75, s60, 2433024
  s_add_u32 s63, s63, s75
  s_mul_i32 s75, s62, 221184
  s_add_u32 s63, s63, s75
  s_mov_b32 s64, 221184
  s_cmp_eq_u32 s62, 10
  s_cselect_b32 s64, 147456, s64
  s_lshl_b32 s65, s61, 8
  s_add_u32 s84, s61, s62
  v_add_u32 v20, s84, v1
  v_mov_b32 v22, 3
  v_mul_u32_u24 v21, 13108, v20
  v_lshrrev_b32 v21, 16, v21
  v_mul_u32_u24 v21, 5, v21
  v_sub_u32 v20, v20, v21
  v_cmp_ge_u32 vcc, 3, v20
  v_cmp_eq_u32 s[66:67], 0, v20
  v_sub_u32 v20, v1, v20
  v_cndmask_b32 v21, 0, -1, vcc
  v_cmp_gt_u32 vcc, 15, v20
  v_cndmask_b32 v21, v21, v22, s[66:67]
  s_nop 0
  v_cndmask_b32 v21, 0, v21, vcc
  v_add_u32 v48, v1, v21
  s_and_b32 s84, s2, 7
  s_mul_i32 s84, s84, 9
  s_lshr_b32 s84, s84, 2
  v_add_u32 v48, s84, v48
  v_subrev_u32 v20, 18, v48
  v_min_u32 v48, v48, v20
  s_add_u32 s67, s65, 0
  s_sub_u32 s66, 7962624, s67
  s_add_u32 s24, s42, s67
  s_addc_u32 s25, s43, 0
  s_mov_b32 s26, s66
  s_mov_b32 s27, 0x20000
  s_add_u32 s67, s63, 2097152
  s_add_u32 s28, s58, s67
  s_addc_u32 s29, s59, 0
  s_mov_b32 s30, s64
  s_mov_b32 s31, 0x20000
  s_mov_b32 s7, 2304
  s_mov_b32 s76, 6912
  s_mov_b32 s77, 2304
  s_mov_b32 s78, 442368
  v_mul_u32_u24 v47, s78, v48
  v_lshlrev_b32 v48, 7, v48
  v_mad_u32_u24 v40, v2, s76, v3
  v_add_u32 v41, 26608, v40
  v_add_u32 v42, 53216, v40
  v_add_u32 v43, 79824, v40
  v_mad_u32_u24 v44, v5, s77, v7
  v_xor_b32 v20, 48, v44
  v_add_u32 v45, 17392, v20
  v_add_u32 v46, 34784, v44
  s_mov_b32 s70, 108
  s_mul_i32 s75, s60, 64
  s_add_u32 s70, s70, s75
  s_mul_i32 s75, s62, 6
  s_add_u32 s70, s70, s75
  s_cmp_eq_u32 s62, 10
  s_cselect_b32 s71, 4, 6
  s_sub_u32 s75, s71, 1
  v_min_u32 v49, s75, v1
  v_add_u32 v49, s70, v49
  v_lshlrev_b32 v49, 7, v49
  s_mov_b32 s83, 12
  s_call_b64 s[86:87], L_steady
  buffer_load_dwordx4 v[16:19], v49, s[12:15], 0 offen sc1
  s_mov_b32 s83, 2
  s_call_b64 s[86:87], L_steady
  s_waitcnt vmcnt(14)
  v_xor_b32 v16, s11, v16
  v_xor_b32 v17, s11, v17
  v_xor_b32 v18, s11, v18
  v_xor_b32 v19, s11, v19
  v_or3_b32 v16, v16, v17, v18
  v_or_b32 v16, v16, v19
  v_cmp_eq_u32 s[94:95], 0, v16
  v_readlane_b32 s100, v47, 0
  v_readlane_b32 s101, v48, 0
  s_mov_b32 s98, 1
  s_mov_b64 s[16:17], s[24:25]
  s_mov_b32 s18, s26
  s_mov_b64 s[20:21], s[28:29]
  s_mov_b32 s22, s30
  v_mov_b32 v24, v40
  v_mov_b32 v25, v41
  v_mov_b32 v26, v42
  v_mov_b32 v27, v43
  v_mov_b32 v28, v44
  v_mov_b32 v29, v45
  v_mov_b32 v30, v46
  v_mov_b32 v9, v47
  v_mov_b32 v10, v48
  v_mov_b32 v8, v49
  s_cmp_eq_u64 s[94:95], exec
  s_cbranch_scc1 L_nx_18_g
  s_waitcnt vmcnt(14)
  s_barrier
  s_waitcnt vmcnt(7)
  s_barrier
  s_waitcnt vmcnt(0)
  s_barrier
  s_barrier
  s_call_b64 s[68:69], L_lpoll
  s_call_b64 s[86:87], L_issue2
  s_waitcnt vmcnt(4)
  s_barrier
  s_call_b64 s[86:87], L_issue2
  s_branch L_nx_18_e
L_nx_18_g:
  s_mov_b32 s83, 2
  s_call_b64 s[86:87], L_steady2
  s_barrier
L_nx_18_e:
  s_branch L_l_k
L_l_nou:
  s_mov_b32 s88, -1
  s_and_b32 s92, s2, 3
  s_lshr_b32 s93, s2, 3
  s_bfe_u32 s60, s2, 0x10002
  s_mul_hi_u32 s62, s93, 858993460
  s_mul_i32 s61, s62, 5
  s_sub_u32 s61, s93, s61
  s_lshr_b32 s70, s93, 2
  s_and_b32 s71, s93, 3
  s_bitcmp1_b32 s92, 0
  s_cselect_b32 s62, s70, s62
  s_cselect_b32 s61, s71, s61
  s_lshl_b32 s70, s92, 2
  s_lshr_b32 s71, 0x0650, s70
  s_and_b32 s71, s71, 15
  s_add_u32 s62, s62, s71
  s_lshr_b32 s71, 0x5400, s70
  s_and_b32 s71, s71, 15
  s_add_u32 s61, s61, s71
  s_mul_i32 s92, s92, 25
  s_add_u32 s92, s92, s93
  s_cmp_eq_u32 s92, 20
  s_cselect_b32 s61, 4, s61
  s_cselect_b32 s62, 5, s62
  s_cmp_eq_u32 s92, 49
  s_cselect_b32 s62, 4, s62
  s_mov_b32 s63, 0
  s_mul_i32 s75, s60, 2433024
  s_add_u32 s63, s63, s75
  s_mul_i32 s75, s62, 221184
  s_add_u32 s63, s63, s75
  s_mov_b32 s64, 221184
  s_cmp_eq_u32 s62, 10
  s_cselect_b32 s64, 147456, s64
  s_lshl_b32 s65, s61, 8
  s_cmp_ge_u32 s92, 99
  s_cbranch_scc1 L_fin
  s_add_u32 s84, s61, s62
  v_add_u32 v20, s84, v1
  v_mov_b32 v22, 3
  v_mul_u32_u24 v21, 13108, v20
  v_lshrrev_b32 v21, 16, v21
  v_mul_u32_u24 v21, 5, v21
  v_sub_u32 v20, v20, v21
  v_cmp_ge_u32 vcc, 3, v20
  v_cmp_eq_u32 s[66:67], 0, v20
  v_sub_u32 v20, v1, v20
  v_cndmask_b32 v21, 0, -1, vcc
  v_cmp_gt_u32 vcc, 15, v20
  v_cndmask_b32 v21, v21, v22, s[66:67]
  s_nop 0
  v_cndmask_b32 v21, 0, v21, vcc
  v_add_u32 v10, v1, v21
  s_and_b32 s84, s2, 7
  s_mul_i32 s84, s84, 9
  s_lshr_b32 s84, s84, 2
  v_add_u32 v10, s84, v10
  v_subrev_u32 v20, 18, v10
  v_min_u32 v10, v10, v20
  s_add_u32 s67, s65, 0
  s_sub_u32 s66, 7962624, s67
  s_add_u32 s16, s42, s67
  s_addc_u32 s17, s43, 0
  s_mov_b32 s18, s66
  s_mov_b32 s19, 0x20000
  s_add_u32 s67, s63, 2097152
  s_add_u32 s20, s58, s67
  s_addc_u32 s21, s59, 0
  s_mov_b32 s22, s64
  s_mov_b32 s23, 0x20000
  s_mov_b32 s7, 2304
  s_mov_b32 s76, 6912
  s_mov_b32 s77, 2304
  s_mov_b32 s78, 442368
  v_mul_u32_u24 v9, s78, v10
  v_lshlrev_b32 v10, 7, v10
  v_mad_u32_u24 v24, v2, s76, v3
  v_add_u32 v25, 26608, v24
  v_add_u32 v26, 53216, v24
  v_add_u32 v27, 79824, v24
  v_readlane_b32 s100, v9, 0
  v_readlane_b32 s101, v10, 0
  s_mov_b32 s98, 1
  v_mad_u32_u24 v28, v5, s77, v7
  v_xor_b32 v20, 48, v28
  v_add_u32 v29, 17392, v20
  v_add_u32 v30, 34784, v28
  s_cmp_lg_u32 s3, 4
  s_cbranch_scc1 L_w4_19
  s_mov_b32 s70, 108
  s_mul_i32 s75, s60, 64
  s_add_u32 s70, s70, s75
  s_mul_i32 s75, s62, 6
  s_add_u32 s70, s70, s75
  s_cmp_eq_u32 s62, 10
  s_cselect_b32 s71, 4, 6
  s_sub_u32 s75, s71, 1
  v_min_u32 v8, s75, v1
  v_add_u32 v8, s70, v8
  v_lshlrev_b32 v8, 7, v8
  s_call_b64 s[68:69], L_lpoll
L_w4_19:
  s_barrier
  s_call_b64 s[86:87], L_issue2
  s_waitcnt vmcnt(4)
  s_barrier
  s_call_b64 s[86:87], L_issue2
L_l_k:
  s_mov_b32 s83, 2
  s_call_b64 s[86:87], L_steady2
  s_cmp_lg_u32 s3, 5
  s_cbranch_scc1 L_sg_20
  s_cmp_eq_u32 s88, -1
  s_cbranch_scc1 L_sg_20
  s_sub_u32 s88, s88, 20
  v_mov_b32 v50, s11
  v_lshlrev_b32 v51, 2, v1
  s_mov_b64 exec, 15
  buffer_store_dword v50, v51, s[12:15], s88 offen sc1
  s_mov_b64 exec, -1
L_sg_20:
  s_add_u32 s84, s61, s62
  v_add_u32 v20, s84, v1
  v_mov_b32 v22, 3
  v_mul_u32_u24 v21, 13108, v20
  v_lshrrev_b32 v21, 16, v21
  v_mul_u32_u24 v21, 5, v21
  v_sub_u32 v20, v20, v21
  v_cmp_ge_u32 vcc, 3, v20
  v_cmp_eq_u32 s[66:67], 0, v20
  v_sub_u32 v20, v1, v20
  v_cndmask_b32 v21, 0, -1, vcc
  v_cmp_gt_u32 vcc, 15, v20
  v_cndmask_b32 v21, v21, v22, s[66:67]
  s_nop 0
  v_cndmask_b32 v21, 0, v21, vcc
  v_add_u32 v48, v1, v21
  s_add_u32 s67, s65, 26427392
  s_add_u32 s24, s58, s67
  s_addc_u32 s25, s59, 0
  s_mov_b32 s26, 67108864
  s_mov_b32 s27, 0x20000
  s_add_u32 s67, s63, 2097152
  s_add_u32 s28, s58, s67
  s_addc_u32 s29, s59, 0
  s_mov_b32 s30, s64
  s_mov_b32 s31, 0x20000
  s_mov_b32 s7, 2304
  s_mov_b32 s76, 2304
  s_mov_b32 s77, 2304
  s_mov_b32 s78, 147456
  v_mul_u32_u24 v47, s78, v48
  v_lshlrev_b32 v48, 7, v48
  v_mad_u32_u24 v40, v2, s76, v3
  v_add_u32 v41, 8176, v40
  v_add_u32 v42, 16352, v40
  v_add_u32 v43, 24528, v40
  v_mad_u32_u24 v44, v5, s77, v7
  v_xor_b32 v20, 48, v44
  v_add_u32 v45, 17392, v20
  v_add_u32 v46, 34784, v44
  s_mov_b32 s70, 240
  s_mul_i32 s75, s61, 12
  s_add_u32 s70, s70, s75
  v_min_u32 v49, 11, v1
  v_add_u32 v49, s70, v49
  v_lshlrev_b32 v49, 7, v49
  s_mov_b32 s83, 13
  s_call_b64 s[86:87], L_steady2
  buffer_load_dwordx4 v[16:19], v49, s[12:15], 0 offen sc1
  s_mov_b32 s83, 1
  s_call_b64 s[86:87], L_steady2
  s_waitcnt vmcnt(11)
  v_xor_b32 v16, s11, v16
  v_xor_b32 v17, s11, v17
  v_xor_b32 v18, s11, v18
  v_xor_b32 v19, s11, v19
  v_or3_b32 v16, v16, v17, v18
  v_or_b32 v16, v16, v19
  v_cmp_eq_u32 s[94:95], 0, v16
  v_readlane_b32 s100, v47, 0
  v_readlane_b32 s101, v48, 0
  s_mov_b32 s98, 1
  s_mov_b64 s[16:17], s[24:25]
  s_mov_b32 s18, s26
  s_mov_b64 s[20:21], s[28:29]
  s_mov_b32 s22, s30
  v_mov_b32 v24, v40
  v_mov_b32 v25, v41
  v_mov_b32 v26, v42
  v_mov_b32 v27, v43
  v_mov_b32 v28, v44
  v_mov_b32 v29, v45
  v_mov_b32 v30, v46
  v_mov_b32 v9, v47
  v_mov_b32 v10, v48
  v_mov_b32 v8, v49
  s_cmp_eq_u64 s[94:95], exec
  s_cbranch_scc1 L_nx_21_g
  s_waitcnt vmcnt(11)
  s_barrier
  s_waitcnt vmcnt(4)
  s_barrier
  s_waitcnt vmcnt(0)
  s_barrier
  s_barrier
  s_call_b64 s[68:69], L_prep_S
  s_call_b64 s[68:69], L_lpoll
  s_mov_b32 s83, 2
  s_call_b64 s[86:87], L_issue
  s_waitcnt vmcnt(7)
  s_barrier
  s_mov_b32 s83, 2
  s_call_b64 s[86:87], L_issue
  s_branch L_nx_21_e
L_nx_21_g:
  s_waitcnt vmcnt(11)
  s_mov_b32 s83, 1
  s_call_b64 s[86:87], L_steady
  s_waitcnt vmcnt(11)
  s_mov_b32 s83, 1
  s_call_b64 s[86:87], L_steady
  s_mov_b32 s83, 2
  s_call_b64 s[86:87], L_steady
  s_call_b64 s[68:69], L_prep_S
  s_barrier
L_nx_21_e:
  s_mov_b32 s83, 2
  s_call_b64 s[86:87], L_steady
  s_cmp_lg_u32 s3, 5
  s_cbranch_scc1 L_sg_22
  s_mov_b32 s88, 44544
  s_mul_i32 s75, s60, 12672
  s_add_u32 s88, s88, s75
  s_mul_i32 s75, s62, 1152
  s_add_u32 s88, s88, s75
  s_mul_i32 s75, s61, 128
  s_add_u32 s88, s88, s75
  s_mul_i32 s75, s3, 4
  s_add_u32 s88, s88, s75
  s_sub_u32 s88, s88, 20
  v_mov_b32 v50, s11
  v_lshlrev_b32 v51, 2, v1
  s_mov_b64 exec, 15
  buffer_store_dword v50, v51, s[12:15], s88 offen sc1
  s_mov_b64 exec, -1
L_sg_22:
  s_mov_b32 s83, 10
  s_call_b64 s[86:87], L_steady
  buffer_load_dwordx4 v[16:19], v49, s[12:15], 0 offen sc1
  s_mov_b32 s83, 2
  s_call_b64 s[86:87], L_steady
  s_waitcnt vmcnt(14)
  v_xor_b32 v16, s11, v16
  v_xor_b32 v17, s11, v17
  v_xor_b32 v18, s11, v18
  v_xor_b32 v19, s11, v19
  v_or3_b32 v16, v16, v17, v18
  v_or_b32 v16, v16, v19
  v_cmp_eq_u32 s[94:95], 0, v16
  v_readlane_b32 s100, v47, 0
  v_readlane_b32 s101, v48, 0
  s_mov_b32 s98, 1
  s_mov_b64 s[16:17], s[24:25]
  s_mov_b32 s18, s26
  s_mov_b64 s[20:21], s[28:29]
  s_mov_b32 s22, s30
  v_mov_b32 v24, v40
  v_mov_b32 v25, v41
  v_mov_b32 v26, v42
  v_mov_b32 v27, v43
  v_mov_b32 v28, v44
  v_mov_b32 v29, v45
  v_mov_b32 v30, v46
  v_mov_b32 v9, v47
  v_mov_b32 v10, v48
  v_mov_b32 v8, v49
  s_cmp_eq_u64 s[94:95], exec
  s_cbranch_scc1 L_nx_23_g
  s_waitcnt vmcnt(14)
  s_barrier
  s_waitcnt vmcnt(7)
  s_barrier
  s_waitcnt vmcnt(0)
  s_barrier
  s_barrier
  s_call_b64 s[68:69], L_lpoll
  s_mov_b32 s83, 2
  s_call_b64 s[86:87], L_issue
  s_waitcnt vmcnt(7)
  s_barrier
  s_mov_b32 s83, 2
  s_call_b64 s[86:87], L_issue
  s_branch L_nx_23_e
L_nx_23_g:
  s_mov_b32 s83, 4
  s_call_b64 s[86:87], L_steady
  s_barrier
L_nx_23_e:
  s_mov_b32 s83, 2
  s_call_b64 s[86:87], L_steady
  s_cmp_lg_u32 s3, 5
  s_cbranch_scc1 L_sg_24
  s_mov_b32 s88, 69888
  s_mul_i32 s75, s60, 12672
  s_add_u32 s88, s88, s75
  s_mul_i32 s75, s61, 1408
  s_add_u32 s88, s88, s75
  s_mul_i32 s75, s62, 128
  s_add_u32 s88, s88, s75
  s_mul_i32 s75, s3, 4
  s_add_u32 s88, s88, s75
  s_sub_u32 s88, s88, 20
  v_mov_b32 v50, s11
  v_lshlrev_b32 v51, 2, v1
  s_mov_b64 exec, 15
  buffer_store_dword v50, v51, s[12:15], s88 offen sc1
  s_mov_b64 exec, -1
L_sg_24:
  s_mov_b32 s83, 12
  s_call_b64 s[86:87], L_steady
  s_waitcnt vmcnt(14)
  s_barrier
  s_mov_b32 s70, 0
  s_mul_i32 s75, s60, 2359296
  s_add_u32 s70, s70, s75
  s_mul_i32 s75, s62, 221184
  s_add_u32 s70, s70, s75
  s_mul_i32 s75, s65, 1
  s_add_u32 s70, s70, s75
  s_sub_u32 s71, s64, s65
  s_add_u32 s24, s36, s70
  s_addc_u32 s25, s37, 0
  s_mov_b32 s26, s71
  s_mov_b32 s27, 0x20000
  s_sub_u32 s84, s3, 4
  s_mul_i32 s70, s84, 24
  v_lshrrev_b32 v50, 4, v1
  v_add_u32 v50, s70, v50
  v_mul_u32_u24 v50, 2304, v50
  v_and_b32 v51, 15, v1
  v_lshl_add_u32 v50, v51, 4, v50
  s_mul_i32 s84, s84, 2080
  s_add_u32 s84, s84, s82
  s_add_u32 m0, s84, 0
  v_add_u32 v51, 0, v50
  buffer_load_dwordx4 v51, s[24:27], 0 offen nt lds
  s_add_u32 m0, s84, 1040
  v_add_u32 v51, 9216, v50
  buffer_load_dwordx4 v51, s[24:27], 0 offen nt lds
  s_add_u32 m0, s84, 2080
  v_add_u32 v51, 18432, v50
  buffer_load_dwordx4 v51, s[24:27], 0 offen nt lds
  s_add_u32 m0, s84, 3120
  v_add_u32 v51, 27648, v50
  buffer_load_dwordx4 v51, s[24:27], 0 offen nt lds
  s_add_u32 m0, s84, 4160
  v_add_u32 v51, 36864, v50
  buffer_load_dwordx4 v51, s[24:27], 0 offen nt lds
  s_add_u32 m0, s84, 5200
  v_add_u32 v51, 46080, v50
  buffer_load_dwordx4 v51, s[24:27], 0 offen nt lds
  s_add_u32 s82, s82, 29120
  s_cmp_ge_u32 s82, 145600
  s_cselect_b32 s82, s85, s82
  s_mov_b32 m0, s82
  s_waitcnt vmcnt(13)
  s_barrier
  s_waitcnt vmcnt(6)
  s_barrier
  s_barrier
  s_add_u32 s84, s61, s62
  v_lshrrev_b32 v10, 1, v1
  v_subrev_u32 v10, 1, v10
  s_add_u32 s84, s62, 3
  v_add_u32 v20, s84, v10
  v_mov_b32 v22, 1
  v_mul_u32_u24 v21, 21846, v20
  v_lshrrev_b32 v21, 16, v21
  v_mul_u32_u24 v21, 3, v21
  v_sub_u32 v20, v20, v21
  v_cmp_ge_u32 vcc, 1, v20
  v_cmp_eq_u32 s[66:67], 0, v20
  v_sub_u32 v20, v10, v20
  v_cndmask_b32 v21, 0, -1, vcc
  v_cmp_gt_u32 vcc, 6, v20
  v_cndmask_b32 v21, v21, v22, s[66:67]
  s_nop 0
  v_cndmask_b32 v21, 0, v21, vcc
  v_add_u32 v10, v10, v21
  s_add_u32 s84, s61, 1
  v_add_u32 v20, 1, v10
  v_and_b32 v20, 8, v20
  v_add_u32 v10, s84, v10
  v_and_b32 v10, 7, v10
  v_max_u32 v10, v10, v20
  v_and_b32 v20, 1, v1
  v_lshl_add_u32 v10, v10, 1, v20
  s_mul_i32 s70, s60, 2433024
  s_add_u32 s70, s70, s65
  s_add_u32 s67, s70, 16695296
  s_add_u32 s16, s58, s67
  s_addc_u32 s17, s59, 0
  s_mov_b32 s18, 67108864
  s_mov_b32 s19, 0x20000
  s_add_u32 s67, s63, 21561344
  s_add_u32 s20, s58, s67
  s_addc_u32 s21, s59, 0
  s_mov_b32 s22, s64
  s_mov_b32 s23, 0x20000
  s_mov_b32 s7, 2304
  s_mov_b32 s76, 2304
  s_mov_b32 s77, 2304
  s_mov_b32 s78, 147456
  v_mul_u32_u24 v9, s78, v10
  v_lshlrev_b32 v10, 11, v10
  v_mad_u32_u24 v24, v2, s76, v3
  v_add_u32 v25, 8176, v24
  v_add_u32 v26, 16352, v24
  v_add_u32 v27, 24528, v24
  v_readlane_b32 s100, v9, 0
  v_readlane_b32 s101, v10, 0
  s_mov_b32 s98, 1
  s_sub_u32 s84, s3, 4
  s_mul_i32 s84, s84, 3
  s_add_u32 s84, s84, 0
  s_lshr_b32 s75, s84, 1
  s_mul_i32 s75, s75, 34816
  s_lshl_b32 s84, s84, 10
  s_add_u32 s84, s84, s75
  s_add_u32 s84, s84, 0x40
  v_lshl_add_u32 v28, v1, 4, s84
  s_sub_u32 s84, s3, 4
  s_mul_i32 s84, s84, 3
  s_add_u32 s84, s84, 1
  s_lshr_b32 s75, s84, 1
  s_mul_i32 s75, s75, 34816
  s_lshl_b32 s84, s84, 10
  s_add_u32 s84, s84, s75
  s_add_u32 s84, s84, 0xfffffc30
  v_lshl_add_u32 v29, v1, 4, s84
  s_sub_u32 s84, s3, 4
  s_mul_i32 s84, s84, 3
  s_add_u32 s84, s84, 2
  s_lshr_b32 s75, s84, 1
  s_mul_i32 s75, s75, 34816
  s_lshl_b32 s84, s84, 10
  s_add_u32 s84, s84, s75
  s_add_u32 s84, s84, 0xfffff820
  v_lshl_add_u32 v30, v1, 4, s84
  s_sub_u32 s20, s20, 64
  s_subb_u32 s21, s21, 0
  s_add_u32 s22, s22, 64
  s_mov_b32 s70, 327680
  s_mul_i32 s75, s60, 143616
  s_add_u32 s70, s70, s75
  s_mul_i32 s75, s62, 768
  s_add_u32 s70, s70, s75
  s_add_u32 s28, s58, s70
  s_addc_u32 s29, s59, 0
  s_mov_b32 s30, 1048576
  s_mov_b32 s31, 0x20000
  v_and_b32 v112, 15, v1
  s_sub_u32 s91, s3, 4
  s_min_u32 s91, s91, 2
  s_lshl_b32 s92, s91, 4
  v_add_lshl_u32 v100, v112, s92, 3
  v_lshrrev_b32 v101, 4, v1
  s_movk_i32 s92, 8448
  v_add_u32 v96, 0, v101
  v_subrev_u32 v96, 1, v96
  s_add_u32 s84, s62, 3
  v_add_u32 v103, s84, v96
  v_mov_b32 v105, 1
  v_mul_u32_u24 v104, 21846, v103
  v_lshrrev_b32 v104, 16, v104
  v_mul_u32_u24 v104, 3, v104
  v_sub_u32 v103, v103, v104
  v_cmp_ge_u32 vcc, 1, v103
  v_cmp_eq_u32 s[66:67], 0, v103
  v_sub_u32 v103, v96, v103
  v_cndmask_b32 v104, 0, -1, vcc
  v_cmp_gt_u32 vcc, 6, v103
  v_cndmask_b32 v104, v104, v105, s[66:67]
  s_nop 0
  v_cndmask_b32 v104, 0, v104, vcc
  v_add_u32 v96, v96, v104
  s_add_u32 s84, s61, 1
  v_add_u32 v103, 1, v96
  v_and_b32 v103, 8, v103
  v_add_u32 v96, s84, v96
  v_and_b32 v96, 7, v96
  v_max_u32 v96, v96, v103
  v_lshlrev_b32 v96, 1, v96
  v_mad_u32_u24 v96, v96, s92, v100
  v_add_u32 v97, s92, v96
  v_add_u32 v98, 4, v101
  v_subrev_u32 v98, 1, v98
  s_add_u32 s84, s62, 3
  v_add_u32 v103, s84, v98
  v_mov_b32 v105, 1
  v_mul_u32_u24 v104, 21846, v103
  v_lshrrev_b32 v104, 16, v104
  v_mul_u32_u24 v104, 3, v104
  v_sub_u32 v103, v103, v104
  v_cmp_ge_u32 vcc, 1, v103
  v_cmp_eq_u32 s[66:67], 0, v103
  v_sub_u32 v103, v98, v103
  v_cndmask_b32 v104, 0, -1, vcc
  v_cmp_gt_u32 vcc, 6, v103
  v_cndmask_b32 v104, v104, v105, s[66:67]
  s_nop 0
  v_cndmask_b32 v104, 0, v104, vcc
  v_add_u32 v98, v98, v104
  s_add_u32 s84, s61, 1
  v_add_u32 v103, 1, v98
  v_and_b32 v103, 8, v103
  v_add_u32 v98, s84, v98
  v_and_b32 v98, 7, v98
  v_max_u32 v98, v98, v103
  v_lshlrev_b32 v98, 1, v98
  v_mad_u32_u24 v98, v98, s92, v100
  v_add_u32 v99, s92, v98
  s_lshl_b32 s92, s91, 6
  s_add_u32 s92, s92, 149696
  v_lshl_add_u32 v112, v112, 2, s92
  v_mul_u32_u24 v101, 192, v101
  v_add_u32 v101, v101, v112
  s_mov_b32 s70, 744
  s_mul_i32 s75, s60, 99
  s_add_u32 s70, s70, s75
  s_mul_i32 s75, s62, 9
  s_add_u32 s70, s70, s75
  s_mov_b32 s71, 546
  s_mul_i32 s75, s60, 99
  s_add_u32 s71, s71, s75
  s_mul_i32 s75, s61, 11
  s_add_u32 s71, s71, s75
  s_cmp_lg_u32 s3, 4
  s_cbranch_scc1 L_w4_25
  s_cmp_eq_u32 s61, 8
  s_cselect_b32 s66, s70, s71
  v_min_u32 v20, 11, v1
  s_sub_u32 s75, s71, 0
  v_mov_b32 v8, s75
  s_sub_u32 s75, s66, 11
  v_mov_b32 v21, s75
  v_cmp_le_u32 vcc, 11, v20
  s_nop 1
  v_cndmask_b32 v8, v8, v21, vcc
  v_add_lshl_u32 v8, v8, v20, 7
  s_call_b64 s[68:69], L_lpoll
L_w4_25:
  v_and_b32 v8, 7, v1
  s_add_u32 s66, s61, 1
  v_add_u32 v8, s66, v8
  v_subrev_u32 v20, 9, v8
  v_min_u32 v8, v8, v20
  v_add_lshl_u32 v8, v8, s70, 7
  s_waitcnt vmcnt(0)
  s_barrier
  s_mov_b32 s83, 2
  s_call_b64 s[86:87], L_issue
  buffer_load_dwordx4 v[16:19], v8, s[12:15], 0 offen sc1
  s_waitcnt vmcnt(8)
  s_barrier
  s_waitcnt vmcnt(0)
  v_xor_b32 v16, s11, v16
  v_xor_b32 v17, s11, v17
  v_xor_b32 v18, s11, v18
  v_xor_b32 v19, s11, v19
  v_or3_b32 v16, v16, v17, v18
  v_or_b32 v16, v16, v19
  v_cmp_ne_u32 vcc, 0, v16
  s_cbranch_vccz L_pv_fast
  s_barrier
  s_call_b64 s[68:69], L_lpoll
  s_mov_b32 s93, 135168
  buffer_load_dwordx2 v[64:65], v96, s[28:31], 0 offen offset:0 sc1
  buffer_load_dwordx2 v[66:67], v96, s[28:31], 0 offen offset:384 sc1
  buffer_load_dwordx2 v[70:71], v97, s[28:31], 0 offen offset:0 sc1
  buffer_load_dwordx2 v[72:73], v97, s[28:31], 0 offen offset:384 sc1
  buffer_load_dwordx2 v[76:77], v98, s[28:31], 0 offen offset:0 sc1
  buffer_load_dwordx2 v[78:79], v98, s[28:31], 0 offen offset:384 sc1
  buffer_load_dwordx2 v[82:83], v99, s[28:31], 0 offen offset:0 sc1
  buffer_load_dwordx2 v[84:85], v99, s[28:31], 0 offen offset:384 sc1
  buffer_load_dwordx2 v[88:89], v100, s[28:31], s93 offen offset:0 sc1
  buffer_load_dwordx2 v[90:91], v100, s[28:31], s93 offen offset:384 sc1
  s_mov_b32 s83, 2
  s_call_b64 s[86:87], L_issue
  s_branch L_pv_tab
L_pv_fast:
  s_mov_b32 s93, 135168
  buffer_load_dwordx2 v[64:65], v96, s[28:31], 0 offen offset:0 sc1
  buffer_load_dwordx2 v[66:67], v96, s[28:31], 0 offen offset:384 sc1
  buffer_load_dwordx2 v[70:71], v97, s[28:31], 0 offen offset:0 sc1
  buffer_load_dwordx2 v[72:73], v97, s[28:31], 0 offen offset:384 sc1
  buffer_load_dwordx2 v[76:77], v98, s[28:31], 0 offen offset:0 sc1
  buffer_load_dwordx2 v[78:79], v98, s[28:31], 0 offen offset:384 sc1
  buffer_load_dwordx2 v[82:83], v99, s[28:31], 0 offen offset:0 sc1
  buffer_load_dwordx2 v[84:85], v99, s[28:31], 0 offen offset:384 sc1
  buffer_load_dwordx2 v[88:89], v100, s[28:31], s93 offen offset:0 sc1
  buffer_load_dwordx2 v[90:91], v100, s[28:31], s93 offen offset:384 sc1
  s_mov_b32 s83, 1
  s_call_b64 s[86:87], L_issue
  s_waitcnt vmcnt(17)
  s_barrier
  s_mov_b32 s83, 1
  s_call_b64 s[86:87], L_issue
L_pv_tab:
  s_waitcnt vmcnt(14)
  v_max3_f32 v104, v64, v76, v88
  v_max3_f32 v105, v66, v78, v90
  v_mov_b32 v108, v104
  v_mov_b32 v109, v105
  s_nop 1
  v_permlane16_swap_b32 v104, v108
  v_permlane16_swap_b32 v105, v109
  v_max_f32 v104, v104, v108
  v_max_f32 v105, v105, v109
  v_mov_b32 v108, v104
  v_mov_b32 v109, v105
  s_nop 1
  v_permlane32_swap_b32 v104, v108
  v_permlane32_swap_b32 v105, v109
  v_max_f32 v104, v104, v108
  v_max_f32 v105, v105, v109
  v_sub_f32 v64, v64, v104
  v_sub_f32 v66, v66, v105
  v_sub_f32 v76, v76, v104
  v_sub_f32 v78, v78, v105
  v_sub_f32 v88, v88, v104
  v_sub_f32 v90, v90, v105
  v_exp_f32 v64, v64
  v_exp_f32 v66, v66
  v_exp_f32 v76, v76
  v_exp_f32 v78, v78
  v_exp_f32 v88, v88
  v_exp_f32 v90, v90
  v_mul_f32 v104, v64, v65
  v_mul_f32 v105, v66, v67
  v_fmac_f32 v104, v64, v71
  v_fmac_f32 v105, v66, v73
  v_fmac_f32 v104, v76, v77
  v_fmac_f32 v105, v78, v79
  v_fmac_f32 v104, v76, v83
  v_fmac_f32 v105, v78, v85
  v_mov_b32 v108, v104
  v_mov_b32 v109, v105
  s_nop 1
  v_permlane16_swap_b32 v104, v108
  v_permlane16_swap_b32 v105, v109
  v_add_f32 v104, v104, v108
  v_add_f32 v105, v105, v109
  v_mov_b32 v108, v104
  v_mov_b32 v109, v105
  s_nop 1
  v_permlane32_swap_b32 v104, v108
  v_permlane32_swap_b32 v105, v109
  v_add_f32 v104, v104, v108
  v_add_f32 v105, v105, v109
  v_fmac_f32 v104, v88, v89
  v_fmac_f32 v105, v90, v91
  v_rcp_f32 v104, v104
  v_rcp_f32 v105, v105
  s_nop 0
  v_mul_f32 v64, v64, v104
  ds_write_b32 v101, v64 offset:0
  v_mul_f32 v66, v66, v105
  ds_write_b32 v101, v66 offset:1728
  v_mul_f32 v76, v76, v104
  ds_write_b32 v101, v76 offset:768
  v_mul_f32 v78, v78, v105
  ds_write_b32 v101, v78 offset:2496
  v_mul_f32 v88, v88, v104
  ds_write_b32 v112, v88 offset:1536
  v_mul_f32 v90, v90, v105
  ds_write_b32 v112, v90 offset:3264
  s_waitcnt vmcnt(7)
  s_barrier
  s_mov_b32 s83, 2
  s_call_b64 s[86:87], L_issue
  s_waitcnt lgkmcnt(0)
  s_mov_b32 s83, 8
  s_call_b64 s[86:87], L_steady
  s_cmp_lg_u32 s3, 4
  s_cbranch_scc1 L_w4_26
  s_lshl_b32 s66, s61, 1
  s_add_u32 s66, s66, 996
  s_lshl_b32 s67, s61, 2
  v_min_u32 v20, 5, v1
  s_sub_u32 s75, s67, 0
  v_mov_b32 v8, s75
  s_sub_u32 s75, s66, 4
  v_mov_b32 v21, s75
  v_cmp_le_u32 vcc, 4, v20
  s_nop 1
  v_cndmask_b32 v8, v8, v21, vcc
  v_add_lshl_u32 v8, v8, v20, 7
  buffer_load_dwordx4 v[16:19], v8, s[12:15], 0 offen sc1
L_w4_26:
  s_mov_b32 s83, 2
  s_call_b64 s[86:87], L_steady
  s_cmp_lg_u32 s3, 4
  s_cbranch_scc1 L_w4_27
  s_waitcnt vmcnt(14)
  v_xor_b32 v16, s11, v16
  v_xor_b32 v17, s11, v17
  v_xor_b32 v18, s11, v18
  v_xor_b32 v19, s11, v19
  v_or3_b32 v16, v16, v17, v18
  v_or_b32 v16, v16, v19
  v_cmp_eq_u32 vcc, 0, v16
  s_cmp_eq_u64 vcc, exec
  s_cbranch_scc1 L_dep_ok_28
  s_call_b64 s[68:69], L_lpoll
L_dep_ok_28:
  s_mov_b32 s67, 262144
  s_mul_i32 s75, s60, 4608
  s_add_u32 s67, s67, s75
  s_mul_i32 s75, s65, 2
  s_add_u32 s67, s67, s75
  s_add_u32 s24, s58, s67
  s_addc_u32 s25, s59, 0
  s_mov_b32 s26, 18944
  s_mov_b32 s27, 0x20000
  v_lshrrev_b32 v21, 5, v1
  v_mul_u32_u24 v21, 17920, v21
  v_lshl_add_u32 v20, v1, 4, v21
  s_mov_b32 m0, 158912
  s_nop 0
  buffer_load_dwordx4 v20, s[24:27], 0 offen sc1 lds
  s_mov_b32 m0, s82
L_w4_27:
  s_mov_b32 s83, 1
  s_call_b64 s[86:87], L_steady
  s_waitcnt vmcnt(14)
  s_barrier
  s_waitcnt vmcnt(7)
  s_barrier
  s_waitcnt vmcnt(0)
  s_barrier
  s_barrier
  s_branch L_fin
L_issue:
  buffer_load_dwordx4 v24, s[16:19], s100 offen offset:0 sc1 lds
  buffer_load_dwordx4 v25, s[16:19], s100 offen offset:1040 sc1 lds
  buffer_load_dwordx4 v26, s[16:19], s100 offen offset:2080 sc1 lds
  buffer_load_dwordx4 v27, s[16:19], s100 offen offset:3120 sc1 lds
  s_add_u32 m0, s82, s5
  v_readlane_b32 s100, v9, s98
  buffer_load_dwordx4 v28, s[20:23], s101 offen offset:0 sc1 lds
  s_add_u32 s82, s82, 29120
  s_cmp_ge_u32 s82, 145600
  buffer_load_dwordx4 v29, s[20:23], s101 offen offset:1040 sc1 lds
  s_cselect_b32 s82, s85, s82
  buffer_load_dwordx4 v30, s[20:23], s101 offen offset:2080 sc1 lds
  s_mov_b32 m0, s82
  v_readlane_b32 s101, v10, s98
  s_add_u32 s98, s98, 1
  s_sub_u32 s83, s83, 1
  s_cmp_lg_u32 s83, 0
  s_cbranch_scc1 L_issue
  s_setpc_b64 s[86:87]
L_steady:
  s_waitcnt vmcnt(14)
  s_barrier
  buffer_load_dwordx4 v24, s[16:19], s100 offen offset:0 sc1 lds
  buffer_load_dwordx4 v25, s[16:19], s100 offen offset:1040 sc1 lds
  buffer_load_dwordx4 v26, s[16:19], s100 offen offset:2080 sc1 lds
  buffer_load_dwordx4 v27, s[16:19], s100 offen offset:3120 sc1 lds
  s_add_u32 m0, s82, s5
  v_readlane_b32 s100, v9, s98
  buffer_load_dwordx4 v28, s[20:23], s101 offen offset:0 sc1 lds
  s_add_u32 s82, s82, 29120
  s_cmp_ge_u32 s82, 145600
  buffer_load_dwordx4 v29, s[20:23], s101 offen offset:1040 sc1 lds
  s_cselect_b32 s82, s85, s82
  buffer_load_dwordx4 v30, s[20:23], s101 offen offset:2080 sc1 lds
  s_mov_b32 m0, s82
  v_readlane_b32 s101, v10, s98
  s_add_u32 s98, s98, 1
  s_sub_u32 s83, s83, 1
  s_cmp_lg_u32 s83, 0
  s_cbranch_scc1 L_steady
  s_setpc_b64 s[86:87]
L_issue2:
  buffer_load_dwordx4 v24, s[16:19], s100 offen offset:0 sc1 lds
  buffer_load_dwordx4 v25, s[16:19], s100 offen offset:1040 sc1 lds
  buffer_load_dwordx4 v26, s[16:19], s100 offen offset:2080 sc1 lds
  buffer_load_dwordx4 v27, s[16:19], s100 offen offset:3120 sc1 lds
  s_add_u32 s99, s100, s7
  s_add_u32 m0, s82, s5
  v_readlane_b32 s100, v9, s98
  buffer_load_dwordx4 v28, s[20:23], s101 offen offset:0 sc1 lds
  s_add_u32 s82, s82, 29120
  s_cmp_ge_u32 s82, 145600
  buffer_load_dwordx4 v29, s[20:23], s101 offen offset:1040 sc1 lds
  s_cselect_b32 s82, s85, s82
  buffer_load_dwordx4 v30, s[20:23], s101 offen offset:2080 sc1 lds
  s_mov_b32 m0, s82
  v_readlane_b32 s101, v10, s98
  s_add_u32 s98, s98, 1
  buffer_load_dwordx4 v24, s[16:19], s99 offen offset:0 sc1 lds
  s_add_u32 s82, s82, 29120
  s_cmp_ge_u32 s82, 145600
  buffer_load_dwordx4 v25, s[16:19], s99 offen offset:1040 sc1 lds
  s_cselect_b32 s82, s85, s82
  buffer_load_dwordx4 v26, s[16:19], s99 offen offset:2080 sc1 lds
  buffer_load_dwordx4 v27, s[16:19], s99 offen offset:3120 sc1 lds
  s_mov_b32 m0, s82
  s_nop 0
  s_setpc_b64 s[86:87]
L_steady2:
  s_waitcnt vmcnt(11)
  s_barrier
  buffer_load_dwordx4 v24, s[16:19], s100 offen offset:0 sc1 lds
  buffer_load_dwordx4 v25, s[16:19], s100 offen offset:1040 sc1 lds
  buffer_load_dwordx4 v26, s[16:19], s100 offen offset:2080 sc1 lds
  buffer_load_dwordx4 v27, s[16:19], s100 offen offset:3120 sc1 lds
  s_add_u32 s99, s100, s7
  s_add_u32 m0, s82, s5
  v_readlane_b32 s100, v9, s98
  buffer_load_dwordx4 v28, s[20:23], s101 offen offset:0 sc1 lds
  s_add_u32 s82, s82, 29120
  s_cmp_ge_u32 s82, 145600
  buffer_load_dwordx4 v29, s[20:23], s101 offen offset:1040 sc1 lds
  s_cselect_b32 s82, s85, s82
  buffer_load_dwordx4 v30, s[20:23], s101 offen offset:2080 sc1 lds
  s_mov_b32 m0, s82
  v_readlane_b32 s101, v10, s98
  s_add_u32 s98, s98, 1
  s_waitcnt vmcnt(11)
  s_barrier
  buffer_load_dwordx4 v24, s[16:19], s99 offen offset:0 sc1 lds
  s_add_u32 s82, s82, 29120
  s_cmp_ge_u32 s82, 145600
  buffer_load_dwordx4 v25, s[16:19], s99 offen offset:1040 sc1 lds
  s_cselect_b32 s82, s85, s82
  buffer_load_dwordx4 v26, s[16:19], s99 offen offset:2080 sc1 lds
  buffer_load_dwordx4 v27, s[16:19], s99 offen offset:3120 sc1 lds
  s_mov_b32 m0, s82
  s_nop 0
  s_sub_u32 s83, s83, 1
  s_cmp_lg_u32 s83, 0
  s_cbranch_scc1 L_steady2
  s_setpc_b64 s[86:87]
L_lpoll:
  s_mov_b32 s74, 0x80000
L_lpoll_l:
  buffer_load_dwordx4 v[16:19], v8, s[12:15], 0 offen sc1
  s_waitcnt vmcnt(0)
  v_xor_b32 v16, s11, v16
  v_xor_b32 v17, s11, v17
  v_xor_b32 v18, s11, v18
  v_xor_b32 v19, s11, v19
  v_or3_b32 v16, v16, v17, v18
  v_or_b32 v16, v16, v19
  v_cmp_eq_u32 vcc, 0, v16
  s_cmp_eq_u64 vcc, exec
  s_cbranch_scc1 L_lpoll_d
  s_sub_u32 s74, s74, 1
  s_cmp_eq_u32 s74, 0
  s_cbranch_scc1 L_lpoll_d
  s_sleep 1
  s_branch L_lpoll_l
L_lpoll_d:
  s_setpc_b64 s[68:69]
L_prep_S:
  s_add_u32 s84, s61, s62
  v_add_u32 v20, s84, v1
  v_mov_b32 v22, 3
  v_mul_u32_u24 v21, 13108, v20
  v_lshrrev_b32 v21, 16, v21
  v_mul_u32_u24 v21, 5, v21
  v_sub_u32 v20, v20, v21
  v_cmp_ge_u32 vcc, 3, v20
  v_cmp_eq_u32 s[66:67], 0, v20
  v_sub_u32 v20, v1, v20
  v_cndmask_b32 v21, 0, -1, vcc
  v_cmp_gt_u32 vcc, 15, v20
  v_cndmask_b32 v21, v21, v22, s[66:67]
  s_nop 0
  v_cndmask_b32 v21, 0, v21, vcc
  v_add_u32 v48, v1, v21
  s_mov_b32 s70, 0
  s_mul_i32 s75, s60, 2433024
  s_add_u32 s70, s70, s75
  s_mul_i32 s75, s61, 294912
  s_add_u32 s70, s70, s75
  s_mov_b32 s71, 294912
  s_cmp_eq_u32 s61, 8
  s_cselect_b32 s71, 73728, s71
  s_add_u32 s67, s70, 11829248
  s_add_u32 s24, s58, s67
  s_addc_u32 s25, s59, 0
  s_mov_b32 s26, s71
  s_mov_b32 s27, 0x20000
  s_add_u32 s67, s63, 6963200
  s_add_u32 s28, s58, s67
  s_addc_u32 s29, s59, 0
  s_mov_b32 s30, s64
  s_mov_b32 s31, 0x20000
  s_mov_b32 s7, 2304
  s_mov_b32 s76, 2304
  s_mov_b32 s77, 2304
  s_mov_b32 s78, 2048
  v_mul_u32_u24 v47, s78, v48
  v_lshlrev_b32 v48, 11, v48
  s_sub_u32 s84, s3, 4
  s_mul_i32 s84, s84, 73728
  s_add_u32 s84, s84, 64
  v_lshl_add_u32 v40, v1, 4, s84
  v_add_u32 v41, 0xfffffff0, v40
  v_add_u32 v42, 0x87e0, v40
  v_add_u32 v43, 0x87d0, v40
  s_sub_u32 s24, s24, 64
  s_subb_u32 s25, s25, 0
  s_add_u32 s26, s26, 64
  s_sub_u32 s84, s3, 4
  s_mul_i32 s84, s84, 3
  s_add_u32 s84, s84, 0
  s_lshr_b32 s75, s84, 1
  s_mul_i32 s75, s75, 34816
  s_lshl_b32 s84, s84, 10
  s_add_u32 s84, s84, s75
  s_add_u32 s84, s84, 0x40
  v_lshl_add_u32 v44, v1, 4, s84
  s_sub_u32 s84, s3, 4
  s_mul_i32 s84, s84, 3
  s_add_u32 s84, s84, 1
  s_lshr_b32 s75, s84, 1
  s_mul_i32 s75, s75, 34816
  s_lshl_b32 s84, s84, 10
  s_add_u32 s84, s84, s75
  s_add_u32 s84, s84, 0xfffffc30
  v_lshl_add_u32 v45, v1, 4, s84
  s_sub_u32 s84, s3, 4
  s_mul_i32 s84, s84, 3
  s_add_u32 s84, s84, 2
  s_lshr_b32 s75, s84, 1
  s_mul_i32 s75, s75, 34816
  s_lshl_b32 s84, s84, 10
  s_add_u32 s84, s84, s75
  s_add_u32 s84, s84, 0xfffff820
  v_lshl_add_u32 v46, v1, 4, s84
  s_sub_u32 s28, s28, 64
  s_subb_u32 s29, s29, 0
  s_add_u32 s30, s30, 64
  s_lshl_b32 s70, s61, 2
  s_mul_hi_u32 s71, s70, 1431655766
  s_mov_b32 s70, 348
  s_mul_i32 s75, s60, 99
  s_add_u32 s70, s70, s75
  s_mul_i32 s75, s71, 9
  s_add_u32 s70, s70, s75
  s_cmp_eq_u32 s61, 8
  s_cselect_b32 s70, 960, s70
  s_mov_b32 s66, 348
  s_mul_i32 s75, s60, 99
  s_add_u32 s66, s66, s75
  s_mul_i32 s75, s62, 9
  s_add_u32 s66, s66, s75
  v_min_u32 v20, 26, v1
  s_sub_u32 s75, s70, 0
  v_mov_b32 v49, s75
  s_sub_u32 s75, s66, 18
  v_mov_b32 v21, s75
  v_cmp_le_u32 vcc, 18, v20
  s_nop 1
  v_cndmask_b32 v49, v49, v21, vcc
  v_add_lshl_u32 v49, v49, v20, 7
  s_setpc_b64 s[68:69]
L_laux:
  s_barrier
  s_mov_b32 s8, 0
  s_mov_b32 s60, 0
  s_mov_b32 s10, 0
  s_sub_u32 s62, s9, 42
  s_sub_u32 s92, s9, 18
  s_cmp_lt_u32 s9, 42
  s_cselect_b32 s62, s92, s62
  s_cmp_ge_u32 s9, 0
  s_cselect_b32 s8, 8982, s8
  s_cmp_ge_u32 s9, 18
  s_cselect_b32 s8, 17174, s8
  s_cmp_ge_u32 s9, 36
  s_cselect_b32 s8, 362262, s8
  s_cmp_ge_u32 s9, 42
  s_cselect_b32 s8, 5796214, s8
  s_cmp_ge_u32 s9, 51
  s_cselect_b32 s8, 362263, s8
  s_cmp_ge_u32 s9, 54
  s_cselect_b32 s8, 1911, s8
L_lx_next:
  s_and_b32 s92, s8, 15
  s_lshr_b32 s8, s8, 4
  s_cmp_eq_u32 s92, 1
  s_cbranch_scc1 L_lx_T
  s_cmp_eq_u32 s92, 2
  s_cbranch_scc1 L_lx_VT
  s_cmp_eq_u32 s92, 3
  s_cbranch_scc1 L_lx_Y
  s_cmp_eq_u32 s92, 4
  s_cbranch_scc1 L_lx_AT
  s_cmp_eq_u32 s92, 5
  s_cbranch_scc1 L_lx_OT
  s_cmp_eq_u32 s92, 6
  s_cbranch_scc1 L_lx_X
  s_cmp_eq_u32 s92, 7
  s_cbranch_scc1 L_lx_G
  s_cmp_eq_u32 s92, 8
  s_cbranch_scc1 L_lx_OP
  s_branch L_fin
L_lx_T:
  s_mov_b32 s61, s9
  s_lshl_b32 s65, s61, 7
  s_add_u32 s67, s65, 0
  s_sub_u32 s66, 7962624, s67
  s_add_u32 s16, s44, s67
  s_addc_u32 s17, s45, 0
  s_mov_b32 s18, s66
  s_mov_b32 s19, 0x20000
  s_sub_u32 s84, s3, 4
  s_mov_b32 s76, 6912
  s_mul_i32 s80, s84, 2112
  s_lshl_b32 s84, s84, 4
  v_and_b32 v20, 3, v1
  v_lshlrev_b32 v20, 4, v20
  v_lshrrev_b32 v21, 5, v1
  v_bfe_u32 v22, v1, 2, 2
  v_lshl_add_u32 v21, v21, 2, v22
  v_bfe_u32 v22, v1, 4, 1
  v_lshl_add_u32 v20, v22, 6, v20
  v_add_u32 v21, s84, v21
  v_mad_u32_u24 v24, v21, s76, v20
  v_add_u32 v25, 54240, v24
  s_mov_b32 s78, 442368
  s_mov_b32 s83, 18
  s_call_b64 s[86:87], L_panel_nt
  s_cmp_lg_u32 s3, 4
  s_cbranch_scc1 L_w4_29
  v_min_u32 v8, 3, v1
  v_add_u32 v8, 236, v8
  v_lshlrev_b32 v8, 7, v8
  s_call_b64 s[68:69], L_lpoll
L_w4_29:
  s_waitcnt vmcnt(0)
  s_barrier
  s_barrier
  s_branch L_lx_next
L_lx_VT:
  s_mov_b32 s61, s9
  s_lshl_b32 s65, s61, 7
  s_add_u32 s67, s65, 0
  s_sub_u32 s66, 2654208, s67
  s_add_u32 s16, s46, s67
  s_addc_u32 s17, s47, 0
  s_mov_b32 s18, s66
  s_mov_b32 s19, 0x20000
  s_sub_u32 s84, s3, 4
  s_mov_b32 s76, 2304
  s_mul_i32 s80, s84, 2112
  s_lshl_b32 s84, s84, 4
  v_and_b32 v20, 3, v1
  v_lshlrev_b32 v20, 4, v20
  v_lshrrev_b32 v21, 5, v1
  v_bfe_u32 v22, v1, 2, 2
  v_lshl_add_u32 v21, v21, 2, v22
  v_bfe_u32 v22, v1, 4, 1
  v_lshl_add_u32 v20, v22, 6, v20
  v_add_u32 v21, s84, v21
  v_mad_u32_u24 v24, v21, s76, v20
  v_add_u32 v25, 17376, v24
  s_mov_b32 s78, 147456
  s_mov_b32 s83, 18
  s_call_b64 s[86:87], L_panel
  s_cmp_lg_u32 s3, 4
  s_cbranch_scc1 L_w4_30
  v_min_u32 v8, 17, v1
  v_add_u32 v8, 978, v8
  v_lshlrev_b32 v8, 7, v8
  s_call_b64 s[68:69], L_lpoll
L_w4_30:
  s_waitcnt vmcnt(0)
  s_barrier
  s_barrier
  s_branch L_lx_next
L_lx_Y:
  s_mul_hi_u32 s60, s9, 238609295
  s_mul_i32 s61, s60, 18
  s_sub_u32 s61, s9, s61
  s_lshl_b32 s65, s61, 7
  s_mov_b32 s70, 108
  s_mul_i32 s75, s60, 64
  s_add_u32 s70, s70, s75
  v_min_u32 v8, 63, v1
  v_add_u32 v8, s70, v8
  v_lshlrev_b32 v8, 7, v8
  s_call_b64 s[68:69], L_lpoll
  s_mov_b32 s67, 2097152
  s_mul_i32 s75, s60, 2433024
  s_add_u32 s67, s67, s75
  s_mul_i32 s75, s65, 1
  s_add_u32 s67, s67, s75
  s_add_u32 s16, s58, s67
  s_addc_u32 s17, s59, 0
  s_mov_b32 s18, 2433024
  s_mov_b32 s19, 0x20000
  s_sub_u32 s84, s3, 4
  s_mov_b32 s76, 2304
  s_mul_i32 s80, s84, 2112
  s_lshl_b32 s84, s84, 4
  v_and_b32 v20, 3, v1
  v_lshlrev_b32 v20, 4, v20
  v_lshrrev_b32 v21, 5, v1
  v_bfe_u32 v22, v1, 2, 2
  v_lshl_add_u32 v21, v21, 2, v22
  v_bfe_u32 v22, v1, 4, 1
  v_lshl_add_u32 v20, v22, 6, v20
  v_add_u32 v21, s84, v21
  v_mad_u32_u24 v24, v21, s76, v20
  v_add_u32 v25, 17376, v24
  s_mov_b32 s78, 147456
  s_mov_b32 s83, 16
  s_call_b64 s[86:87], L_panel
  s_cmp_lg_u32 s3, 4
  s_cbranch_scc1 L_w4_31
  v_min_u32 v8, 17, v1
  v_add_u32 v8, 942, v8
  v_lshlrev_b32 v8, 7, v8
  s_call_b64 s[68:69], L_lpoll
L_w4_31:
  s_barrier
  s_cmp_lg_u32 s3, 4
  s_cbranch_scc1 L_w4_32
  s_lshl_b32 s70, s61, 1
  s_mul_hi_u32 s71, s70, 1431655766
  s_min_u32 s71, s71, 9
  s_mov_b32 s70, 348
  s_mul_i32 s75, s60, 99
  s_add_u32 s70, s70, s75
  s_mul_i32 s75, s71, 9
  s_add_u32 s70, s70, s75
  s_cmp_eq_u32 s61, 16
  s_cselect_b32 s70, 960, s70
  v_min_u32 v8, 17, v1
  v_add_u32 v8, s70, v8
  v_lshlrev_b32 v8, 7, v8
  s_call_b64 s[68:69], L_lpoll
L_w4_32:
  s_waitcnt vmcnt(0)
  s_barrier
  s_add_u32 s70, s61, 978
  v_min_u32 v8, 0, v1
  v_add_u32 v8, s70, v8
  v_lshlrev_b32 v8, 7, v8
  s_call_b64 s[68:69], L_lpoll
  s_mov_b32 s83, 1
  s_call_b64 s[86:87], L_panel_l
  s_mov_b32 s71, 1014
  s_mul_i32 s75, s60, 17
  s_add_u32 s71, s71, s75
  s_cmp_lg_u32 s3, 4
  s_cbranch_scc1 L_w4_33
  v_min_u32 v8, 16, v1
  v_add_u32 v8, s71, v8
  v_lshlrev_b32 v8, 7, v8
  s_call_b64 s[68:69], L_lpoll
L_w4_33:
  s_waitcnt vmcnt(0)
  s_barrier
  s_barrier
  s_branch L_lx_next
L_lx_AT:
  s_sub_u32 s61, s9, 18
  s_lshl_b32 s65, s61, 7
  s_add_u32 s67, s65, 4608
  s_sub_u32 s66, 7962624, s67
  s_add_u32 s16, s42, s67
  s_addc_u32 s17, s43, 0
  s_mov_b32 s18, s66
  s_mov_b32 s19, 0x20000
  s_sub_u32 s84, s3, 4
  s_mov_b32 s76, 6912
  s_mul_i32 s80, s84, 2112
  s_lshl_b32 s84, s84, 4
  v_and_b32 v20, 3, v1
  v_lshlrev_b32 v20, 4, v20
  v_lshrrev_b32 v21, 5, v1
  v_bfe_u32 v22, v1, 2, 2
  v_lshl_add_u32 v21, v21, 2, v22
  v_bfe_u32 v22, v1, 4, 1
  v_lshl_add_u32 v20, v22, 6, v20
  v_add_u32 v21, s84, v21
  v_mad_u32_u24 v24, v21, s76, v20
  v_add_u32 v25, 54240, v24
  s_mov_b32 s78, 442368
  s_mov_b32 s83, 18
  s_call_b64 s[86:87], L_panel
  s_cmp_lg_u32 s3, 4
  s_cbranch_scc1 L_w4_34
  v_min_u32 v8, 35, v1
  v_add_u32 v8, 1048, v8
  v_lshlrev_b32 v8, 7, v8
  s_call_b64 s[68:69], L_lpoll
L_w4_34:
  s_waitcnt vmcnt(0)
  s_barrier
  s_barrier
  s_branch L_lx_next
L_lx_OT:
  s_sub_u32 s61, s9, 36
  s_lshl_b32 s65, s61, 7
  s_mov_b32 s70, 36
  s_mul_i32 s75, s61, 2
  s_add_u32 s70, s70, s75
  s_cmp_lg_u32 s3, 4
  s_cbranch_scc1 L_w4_35
  v_min_u32 v8, 1, v1
  v_add_u32 v8, s70, v8
  v_lshlrev_b32 v8, 7, v8
  s_call_b64 s[68:69], L_lpoll
L_w4_35:
  s_barrier
  s_cmp_lg_u32 s3, 4
  s_cbranch_scc1 L_w4_36
  v_min_u32 v8, 17, v1
  v_add_u32 v8, 1084, v8
  v_lshlrev_b32 v8, 7, v8
  s_call_b64 s[68:69], L_lpoll
L_w4_36:
  s_waitcnt vmcnt(0)
  s_barrier
  s_barrier
  s_branch L_lx_next
L_lx_X:
  s_lshl_b32 s92, s9, 1
  s_add_u32 s92, s92, 7
  s_add_u32 s93, s9, 48
  s_cmp_lt_u32 s9, 42
  s_cselect_b32 s92, s93, s92
  s_mov_b32 s81, 1
  s_mov_b32 s66, 1
  s_cbranch_scc0 L_lx_X2
  s_barrier
  s_branch L_lx_next
L_lx_X2:
  s_lshr_b32 s71, s3, 2
  s_mov_b32 s79, 153792
  s_mul_i32 s75, s71, 2048
  s_add_u32 s79, s79, s75
  s_mov_b32 s80, 163528
  s_mul_i32 s75, s71, 4
  s_add_u32 s80, s80, s75
  s_mov_b32 s71, s81
  s_mov_b32 s81, s92
  s_mul_hi_u32 s92, s81, 1431655766
  s_mul_i32 s93, s92, 3
  s_sub_u32 s93, s81, s93
  s_lshl_b32 s67, s92, 7
  s_mul_i32 s70, s93, 384
  s_movk_i32 s78, 9216
  s_mov_b32 s76, 151552
  s_mul_i32 s75, s93, 36864
  s_add_u32 s76, s76, s75
  s_mul_i32 s75, s71, 18432
  s_add_u32 s76, s76, s75
  s_mul_i32 s75, s92, 256
  s_add_u32 s76, s76, s75
  s_mov_b32 s77, 4
  s_mov_b32 s6, -1
  s_call_b64 s[86:87], L_gemv
  s_barrier
  s_branch L_lx_next
L_lx_G:
  s_barrier
  s_lshl_b32 s92, s62, 1
  s_add_u32 s92, s92, 1
  s_add_u32 s10, s10, 1
  s_cmp_lt_u32 s62, 12
  s_cselect_b32 s93, 24, 2
  s_add_u32 s62, s62, s93
  s_cmp_ge_u32 s92, 36
  s_cselect_b32 s93, 1, 0
  s_mul_i32 s75, s93, 36
  s_sub_u32 s92, s92, s75
  s_lshr_b32 s71, s3, 2
  s_mov_b32 s79, 153792
  s_mul_i32 s75, s71, 2048
  s_add_u32 s79, s79, s75
  s_mov_b32 s80, 163560
  s_mul_i32 s75, s71, 4
  s_add_u32 s80, s80, s75
  s_mov_b32 s81, s92
  s_mul_hi_u32 s71, s81, 238609295
  s_mul_i32 s92, s71, 18
  s_sub_u32 s92, s81, s92
  s_lshl_b32 s66, s93, 1
  s_add_u32 s66, s66, 1
  s_lshl_b32 s67, s92, 7
  s_add_u32 s67, s67, 4608
  s_movk_i32 s78, 4608
  s_mul_i32 s70, s93, 384
  s_mov_b32 s6, 0
  s_mul_i32 s75, s81, 256
  s_add_u32 s6, s6, s75
  s_mul_i32 s75, s93, 128
  s_add_u32 s6, s6, s75
  s_mov_b32 s76, 262144
  s_mul_i32 s75, s93, 18432
  s_add_u32 s76, s76, s75
  s_mul_i32 s75, s71, 9216
  s_add_u32 s76, s76, s75
  s_mul_i32 s75, s92, 256
  s_add_u32 s76, s76, s75
  s_lshl_b32 s77, s10, 2
  s_call_b64 s[86:87], L_gemv
  s_branch L_lx_next
L_lx_OP:
  s_sub_u32 s61, s9, 36
  s_lshl_b32 s65, s61, 7
  s_add_u32 s67, s65, 0
  s_sub_u32 s66, 2654208, s67
  s_add_u32 s16, s48, s67
  s_addc_u32 s17, s49, 0
  s_mov_b32 s18, s66
  s_mov_b32 s19, 0x20000
  s_sub_u32 s84, s3, 4
  s_mov_b32 s76, 2304
  s_mul_i32 s80, s84, 2112
  s_lshl_b32 s84, s84, 4
  v_and_b32 v20, 3, v1
  v_lshlrev_b32 v20, 4, v20
  v_lshrrev_b32 v21, 5, v1
  v_bfe_u32 v22, v1, 2, 2
  v_lshl_add_u32 v21, v21, 2, v22
  v_bfe_u32 v22, v1, 4, 1
  v_lshl_add_u32 v20, v22, 6, v20
  v_add_u32 v21, s84, v21
  v_mad_u32_u24 v24, v21, s76, v20
  v_add_u32 v25, 17376, v24
  s_mov_b32 s78, 147456
  s_mov_b32 s83, 18
  s_call_b64 s[86:87], L_panel_nt
  s_branch L_lx_next
L_panel:
  s_mov_b32 s81, 0
L_panel_l:
  s_mov_b32 m0, s80
  s_add_u32 s80, s80, 8448
  buffer_load_dwordx4 v24, s[16:19], s81 offen sc1 lds
  buffer_load_dwordx4 v25, s[16:19], s81 offen offset:1056 sc1 lds
  s_add_u32 s81, s81, s78
  s_sub_u32 s83, s83, 1
  s_cmp_lg_u32 s83, 0
  s_cbranch_scc1 L_panel_l
  s_setpc_b64 s[86:87]
L_panel_nt:
  s_mov_b32 s81, 0
L_panel_nt_l:
  s_mov_b32 m0, s80
  s_add_u32 s80, s80, 8448
  buffer_load_dwordx4 v24, s[16:19], s81 offen nt lds
  buffer_load_dwordx4 v25, s[16:19], s81 offen offset:1056 nt lds
  s_add_u32 s81, s81, s78
  s_sub_u32 s83, s83, 1
  s_cmp_lg_u32 s83, 0
  s_cbranch_scc1 L_panel_nt_l
  s_setpc_b64 s[86:87]
L_fin:
L_end:
  s_endpgm
.section .rodata,"a"
.p2align 6
.amdhsa_kernel standalone__mm_dit__diffusion_kernel
  .amdhsa_next_free_vgpr 256
  .amdhsa_next_free_sgpr 102
  .amdhsa_accum_offset 256
  .amdhsa_group_segment_fixed_size 0
  .amdhsa_kernarg_size 96
  .amdhsa_user_sgpr_count 2
  .amdhsa_user_sgpr_kernarg_segment_ptr 1
  .amdhsa_system_sgpr_workgroup_id_x 1
  .amdhsa_float_denorm_mode_32 3
  .amdhsa_float_denorm_mode_16_64 3
.end_amdhsa_kernel
```
